```python
import torch

def _softmax(x, axis=-1):
    return torch.softmax(x, dim=axis)

def _gelu(x):
    return torch.nn.functional.gelu(x, approximate='tanh')

def _silu(x):
    return torch.nn.functional.silu(x)

def _sigmoid(x):
    return torch.sigmoid(x)

def _layernorm(x, axis=-1, eps=1e-05):
    m = x.mean(dim=axis, keepdim=True)
    v = x.var(dim=axis, keepdim=True, unbiased=False)
    return (x - m) / torch.sqrt(v + eps)

def _scatter_add(tgt, idx, src, axis=0):
    return tgt.clone().index_add_(axis, idx, src)

def _segment_sum(src, seg, n):
    out = torch.zeros((n,) + src.shape[1:], dtype=src.dtype)
    return out.index_add_(0, seg, src)

def _pad(x, pw):
    flat = tuple((v for pair in reversed(pw) for v in pair))
    return torch.nn.functional.pad(x, flat)
kernel_name = 'parallel_sum__sliding_local_dilated__mixer_gmlp__prompt'

def setup_inputs():

    _w = lambda a: (lambda t: t.to(torch.bfloat16) if t.is_floating_point() else t)(torch.as_tensor(a))

    def _A_setup():
        B, S, D = (1, 2048, 512)
        return {'x': _w((lambda *s: torch.randn(*s, dtype=torch.bfloat16) * 0.05)(B, S, D)), 'wqkv': _w((lambda *s: torch.randn(*s, dtype=torch.bfloat16) * 0.1)(D, 3 * D)), 'wo': _w((lambda *s: torch.randn(*s, dtype=torch.bfloat16) * 0.05)(D, D))}
    _A_in = _A_setup()

    def _B_setup():
        B, S, D, F = (1, 2048, 512, 1376)
        Fh = F // 2
        return {'x': _w((lambda *s: torch.randn(*s, dtype=torch.bfloat16) * 0.05)(B, S, D)), 'w_in': _w((lambda *s: torch.randn(*s, dtype=torch.bfloat16) * 0.4)(D, 2 * Fh)), 'w_sp': _w(0.01 * (lambda *s: torch.randn(*s, dtype=torch.bfloat16) * 0.4)(S, S)), 'b_sp': _w(1.0 + 0.01 * (lambda *s: torch.randn(*s, dtype=torch.bfloat16) * 0.05)(S)), 'w_out': _w((lambda *s: torch.randn(*s, dtype=torch.bfloat16) * 0.05)(Fh, D))}
    _B_in = _B_setup()
    return {'A_x': _A_in['x'], 'A_wqkv': _A_in['wqkv'], 'A_wo': _A_in['wo'], 'B_x': _B_in['x'], 'B_w_in': _B_in['w_in'], 'B_w_sp': _B_in['w_sp'], 'B_b_sp': _B_in['b_sp'], 'B_w_out': _B_in['w_out']}

def reference(A_x, A_wqkv, A_wo, B_x, B_w_in, B_w_sp, B_b_sp, B_w_out):

    def _A_ref(x, wqkv, wo):
        B, S, D = x.shape
        H = 32
        Dh = D // H
        W, dil = (8, 2)
        qkv = (lambda x, *d: x.permute(*d))((x @ wqkv).reshape(B, S, 3, H, Dh), 2, 0, 3, 1, 4)
        q, k, v = (qkv[0], qkv[1], qkv[2])
        scale = Dh ** (-0.5)
        pos = torch.arange(S)
        off = torch.arange(W) * dil
        idx = pos[:, None] - off[None, :]
        mask = idx >= 0
        idx_c = torch.where(mask, idx, 0).reshape(-1)
        kg = k[:, :, idx_c, :].reshape(B, H, S, W, Dh)
        vg = v[:, :, idx_c, :].reshape(B, H, S, W, Dh)
        logits = torch.einsum('bhsd,bhswd->bhsw', q, kg) * scale
        logits = torch.where(mask[None, None, :, :], logits, -1000000000.0)
        attn = _softmax(logits, axis=-1)
        o = torch.einsum('bhsw,bhswd->bhsd', attn, vg)
        return (lambda x, *d: x.permute(*d))(o, 0, 2, 1, 3).reshape(B, S, D) @ wo

    def _B_ref(x, w_in, w_sp, b_sp, w_out):
        B, S, D = x.shape
        F = w_in.shape[-1]
        Fh = F // 2
        z = _gelu(torch.einsum('bsd,df->bsf', x, w_in))
        z1 = z[..., :Fh].clone()
        z2 = _layernorm(z[..., Fh:], axis=-1)
        g = torch.einsum('ts,bsf->btf', w_sp, z2) + b_sp[None, :, None]
        return torch.einsum('bsf,fd->bsd', z1 * g, w_out)
    x = A_x
    xn = _layernorm(x, axis=-1)
    return x + _A_ref(xn, A_wqkv, A_wo) + _B_ref(xn, B_w_in, B_w_sp, B_b_sp, B_w_out)
```

```asm
; @launch grid=(256,1,1) block=(512,1,1) lds=163840
.amdgcn_target "amdgcn-amd-amdhsa--gfx950"
.text
.globl parallel_sum__sliding_local_dilated__mixer_gmlp__prompt_kernel
.p2align 8
.type parallel_sum__sliding_local_dilated__mixer_gmlp__prompt_kernel,@function
parallel_sum__sliding_local_dilated__mixer_gmlp__prompt_kernel:
s_memrealtime s[84:85]
s_cmp_ge_u32 s2, 256
s_cbranch_scc1 LF_end
s_load_dwordx16 s[64:79], s[0:1], 0
s_load_dwordx4 s[88:91], s[0:1], 64
s_load_dwordx2 s[92:93], s[0:1], 80
s_getpc_b64 s[62:63]
LF_pc:
s_lshr_b32 s61, s2, 3
s_mul_i32 s61, s61, ((LF_end - LF_pc) >> 12) + 1
v_add_u32 v3, s61, v0
v_lshlrev_b32_e64 v3, 7, v3
v_min_u32 v3, LF_end - LF_pc, v3
s_mov_b32 m0, 163072
v_cmp_gt_u32 vcc, ((LF_end - LF_pc) >> 12) + 1, v0
s_and_saveexec_b64 s[60:61], vcc
s_cbranch_execz LF_npf
global_load_lds_dword v3, s[62:63]
LF_npf:
s_mov_b64 exec, -1
v_lshrrev_b32 v3, 6, v0
v_and_b32 v1, 63, v0
v_mov_b32 v2, 0
v_readfirstlane_b32 s3, v3
s_and_b32 s53, s2, 7
s_lshr_b32 s54, s2, 3
s_lshr_b32 s55, s53, 1
s_and_b32 s56, s54, 3
s_lshr_b32 s50, s54, 2
s_lshl_b32 s6, s55, 2
s_add_u32 s6, s6, s56
s_and_b32 s48, s53, 1
s_lshl_b32 s49, s53, 2
s_add_u32 s49, s49, s56
s_lshl_b32 s7, s48, 2
s_and_b32 s58, s50, 3
s_add_u32 s7, s7, s58
s_lshr_b32 s45, s50, 2
s_xor_b32 s45, s45, 1
s_lshl_b32 s44, s56, 1
s_add_u32 s44, s44, s50
s_add_u32 s44, s44, s55
s_and_b32 s44, s44, 7
s_xor_b32 s58, s45, 1
s_lshl_b32 s58, s58, 2
s_xor_b32 s50, s7, s58
s_lshl_b32 s51, s50, 1
s_add_u32 s51, s51, s45
s_lshl_b32 s51, s51, 1
s_add_u32 s51, s51, s6
s_and_b32 s51, s51, 15
s_and_b32 s4, s3, 3
s_cmp_lt_u32 s3, 4
s_cbranch_scc1 LF_c
s_cmp_lg_u32 s45, 0
s_cbranch_scc1 LF_hz
v_lshrrev_b32 v3, 3, v1
v_lshlrev_b32 v3, 11, v3
v_lshrrev_b32 v30, 4, v1
v_and_b32 v31, 7, v1
v_xor_b32 v30, v30, v31
v_lshl_add_u32 v4, v30, 4, v3
v_xor_b32_e64 v30, 4, v30
v_lshl_add_u32 v5, v30, 4, v3
v_add_u32 v5, 15360, v5
v_bfe_u32 v3, v1, 4, 1
v_lshlrev_b32 v3, 1, v3
v_and_b32 v30, 7, v1
v_xor_b32 v30, v30, v3
v_lshrrev_b32 v3, 3, v1
v_mul_u32_u24 v3, 3072, v3
v_lshl_add_u32 v6, v30, 4, v3
v_xor_b32_e64 v30, 4, v30
v_lshl_add_u32 v7, v30, 4, v3
v_add_u32 v7, 24576, v7
v_lshrrev_b32 v3, 4, v1
s_lshl_b32 s61, s4, 1
v_add_u32 v3, s61, v3
v_and_b32 v30, 7, v1
v_xor_b32 v30, v30, v3
v_and_b32 v30, 7, v30
v_lshrrev_b32 v3, 3, v1
v_lshlrev_b32 v3, 10, v3
v_lshl_add_u32 v20, v30, 4, v3
s_lshl_b32 s53, s6, 7
s_sub_u32 s55, s53, 16
s_max_i32 s55, s55, 0
s_lshl_b32 s61, s4, 2
s_add_u32 s55, s55, s61
s_lshl_b32 s55, s55, 10
s_lshl_b32 s61, s4, 5
s_add_u32 s53, s53, s61
s_lshl_b32 s53, s53, 10
s_mul_i32 s54, s4, 49152
s_lshl_b32 s61, s7, 7
s_add_u32 s54, s54, s61
s_mul_i32 s56, s4, 6144
s_lshl_b32 s57, s4, 9
s_lshl_b32 s60, s4, 12
s_waitcnt lgkmcnt(0)
s_mov_b32 s8, s64
s_and_b32 s9, s65, 0xffff
s_mov_b32 s10, 0x200000
s_mov_b32 s11, 0x20000
s_mov_b32 s12, s66
s_and_b32 s13, s67, 0xffff
s_mov_b32 s14, 0x180000
s_mov_b32 s15, 0x20000
s_add_u32 s61, s44, 0
s_and_b32 s61, s61, 7
s_lshl_b32 s58, s61, 7
s_add_u32 s62, s58, s53
s_add_u32 m0, s60, 86016
s_add_u32 s63, s62, 1024
buffer_load_dwordx4 v4, s[8:11], s62 offen lds
buffer_load_dwordx4 v5, s[8:11], s62 offen offset:1024 lds
s_add_u32 m0, s60, 88064
s_nop 0
buffer_load_dwordx4 v4, s[8:11], s63 offen lds
buffer_load_dwordx4 v5, s[8:11], s63 offen offset:1024 lds
s_mul_i32 s63, s61, 196608
s_add_u32 s63, s63, s54
s_add_u32 m0, s56, 104448
s_add_u32 s62, s58, s55
buffer_load_dwordx4 v6, s[12:15], s63 offen offset:0 lds
buffer_load_dwordx4 v6, s[12:15], s63 offen offset:1024 lds
buffer_load_dwordx4 v6, s[12:15], s63 offen offset:2048 lds
s_add_u32 m0, s56, 107520
s_nop 0
buffer_load_dwordx4 v7, s[12:15], s63 offen offset:0 lds
buffer_load_dwordx4 v7, s[12:15], s63 offen offset:1024 lds
buffer_load_dwordx4 v7, s[12:15], s63 offen offset:2048 lds
s_add_u32 m0, s57, 102400
s_mov_b32 exec_hi, 0
buffer_load_dwordx4 v20, s[8:11], s62 offen lds
s_mov_b32 exec_hi, -1
s_add_u32 s61, s44, 1
s_and_b32 s61, s61, 7
s_lshl_b32 s58, s61, 7
s_add_u32 s62, s58, s53
s_add_u32 m0, s60, 43008
s_add_u32 s63, s62, 1024
buffer_load_dwordx4 v4, s[8:11], s62 offen lds
buffer_load_dwordx4 v5, s[8:11], s62 offen offset:1024 lds
s_add_u32 m0, s60, 45056
s_nop 0
buffer_load_dwordx4 v4, s[8:11], s63 offen lds
buffer_load_dwordx4 v5, s[8:11], s63 offen offset:1024 lds
s_mul_i32 s63, s61, 196608
s_add_u32 s63, s63, s54
s_add_u32 m0, s56, 61440
s_add_u32 s62, s58, s55
buffer_load_dwordx4 v6, s[12:15], s63 offen offset:0 lds
buffer_load_dwordx4 v6, s[12:15], s63 offen offset:1024 lds
buffer_load_dwordx4 v6, s[12:15], s63 offen offset:2048 lds
s_add_u32 m0, s56, 64512
s_nop 0
buffer_load_dwordx4 v7, s[12:15], s63 offen offset:0 lds
buffer_load_dwordx4 v7, s[12:15], s63 offen offset:1024 lds
buffer_load_dwordx4 v7, s[12:15], s63 offen offset:2048 lds
s_add_u32 m0, s57, 59392
s_mov_b32 exec_hi, 0
buffer_load_dwordx4 v20, s[8:11], s62 offen lds
s_mov_b32 exec_hi, -1
s_branch LF_hq1
LF_hz:
v_lshrrev_b32 v3, 3, v1
v_lshlrev_b32 v3, 11, v3
v_lshrrev_b32 v30, 4, v1
v_and_b32 v31, 7, v1
v_xor_b32 v30, v30, v31
v_lshl_add_u32 v4, v30, 4, v3
v_xor_b32_e64 v30, 4, v30
v_lshl_add_u32 v5, v30, 4, v3
v_add_u32 v5, 15360, v5
s_mul_i32 s55, s7, 6
s_add_u32 s57, s55, 5
s_min_u32 s57, s57, 43
s_sub_u32 s55, s55, 1
s_max_i32 s55, s55, 0
s_sub_u32 s57, s57, s55
s_lshl_b32 s57, s57, 1
v_add_u32 v3, 0, v1
v_mul_u32_u24 v30, 683, v3
v_lshrrev_b32 v30, 13, v30
v_mul_u32_u24 v31, 12, v30
v_sub_u32 v31, v3, v31
v_lshrrev_b32 v3, 2, v30
v_and_b32 v3, 2, v3
v_xor_b32_e64 v31, v3, v31
v_cmp_le_u32 vcc, s57, v31
v_mul_u32_u24 v30, 2752, v30
v_lshl_add_u32 v20, v31, 4, v30
v_cndmask_b32_e64 v3, 0, 1, vcc
v_lshl_add_u32 v23, v3, 28, v20
v_add_u32_e64 v3, 64, v1
v_mul_u32_u24 v30, 683, v3
v_lshrrev_b32 v30, 13, v30
v_mul_u32_u24 v31, 12, v30
v_sub_u32 v31, v3, v31
v_lshrrev_b32 v3, 2, v30
v_and_b32 v3, 2, v3
v_xor_b32_e64 v31, v3, v31
v_cmp_le_u32 vcc, s57, v31
v_mul_u32_u24 v30, 2752, v30
v_lshl_add_u32 v21, v31, 4, v30
v_cndmask_b32_e64 v3, 0, 1, vcc
v_subrev_u32 v21, 1024, v21
v_lshl_add_u32 v24, v3, 28, v21
v_add_u32 v3, 128, v1
v_mul_u32_u24 v30, 683, v3
v_lshrrev_b32 v30, 13, v30
v_mul_u32_u24 v31, 12, v30
v_sub_u32 v31, v3, v31
v_lshrrev_b32 v3, 2, v30
v_and_b32 v3, 2, v3
v_xor_b32_e64 v31, v3, v31
v_cmp_le_u32 vcc, s57, v31
v_mul_u32_u24 v30, 2752, v30
v_lshl_add_u32 v22, v31, 4, v30
v_cndmask_b32_e64 v3, 0, 1, vcc
v_subrev_u32 v22, 2048, v22
v_lshl_add_u32 v25, v3, 28, v22
s_lshl_b32 s53, s6, 2
s_add_u32 s53, s53, s4
s_lshl_b32 s53, s53, 15
s_mul_i32 s54, s4, 44032
s_lshl_b32 s61, s55, 5
s_add_u32 s54, s54, s61
s_add_u32 s54, s54, 1376
s_mul_i32 s56, s4, 3072
s_lshl_b32 s60, s4, 12
s_waitcnt lgkmcnt(0)
s_mov_b32 s8, s64
s_and_b32 s9, s65, 0xffff
s_mov_b32 s10, 0x200000
s_mov_b32 s11, 0x20000
s_mov_b32 s12, s72
s_and_b32 s13, s73, 0xffff
s_mov_b32 s14, 0x158000
s_mov_b32 s15, 0x20000
s_add_u32 s61, s44, 0
s_and_b32 s61, s61, 7
s_lshl_b32 s58, s61, 7
s_add_u32 s62, s58, s53
s_add_u32 m0, s60, 0
s_add_u32 s63, s62, 1024
buffer_load_dwordx4 v4, s[8:11], s62 offen lds
buffer_load_dwordx4 v5, s[8:11], s62 offen offset:1024 lds
s_add_u32 m0, s60, 2048
s_nop 0
buffer_load_dwordx4 v4, s[8:11], s63 offen lds
buffer_load_dwordx4 v5, s[8:11], s63 offen offset:1024 lds
s_mul_i32 s63, s61, 176128
s_add_u32 m0, s56, 16384
s_add_u32 s63, s63, s54
buffer_load_dwordx4 v23, s[12:15], s63 offen offset:0 lds
buffer_load_dwordx4 v24, s[12:15], s63 offen offset:1024 lds
buffer_load_dwordx4 v25, s[12:15], s63 offen offset:2048 lds
s_add_u32 s61, s44, 1
s_and_b32 s61, s61, 7
s_lshl_b32 s58, s61, 7
s_add_u32 s62, s58, s53
s_add_u32 m0, s60, 28672
s_add_u32 s63, s62, 1024
buffer_load_dwordx4 v4, s[8:11], s62 offen lds
buffer_load_dwordx4 v5, s[8:11], s62 offen offset:1024 lds
s_add_u32 m0, s60, 30720
s_nop 0
buffer_load_dwordx4 v4, s[8:11], s63 offen lds
buffer_load_dwordx4 v5, s[8:11], s63 offen offset:1024 lds
s_mul_i32 s63, s61, 176128
s_add_u32 m0, s56, 45056
s_add_u32 s63, s63, s54
buffer_load_dwordx4 v23, s[12:15], s63 offen offset:0 lds
buffer_load_dwordx4 v24, s[12:15], s63 offen offset:1024 lds
buffer_load_dwordx4 v25, s[12:15], s63 offen offset:2048 lds
s_branch LF_hz1
LF_c:
s_waitcnt lgkmcnt(0)
s_mov_b32 s8, s64
s_and_b32 s9, s65, 0xffff
s_mov_b32 s10, 0x200000
s_mov_b32 s11, 0x20000
s_mov_b32 s16, s92
s_and_b32 s17, s93, 0xffff
s_mov_b32 s18, 0x10000000
s_mov_b32 s19, 0x20000
s_mov_b32 s40, s90
s_and_b32 s41, s91, 0xffff
s_mov_b32 s42, 0x100
s_mov_b32 s43, 0x20000
s_mov_b32 s20, s74
s_and_b32 s21, s75, 0xffff
s_mov_b32 s22, 0x800000
s_mov_b32 s23, 0x20000
s_mov_b32 s24, s68
s_and_b32 s25, s69, 0xffff
s_mov_b32 s26, 0x80000
s_mov_b32 s27, 0x20000
s_mov_b32 s28, s78
s_and_b32 s29, s79, 0xffff
s_mov_b32 s30, 0xac000
s_mov_b32 s31, 0x20000
s_mov_b32 s32, s88
s_and_b32 s33, s89, 0xffff
s_mov_b32 s34, 0x200000
s_mov_b32 s35, 0x20000
s_mov_b32 s36, s76
s_and_b32 s37, s77, 0xffff
s_mov_b32 s38, 0x1000
s_mov_b32 s39, 0x20000
s_or_b32 s61, s2, s3
s_cmp_lg_u32 s61, 0
s_cbranch_scc1 Lnn_32
s_or_b32 s62, s84, 1
v_mov_b32 v30, s62
v_lshlrev_b32_e64 v31, 6, v1
s_mov_b64 exec, 15
buffer_store_dword v30, v31, s[40:43], 0 offen sc1
s_mov_b64 exec, -1
Lnn_32:
s_lshl_b32 s61, s6, 1
s_add_u32 s61, s61, s45
s_lshl_b32 s61, s61, 3
s_add_u32 s61, s61, s7
s_lshl_b32 s61, s61, 2
s_add_u32 s47, s61, s4
s_lshl_b32 s61, s47, 11
v_lshrrev_b32 v3, 5, v1
v_lshlrev_b32 v3, 10, v3
v_and_b32_e64 v30, 31, v1
v_lshl_add_u32 v3, v30, 4, v3
buffer_load_dwordx4 v[40:43], v3, s[8:11], s61 offen
buffer_load_dwordx4 v[44:47], v3, s[8:11], s61 offen offset:512
v_and_b32_e64 v3, 15, v1
v_bfe_u32 v31, v1, 4, 1
v_lshl_add_u32 v3, v3, 1, v31
v_lshlrev_b32_e64 v3, 1, v3
s_lshl_b32 s61, s6, 2
s_add_u32 s61, s61, s4
s_lshl_b32 s61, s61, 6
s_cmp_eq_u32 s48, 0
s_cselect_b32 s61, s61, 4096
buffer_load_ushort v0, v3, s[36:39], s61 offen
s_cmp_lg_u32 s45, 0
s_cbranch_scc1 LF_cz
s_lshr_b32 s5, s4, 1
s_and_b32 s46, s4, 1
s_lshl_b32 s61, s5, 13
v_and_b32 v3, 15, v1
v_lshrrev_b32 v30, 4, v1
v_lshrrev_b32 v31, 1, v3
v_xor_b32 v30, v30, v31
v_lshlrev_b32 v3, 7, v3
v_add_u32_e64 v3, s61, v3
v_lshl_add_u32 v10, v30, 4, v3
v_xor_b32_e64 v30, 4, v30
v_lshl_add_u32 v11, v30, 4, v3
v_and_b32 v3, 15, v1
v_lshrrev_b32 v30, 4, v1
v_lshrrev_b32 v31, 1, v3
v_xor_b32 v30, v30, v31
v_lshlrev_b32_e64 v3, 7, v3
v_add_u32 v3, 16384, v3
v_lshl_add_u32 v12, v30, 4, v3
v_xor_b32_e64 v30, 4, v30
v_lshl_add_u32 v13, v30, 4, v3
v_lshrrev_b32_e64 v3, 4, v1
v_mul_u32_u24 v30, 3072, v3
v_bfe_u32 v31, v1, 2, 2
v_lshl_add_u32 v30, v31, 7, v30
v_and_b32_e64 v14, 3, v1
v_lshl_add_u32 v30, v14, 3, v30
v_lshrrev_b32 v31, 1, v31
v_and_b32 v3, 1, v3
v_lshl_or_b32 v31, v3, 1, v31
v_lshl_add_u32 v14, v31, 5, v30
v_add_u32 v14, 18432, v14
s_lshl_b32 s61, s46, 6
v_xor_b32 v14, s61, v14
v_xor_b32 v15, 32, v14
v_and_b32 v3, 15, v1
v_lshrrev_b32 v30, 4, v1
v_lshlrev_b32 v30, 2, v30
v_sub_u32_e64 v31, v3, v30
v_mov_b32 v224, 0xf149f2ca
v_mov_b32 v225, 0xffff
v_mov_b32 v226, 0xffff0000
v_subrev_u32 v227, 0, v31
v_cmp_gt_u32 vcc, 8, v227
v_cmp_gt_i32 s[62:63], -8, v227
s_nop 0
v_cndmask_b32_e64 v200, v224, 0, vcc
v_cndmask_b32_e64 v228, 0, v225, vcc
v_cndmask_b32_e64 v204, v224, 0, s[62:63]
v_subrev_u32_e64 v227, 1, v31
v_cmp_gt_u32 vcc, 8, v227
v_cmp_gt_i32 s[62:63], -8, v227
s_nop 0
v_cndmask_b32_e64 v201, v224, 0, vcc
v_cndmask_b32_e64 v229, 0, v226, vcc
v_cndmask_b32_e64 v205, v224, 0, s[62:63]
v_subrev_u32_e64 v227, 2, v31
v_cmp_gt_u32 vcc, 8, v227
v_cmp_gt_i32 s[62:63], -8, v227
s_nop 0
v_cndmask_b32_e64 v202, v224, 0, vcc
v_cndmask_b32_e64 v230, 0, v225, vcc
v_cndmask_b32_e64 v206, v224, 0, s[62:63]
v_subrev_u32_e64 v227, 3, v31
v_cmp_gt_u32 vcc, 8, v227
v_cmp_gt_i32 s[62:63], -8, v227
s_nop 0
v_cndmask_b32_e64 v203, v224, 0, vcc
v_cndmask_b32_e64 v231, 0, v226, vcc
v_cndmask_b32_e64 v207, v224, 0, s[62:63]
v_or_b32 v216, v228, v229
v_or_b32 v217, v230, v231
s_lshl_b32 s61, s5, 8
s_add_u32 s61, s61, 159744
v_and_b32 v27, 0x30, v1
v_add_u32 v218, s61, v27
v_lshl_add_u32 v219, v3, 2, s61
s_lshl_b32 s61, s46, 7
s_add_u32 s61, s61, 162304
v_add_u32 v220, s61, v27
v_lshl_add_u32 v221, v3, 2, s61
v_lshlrev_b32 v222, 4, v1
s_lshl_b32 s61, s46, 12
s_add_u32 s61, s61, 151552
v_add_u32 v223, s61, v222
s_lshl_b32 s53, s6, 1
s_add_u32 s53, s53, s5
s_lshl_b32 s53, s53, 4
s_add_u32 s53, s53, s7
s_lshl_b32 s53, s53, 1
s_add_u32 s53, s53, s46
s_lshl_b32 s53, s53, 11
s_add_u32 s53, s53, 16777216
s_add_u32 s54, s53, 32768
v_lshrrev_b32 v27, 4, v1
v_lshlrev_b32 v27, 9, v27
v_lshl_add_u32 v4, v3, 4, v27
s_lshl_b32 s61, s4, 2
s_add_u32 s61, s61, 163328
v_mov_b32 v7, s61
v_xor_b32 v8, 8, v7
s_lshl_b32 s61, s46, 2
s_add_u32 s61, s61, 163344
v_mov_b32 v9, s61
v_mov_b32 v27, 0
ds_write_b32 v7, v27
ds_write_b32 v9, v27
v_mov_b32 v26, v30
v_mov_b32 v27, v3
v_lshrrev_b32 v31, 4, v1
v_lshlrev_b32 v31, 12, v31
v_and_b32_e64 v30, 15, v1
v_lshl_add_u32 v5, v30, 7, v31
v_lshlrev_b32 v6, 7, v1
s_lshl_b32 s68, s6, 3
s_add_u32 s68, s68, s50
s_lshl_b32 s68, s68, 2
s_add_u32 s68, s68, s4
s_lshl_b32 s68, s68, 14
s_lshl_b32 s61, s48, 11
s_add_u32 s68, s68, s61
s_lshr_b32 s61, s2, 3
s_lshl_b32 s61, s61, 2
s_add_u32 s61, s61, s4
s_lshl_b32 s69, s61, 12
s_mul_i32 s70, s61, 5504
s_mov_b32 m0, 163072
v_mov_b32_e64 v27, v3
v_mov_b32 v48, 0x3f803f80
v_mov_b32 v32, 0
v_mov_b32 v33, 0
v_mov_b32 v34, 0
v_mov_b32_e64 v35, 0
s_lshl_b32 s47, s47, 5
s_add_u32 s47, s47, 21495808
v_lshrrev_b32 v3, 1, v1
s_waitcnt vmcnt(1)
v_dot2_f32_bf16 v32, v40, v48, v32
v_dot2_f32_bf16 v34, v40, v40, v34
v_dot2_f32_bf16 v33, v41, v48, v33
v_dot2_f32_bf16 v35, v41, v41, v35
v_dot2_f32_bf16 v32, v42, v48, v32
v_dot2_f32_bf16 v34, v42, v42, v34
v_dot2_f32_bf16 v33, v43, v48, v33
v_dot2_f32_bf16 v35, v43, v43, v35
v_dot2_f32_bf16 v32, v44, v48, v32
v_dot2_f32_bf16 v34, v44, v44, v34
v_dot2_f32_bf16 v33, v45, v48, v33
v_dot2_f32_bf16 v35, v45, v45, v35
v_dot2_f32_bf16 v32, v46, v48, v32
v_dot2_f32_bf16 v34, v46, v46, v34
v_dot2_f32_bf16 v33, v47, v48, v33
v_dot2_f32_bf16 v35, v47, v47, v35
s_nop 2
v_add_f32 v32, v32, v33
v_add_f32 v34, v34, v35
s_nop 0
v_add_f32_dpp v32, v32, v32 row_ror:8 row_mask:0xf bank_mask:0xf
v_add_f32_dpp v34, v34, v34 row_ror:8 row_mask:0xf bank_mask:0xf
s_nop 0
v_add_f32_dpp v32, v32, v32 row_ror:4 row_mask:0xf bank_mask:0xf
v_add_f32_dpp v34, v34, v34 row_ror:4 row_mask:0xf bank_mask:0xf
s_nop 0
v_add_f32_dpp v32, v32, v32 row_ror:2 row_mask:0xf bank_mask:0xf
v_add_f32_dpp v34, v34, v34 row_ror:2 row_mask:0xf bank_mask:0xf
s_nop 0
v_add_f32_dpp v32, v32, v32 row_ror:1 row_mask:0xf bank_mask:0xf
v_add_f32_dpp v34, v34, v34 row_ror:1 row_mask:0xf bank_mask:0xf
v_mov_b32 v33, v32
v_mov_b32 v35, v34
s_nop 1
v_permlane16_swap_b32 v32, v33
v_permlane16_swap_b32 v34, v35
v_add_f32 v32, v32, v33
v_add_f32 v34, v34, v35
v_mul_f32 v32, 0x3b000000, v32
v_mul_f32 v34, 0x3b000000, v34
v_fma_f32 v34, -v32, v32, v34
v_max_f32_e64 v34, 0, v34
v_add_f32 v34, 0x3727c5ac, v34
s_load_dword s52, s[90:91], 64
s_waitcnt lgkmcnt(0)
s_cmp_lg_u32 s52, 0
s_cbranch_scc1 Lok_34
s_mov_b32 s63, 0
Lspin_33:
s_sleep 2
v_mov_b32 v31, 0
buffer_load_dword v30, v31, s[40:43], 0 offen sc1
s_waitcnt vmcnt(0)
s_add_u32 s63, s63, 1
s_cmp_gt_u32 s63, 32768
s_cbranch_scc1 Lok_34
v_readfirstlane_b32 s52, v30
s_cmp_lg_u32 s52, 0
s_cbranch_scc0 Lspin_33
Lok_34:
v_mov_b32 v33, s52
v_mov_b32 v35, s52
s_mov_b32 exec_lo, 1
s_mov_b32 exec_hi, 1
buffer_store_dwordx4 v[32:35], v3, s[16:19], s47 offen sc1
s_mov_b64 exec, -1
v_mov_b32 v3, v27
v_mov_b32 v30, v26
s_cmp_lg_u32 s5, 0
s_cbranch_scc1 Lrh1_35
v_lshlrev_b32 v3, 1, v3
v_sub_u32 v31, v30, v3
s_cmp_eq_u32 s6, 0
s_cselect_b32 s61, 1000, 0
v_subrev_u32_e64 v31, s61, v31
v_cmp_le_i32 vcc, 2, v31
s_nop 1
v_cndmask_b32_e64 v208, v224, 0, vcc
v_mov_b32_e64 v209, v224
v_cmp_le_i32 vcc, 0, v31
s_nop 1
v_cndmask_b32_e64 v210, v224, 0, vcc
v_mov_b32 v211, v224
v_mov_b32 v212, v224
v_cmp_le_i32 vcc, 2, v31
s_nop 1
v_cndmask_b32_e64 v213, v224, 0, vcc
v_mov_b32_e64 v214, v224
v_cmp_le_i32 vcc, 0, v31
s_nop 1
v_cndmask_b32_e64 v215, v224, 0, vcc
v_mov_b32 v28, 0x3f803f80
v_mov_b32 v29, 0x3f803f80
v_mov_b32 v30, 0x3f803f80
v_mov_b32 v31, 0x3f803f80
v_add_u32 v16, 86016, v10
v_add_u32 v17, 86016, v11
v_add_u32 v18, 86016, v12
v_add_u32 v19, 86016, v13
v_add_u32 v20, 86016, v14
v_add_u32 v21, 86016, v15
s_waitcnt lgkmcnt(0)
s_barrier
ds_read_b64_tr_b16 v[144:145], v20 offset:0
ds_read_b64_tr_b16 v[146:147], v20 offset:512
ds_read_b128 v[148:151], v16 offset:0
ds_read_b128 v[152:155], v16 offset:2048
ds_read_b128 v[156:159], v16 offset:4096
ds_read_b128 v[160:163], v16 offset:6144
ds_read_b64_tr_b16 v[164:165], v21 offset:0
ds_read_b64_tr_b16 v[166:167], v21 offset:512
ds_read_b64_tr_b16 v[168:169], v20 offset:1024
ds_read_b64_tr_b16 v[170:171], v20 offset:1536
s_waitcnt lgkmcnt(7)
v_mfma_f32_16x16x32_bf16 v[32:35], v[144:147], v[148:151], 0
s_waitcnt lgkmcnt(6)
v_mfma_f32_16x16x32_bf16 v[36:39], v[144:147], v[152:155], 0
s_waitcnt lgkmcnt(5)
v_mfma_f32_16x16x32_bf16 v[40:43], v[144:147], v[156:159], 0
ds_read_b128 v[172:175], v18
s_waitcnt lgkmcnt(5)
v_mfma_f32_16x16x32_bf16 v[44:47], v[144:147], v[160:163], 0
ds_read_b64_tr_b16 v[176:177], v21 offset:1024
v_mfma_f32_16x16x32_bf16 v[240:243], v[28:31], v[144:147], 0
ds_read_b64_tr_b16 v[178:179], v21 offset:1536
s_waitcnt lgkmcnt(5)
v_mfma_f32_16x16x32_bf16 v[48:51], v[164:167], v[148:151], 0
v_mfma_f32_16x16x32_bf16 v[52:55], v[164:167], v[152:155], 0
v_mfma_f32_16x16x32_bf16 v[56:59], v[164:167], v[156:159], 0
v_mfma_f32_16x16x32_bf16 v[60:63], v[164:167], v[160:163], 0
ds_read_b64_tr_b16 v[180:181], v20 offset:2048
s_waitcnt lgkmcnt(4)
v_mfma_f32_16x16x32_bf16 v[64:67], v[168:171], v[148:151], 0
ds_read_b64_tr_b16 v[182:183], v20 offset:2560
v_mfma_f32_16x16x32_bf16 v[68:71], v[168:171], v[152:155], 0
v_mfma_f32_16x16x32_bf16 v[72:75], v[168:171], v[156:159], 0
v_mfma_f32_16x16x32_bf16 v[76:79], v[168:171], v[160:163], 0
s_waitcnt lgkmcnt(4)
v_mfma_f32_16x16x32_bf16 v[128:131], v[168:171], v[172:175], 0
ds_read_b64_tr_b16 v[184:185], v21 offset:2048
s_waitcnt lgkmcnt(3)
v_mfma_f32_16x16x32_bf16 v[80:83], v[176:179], v[148:151], 0
ds_read_b64_tr_b16 v[186:187], v21 offset:2560
v_mfma_f32_16x16x32_bf16 v[84:87], v[176:179], v[152:155], 0
v_mfma_f32_16x16x32_bf16 v[88:91], v[176:179], v[156:159], 0
v_mfma_f32_16x16x32_bf16 v[92:95], v[176:179], v[160:163], 0
v_mfma_f32_16x16x32_bf16 v[132:135], v[176:179], v[172:175], 0
ds_read_b64_tr_b16 v[188:189], v20 offset:12288
s_waitcnt lgkmcnt(3)
v_mfma_f32_16x16x32_bf16 v[96:99], v[148:151], v[180:183], 0
ds_read_b64_tr_b16 v[190:191], v20 offset:12800
v_mfma_f32_16x16x32_bf16 v[100:103], v[152:155], v[180:183], 0
ds_read_b128 v[192:195], v17 offset:0
v_mfma_f32_16x16x32_bf16 v[104:107], v[156:159], v[180:183], 0
ds_read_b128 v[196:199], v17 offset:2048
v_mfma_f32_16x16x32_bf16 v[108:111], v[160:163], v[180:183], 0
ds_read_b128 v[144:147], v17 offset:4096
v_mfma_f32_16x16x32_bf16 v[136:139], v[172:175], v[180:183], 0
ds_read_b128 v[164:167], v17 offset:6144
s_waitcnt lgkmcnt(6)
v_mfma_f32_16x16x32_bf16 v[112:115], v[148:151], v[184:187], 0
ds_read_b64_tr_b16 v[168:169], v21 offset:12288
v_mfma_f32_16x16x32_bf16 v[116:119], v[152:155], v[184:187], 0
ds_read_b64_tr_b16 v[170:171], v21 offset:12800
v_mfma_f32_16x16x32_bf16 v[120:123], v[156:159], v[184:187], 0
v_mfma_f32_16x16x32_bf16 v[124:127], v[160:163], v[184:187], 0
ds_read_b64_tr_b16 v[176:177], v20 offset:13312
v_mfma_f32_16x16x32_bf16 v[140:143], v[172:175], v[184:187], 0
ds_read_b64_tr_b16 v[178:179], v20 offset:13824
s_waitcnt lgkmcnt(7)
v_mfma_f32_16x16x32_bf16 v[32:35], v[188:191], v[192:195], v[32:35]
s_waitcnt lgkmcnt(6)
v_mfma_f32_16x16x32_bf16 v[36:39], v[188:191], v[196:199], v[36:39]
s_waitcnt lgkmcnt(5)
v_mfma_f32_16x16x32_bf16 v[40:43], v[188:191], v[144:147], v[40:43]
ds_read_b128 v[180:183], v19
s_waitcnt lgkmcnt(5)
v_mfma_f32_16x16x32_bf16 v[44:47], v[188:191], v[164:167], v[44:47]
ds_read_b64_tr_b16 v[148:149], v21 offset:13312
v_mfma_f32_16x16x32_bf16 v[240:243], v[28:31], v[188:191], v[240:243]
ds_read_b64_tr_b16 v[150:151], v21 offset:13824
s_waitcnt lgkmcnt(5)
v_mfma_f32_16x16x32_bf16 v[48:51], v[168:171], v[192:195], v[48:51]
v_mfma_f32_16x16x32_bf16 v[52:55], v[168:171], v[196:199], v[52:55]
v_mfma_f32_16x16x32_bf16 v[56:59], v[168:171], v[144:147], v[56:59]
v_mfma_f32_16x16x32_bf16 v[60:63], v[168:171], v[164:167], v[60:63]
ds_read_b64_tr_b16 v[152:153], v20 offset:14336
s_waitcnt lgkmcnt(4)
v_mfma_f32_16x16x32_bf16 v[64:67], v[176:179], v[192:195], v[64:67]
ds_read_b64_tr_b16 v[154:155], v20 offset:14848
v_mfma_f32_16x16x32_bf16 v[68:71], v[176:179], v[196:199], v[68:71]
v_mfma_f32_16x16x32_bf16 v[72:75], v[176:179], v[144:147], v[72:75]
v_mfma_f32_16x16x32_bf16 v[76:79], v[176:179], v[164:167], v[76:79]
s_waitcnt lgkmcnt(4)
v_mfma_f32_16x16x32_bf16 v[128:131], v[176:179], v[180:183], v[128:131]
ds_read_b64_tr_b16 v[156:157], v21 offset:14336
s_waitcnt lgkmcnt(3)
v_mfma_f32_16x16x32_bf16 v[80:83], v[148:151], v[192:195], v[80:83]
ds_read_b64_tr_b16 v[158:159], v21 offset:14848
v_mfma_f32_16x16x32_bf16 v[84:87], v[148:151], v[196:199], v[84:87]
v_mfma_f32_16x16x32_bf16 v[88:91], v[148:151], v[144:147], v[88:91]
v_mfma_f32_16x16x32_bf16 v[92:95], v[148:151], v[164:167], v[92:95]
v_mfma_f32_16x16x32_bf16 v[132:135], v[148:151], v[180:183], v[132:135]
v_add_u32 v16, 43008, v10
v_add_u32 v17, 43008, v11
v_add_u32 v18, 43008, v12
v_add_u32 v19, 43008, v13
v_add_u32 v20, 43008, v14
v_add_u32 v21, 43008, v15
s_waitcnt lgkmcnt(0)
s_barrier
ds_read_b64_tr_b16 v[160:161], v20 offset:0
v_mfma_f32_16x16x32_bf16 v[96:99], v[192:195], v[152:155], v[96:99]
ds_read_b64_tr_b16 v[162:163], v20 offset:512
v_mfma_f32_16x16x32_bf16 v[100:103], v[196:199], v[152:155], v[100:103]
ds_read_b128 v[172:175], v16 offset:0
v_mfma_f32_16x16x32_bf16 v[104:107], v[144:147], v[152:155], v[104:107]
ds_read_b128 v[184:187], v16 offset:2048
v_mfma_f32_16x16x32_bf16 v[108:111], v[164:167], v[152:155], v[108:111]
ds_read_b128 v[188:191], v16 offset:4096
v_mfma_f32_16x16x32_bf16 v[136:139], v[180:183], v[152:155], v[136:139]
ds_read_b128 v[168:171], v16 offset:6144
v_mfma_f32_16x16x32_bf16 v[112:115], v[192:195], v[156:159], v[112:115]
ds_read_b64_tr_b16 v[176:177], v21 offset:0
v_mfma_f32_16x16x32_bf16 v[116:119], v[196:199], v[156:159], v[116:119]
ds_read_b64_tr_b16 v[178:179], v21 offset:512
v_mfma_f32_16x16x32_bf16 v[120:123], v[144:147], v[156:159], v[120:123]
v_mfma_f32_16x16x32_bf16 v[124:127], v[164:167], v[156:159], v[124:127]
ds_read_b64_tr_b16 v[148:149], v20 offset:1024
v_mfma_f32_16x16x32_bf16 v[140:143], v[180:183], v[156:159], v[140:143]
ds_read_b64_tr_b16 v[150:151], v20 offset:1536
s_waitcnt lgkmcnt(7)
v_mfma_f32_16x16x32_bf16 v[32:35], v[160:163], v[172:175], v[32:35]
s_waitcnt lgkmcnt(6)
v_mfma_f32_16x16x32_bf16 v[36:39], v[160:163], v[184:187], v[36:39]
s_waitcnt lgkmcnt(5)
v_mfma_f32_16x16x32_bf16 v[40:43], v[160:163], v[188:191], v[40:43]
ds_read_b128 v[152:155], v18
s_waitcnt lgkmcnt(5)
v_mfma_f32_16x16x32_bf16 v[44:47], v[160:163], v[168:171], v[44:47]
ds_read_b64_tr_b16 v[192:193], v21 offset:1024
v_mfma_f32_16x16x32_bf16 v[240:243], v[28:31], v[160:163], v[240:243]
ds_read_b64_tr_b16 v[194:195], v21 offset:1536
s_waitcnt lgkmcnt(5)
v_mfma_f32_16x16x32_bf16 v[48:51], v[176:179], v[172:175], v[48:51]
v_mfma_f32_16x16x32_bf16 v[52:55], v[176:179], v[184:187], v[52:55]
v_mfma_f32_16x16x32_bf16 v[56:59], v[176:179], v[188:191], v[56:59]
v_mfma_f32_16x16x32_bf16 v[60:63], v[176:179], v[168:171], v[60:63]
ds_read_b64_tr_b16 v[196:197], v20 offset:2048
s_waitcnt lgkmcnt(4)
v_mfma_f32_16x16x32_bf16 v[64:67], v[148:151], v[172:175], v[64:67]
ds_read_b64_tr_b16 v[198:199], v20 offset:2560
v_mfma_f32_16x16x32_bf16 v[68:71], v[148:151], v[184:187], v[68:71]
v_mfma_f32_16x16x32_bf16 v[72:75], v[148:151], v[188:191], v[72:75]
v_mfma_f32_16x16x32_bf16 v[76:79], v[148:151], v[168:171], v[76:79]
s_waitcnt lgkmcnt(4)
v_mfma_f32_16x16x32_bf16 v[128:131], v[148:151], v[152:155], v[128:131]
ds_read_b64_tr_b16 v[144:145], v21 offset:2048
s_waitcnt lgkmcnt(3)
v_mfma_f32_16x16x32_bf16 v[80:83], v[192:195], v[172:175], v[80:83]
ds_read_b64_tr_b16 v[146:147], v21 offset:2560
v_mfma_f32_16x16x32_bf16 v[84:87], v[192:195], v[184:187], v[84:87]
v_mfma_f32_16x16x32_bf16 v[88:91], v[192:195], v[188:191], v[88:91]
v_mfma_f32_16x16x32_bf16 v[92:95], v[192:195], v[168:171], v[92:95]
v_mfma_f32_16x16x32_bf16 v[132:135], v[192:195], v[152:155], v[132:135]
ds_read_b64_tr_b16 v[164:165], v20 offset:12288
s_waitcnt lgkmcnt(3)
v_mfma_f32_16x16x32_bf16 v[96:99], v[172:175], v[196:199], v[96:99]
ds_read_b64_tr_b16 v[166:167], v20 offset:12800
v_mfma_f32_16x16x32_bf16 v[100:103], v[184:187], v[196:199], v[100:103]
ds_read_b128 v[156:159], v17 offset:0
v_mfma_f32_16x16x32_bf16 v[104:107], v[188:191], v[196:199], v[104:107]
ds_read_b128 v[180:183], v17 offset:2048
v_mfma_f32_16x16x32_bf16 v[108:111], v[168:171], v[196:199], v[108:111]
ds_read_b128 v[160:163], v17 offset:4096
v_mfma_f32_16x16x32_bf16 v[136:139], v[152:155], v[196:199], v[136:139]
ds_read_b128 v[176:179], v17 offset:6144
s_waitcnt lgkmcnt(6)
v_mfma_f32_16x16x32_bf16 v[112:115], v[172:175], v[144:147], v[112:115]
ds_read_b64_tr_b16 v[148:149], v21 offset:12288
v_mfma_f32_16x16x32_bf16 v[116:119], v[184:187], v[144:147], v[116:119]
ds_read_b64_tr_b16 v[150:151], v21 offset:12800
v_mfma_f32_16x16x32_bf16 v[120:123], v[188:191], v[144:147], v[120:123]
v_mfma_f32_16x16x32_bf16 v[124:127], v[168:171], v[144:147], v[124:127]
ds_read_b64_tr_b16 v[192:193], v20 offset:13312
v_mfma_f32_16x16x32_bf16 v[140:143], v[152:155], v[144:147], v[140:143]
ds_read_b64_tr_b16 v[194:195], v20 offset:13824
s_waitcnt lgkmcnt(7)
v_mfma_f32_16x16x32_bf16 v[32:35], v[164:167], v[156:159], v[32:35]
s_waitcnt lgkmcnt(6)
v_mfma_f32_16x16x32_bf16 v[36:39], v[164:167], v[180:183], v[36:39]
s_waitcnt lgkmcnt(5)
v_mfma_f32_16x16x32_bf16 v[40:43], v[164:167], v[160:163], v[40:43]
ds_read_b128 v[196:199], v19
s_waitcnt lgkmcnt(5)
v_mfma_f32_16x16x32_bf16 v[44:47], v[164:167], v[176:179], v[44:47]
ds_read_b64_tr_b16 v[172:173], v21 offset:13312
v_mfma_f32_16x16x32_bf16 v[240:243], v[28:31], v[164:167], v[240:243]
ds_read_b64_tr_b16 v[174:175], v21 offset:13824
s_waitcnt lgkmcnt(5)
v_mfma_f32_16x16x32_bf16 v[48:51], v[148:151], v[156:159], v[48:51]
v_mfma_f32_16x16x32_bf16 v[52:55], v[148:151], v[180:183], v[52:55]
v_mfma_f32_16x16x32_bf16 v[56:59], v[148:151], v[160:163], v[56:59]
v_mfma_f32_16x16x32_bf16 v[60:63], v[148:151], v[176:179], v[60:63]
ds_read_b64_tr_b16 v[184:185], v20 offset:14336
s_waitcnt lgkmcnt(4)
v_mfma_f32_16x16x32_bf16 v[64:67], v[192:195], v[156:159], v[64:67]
ds_read_b64_tr_b16 v[186:187], v20 offset:14848
v_mfma_f32_16x16x32_bf16 v[68:71], v[192:195], v[180:183], v[68:71]
v_mfma_f32_16x16x32_bf16 v[72:75], v[192:195], v[160:163], v[72:75]
v_mfma_f32_16x16x32_bf16 v[76:79], v[192:195], v[176:179], v[76:79]
s_waitcnt lgkmcnt(4)
v_mfma_f32_16x16x32_bf16 v[128:131], v[192:195], v[196:199], v[128:131]
ds_read_b64_tr_b16 v[188:189], v21 offset:14336
s_waitcnt lgkmcnt(3)
v_mfma_f32_16x16x32_bf16 v[80:83], v[172:175], v[156:159], v[80:83]
ds_read_b64_tr_b16 v[190:191], v21 offset:14848
v_mfma_f32_16x16x32_bf16 v[84:87], v[172:175], v[180:183], v[84:87]
v_mfma_f32_16x16x32_bf16 v[88:91], v[172:175], v[160:163], v[88:91]
v_mfma_f32_16x16x32_bf16 v[92:95], v[172:175], v[176:179], v[92:95]
v_mfma_f32_16x16x32_bf16 v[132:135], v[172:175], v[196:199], v[132:135]
v_add_u32 v16, 0, v10
v_add_u32 v17, 0, v11
v_add_u32 v18, 0, v12
v_add_u32 v19, 0, v13
v_add_u32 v20, 0, v14
v_add_u32 v21, 0, v15
s_waitcnt lgkmcnt(0)
s_barrier
ds_read_b64_tr_b16 v[168:169], v20 offset:0
v_mfma_f32_16x16x32_bf16 v[96:99], v[156:159], v[184:187], v[96:99]
ds_read_b64_tr_b16 v[170:171], v20 offset:512
v_mfma_f32_16x16x32_bf16 v[100:103], v[180:183], v[184:187], v[100:103]
ds_read_b128 v[144:147], v16 offset:0
v_mfma_f32_16x16x32_bf16 v[104:107], v[160:163], v[184:187], v[104:107]
ds_read_b128 v[152:155], v16 offset:2048
v_mfma_f32_16x16x32_bf16 v[108:111], v[176:179], v[184:187], v[108:111]
ds_read_b128 v[164:167], v16 offset:4096
v_mfma_f32_16x16x32_bf16 v[136:139], v[196:199], v[184:187], v[136:139]
ds_read_b128 v[148:151], v16 offset:6144
v_mfma_f32_16x16x32_bf16 v[112:115], v[156:159], v[188:191], v[112:115]
ds_read_b64_tr_b16 v[192:193], v21 offset:0
v_mfma_f32_16x16x32_bf16 v[116:119], v[180:183], v[188:191], v[116:119]
ds_read_b64_tr_b16 v[194:195], v21 offset:512
v_mfma_f32_16x16x32_bf16 v[120:123], v[160:163], v[188:191], v[120:123]
v_mfma_f32_16x16x32_bf16 v[124:127], v[176:179], v[188:191], v[124:127]
ds_read_b64_tr_b16 v[172:173], v20 offset:1024
v_mfma_f32_16x16x32_bf16 v[140:143], v[196:199], v[188:191], v[140:143]
ds_read_b64_tr_b16 v[174:175], v20 offset:1536
s_waitcnt lgkmcnt(7)
v_mfma_f32_16x16x32_bf16 v[32:35], v[168:171], v[144:147], v[32:35]
s_waitcnt lgkmcnt(6)
v_mfma_f32_16x16x32_bf16 v[36:39], v[168:171], v[152:155], v[36:39]
s_waitcnt lgkmcnt(5)
v_mfma_f32_16x16x32_bf16 v[40:43], v[168:171], v[164:167], v[40:43]
ds_read_b128 v[184:187], v18
s_waitcnt lgkmcnt(5)
v_mfma_f32_16x16x32_bf16 v[44:47], v[168:171], v[148:151], v[44:47]
ds_read_b64_tr_b16 v[156:157], v21 offset:1024
v_mfma_f32_16x16x32_bf16 v[240:243], v[28:31], v[168:171], v[240:243]
ds_read_b64_tr_b16 v[158:159], v21 offset:1536
s_waitcnt lgkmcnt(5)
v_mfma_f32_16x16x32_bf16 v[48:51], v[192:195], v[144:147], v[48:51]
v_mfma_f32_16x16x32_bf16 v[52:55], v[192:195], v[152:155], v[52:55]
v_mfma_f32_16x16x32_bf16 v[56:59], v[192:195], v[164:167], v[56:59]
v_mfma_f32_16x16x32_bf16 v[60:63], v[192:195], v[148:151], v[60:63]
ds_read_b64_tr_b16 v[180:181], v20 offset:2048
s_waitcnt lgkmcnt(4)
v_mfma_f32_16x16x32_bf16 v[64:67], v[172:175], v[144:147], v[64:67]
ds_read_b64_tr_b16 v[182:183], v20 offset:2560
v_mfma_f32_16x16x32_bf16 v[68:71], v[172:175], v[152:155], v[68:71]
v_mfma_f32_16x16x32_bf16 v[72:75], v[172:175], v[164:167], v[72:75]
v_mfma_f32_16x16x32_bf16 v[76:79], v[172:175], v[148:151], v[76:79]
s_waitcnt lgkmcnt(4)
v_mfma_f32_16x16x32_bf16 v[128:131], v[172:175], v[184:187], v[128:131]
ds_read_b64_tr_b16 v[160:161], v21 offset:2048
s_waitcnt lgkmcnt(3)
v_mfma_f32_16x16x32_bf16 v[80:83], v[156:159], v[144:147], v[80:83]
ds_read_b64_tr_b16 v[162:163], v21 offset:2560
v_mfma_f32_16x16x32_bf16 v[84:87], v[156:159], v[152:155], v[84:87]
v_mfma_f32_16x16x32_bf16 v[88:91], v[156:159], v[164:167], v[88:91]
v_mfma_f32_16x16x32_bf16 v[92:95], v[156:159], v[148:151], v[92:95]
v_mfma_f32_16x16x32_bf16 v[132:135], v[156:159], v[184:187], v[132:135]
ds_read_b64_tr_b16 v[176:177], v20 offset:12288
s_waitcnt lgkmcnt(3)
v_mfma_f32_16x16x32_bf16 v[96:99], v[144:147], v[180:183], v[96:99]
ds_read_b64_tr_b16 v[178:179], v20 offset:12800
v_mfma_f32_16x16x32_bf16 v[100:103], v[152:155], v[180:183], v[100:103]
ds_read_b128 v[188:191], v17 offset:0
v_mfma_f32_16x16x32_bf16 v[104:107], v[164:167], v[180:183], v[104:107]
ds_read_b128 v[196:199], v17 offset:2048
v_mfma_f32_16x16x32_bf16 v[108:111], v[148:151], v[180:183], v[108:111]
ds_read_b128 v[168:171], v17 offset:4096
v_mfma_f32_16x16x32_bf16 v[136:139], v[184:187], v[180:183], v[136:139]
ds_read_b128 v[192:195], v17 offset:6144
s_waitcnt lgkmcnt(6)
v_mfma_f32_16x16x32_bf16 v[112:115], v[144:147], v[160:163], v[112:115]
ds_read_b64_tr_b16 v[172:173], v21 offset:12288
v_mfma_f32_16x16x32_bf16 v[116:119], v[152:155], v[160:163], v[116:119]
ds_read_b64_tr_b16 v[174:175], v21 offset:12800
v_mfma_f32_16x16x32_bf16 v[120:123], v[164:167], v[160:163], v[120:123]
v_mfma_f32_16x16x32_bf16 v[124:127], v[148:151], v[160:163], v[124:127]
ds_read_b64_tr_b16 v[156:157], v20 offset:13312
v_mfma_f32_16x16x32_bf16 v[140:143], v[184:187], v[160:163], v[140:143]
ds_read_b64_tr_b16 v[158:159], v20 offset:13824
s_waitcnt lgkmcnt(7)
v_mfma_f32_16x16x32_bf16 v[32:35], v[176:179], v[188:191], v[32:35]
s_waitcnt lgkmcnt(6)
v_mfma_f32_16x16x32_bf16 v[36:39], v[176:179], v[196:199], v[36:39]
s_waitcnt lgkmcnt(5)
v_mfma_f32_16x16x32_bf16 v[40:43], v[176:179], v[168:171], v[40:43]
ds_read_b128 v[180:183], v19
s_waitcnt lgkmcnt(5)
v_mfma_f32_16x16x32_bf16 v[44:47], v[176:179], v[192:195], v[44:47]
ds_read_b64_tr_b16 v[144:145], v21 offset:13312
v_mfma_f32_16x16x32_bf16 v[240:243], v[28:31], v[176:179], v[240:243]
ds_read_b64_tr_b16 v[146:147], v21 offset:13824
s_waitcnt lgkmcnt(5)
v_mfma_f32_16x16x32_bf16 v[48:51], v[172:175], v[188:191], v[48:51]
v_mfma_f32_16x16x32_bf16 v[52:55], v[172:175], v[196:199], v[52:55]
v_mfma_f32_16x16x32_bf16 v[56:59], v[172:175], v[168:171], v[56:59]
v_mfma_f32_16x16x32_bf16 v[60:63], v[172:175], v[192:195], v[60:63]
ds_read_b64_tr_b16 v[152:153], v20 offset:14336
s_waitcnt lgkmcnt(4)
v_mfma_f32_16x16x32_bf16 v[64:67], v[156:159], v[188:191], v[64:67]
ds_read_b64_tr_b16 v[154:155], v20 offset:14848
v_mfma_f32_16x16x32_bf16 v[68:71], v[156:159], v[196:199], v[68:71]
v_mfma_f32_16x16x32_bf16 v[72:75], v[156:159], v[168:171], v[72:75]
v_mfma_f32_16x16x32_bf16 v[76:79], v[156:159], v[192:195], v[76:79]
s_waitcnt lgkmcnt(4)
v_mfma_f32_16x16x32_bf16 v[128:131], v[156:159], v[180:183], v[128:131]
ds_read_b64_tr_b16 v[164:165], v21 offset:14336
s_waitcnt lgkmcnt(3)
v_mfma_f32_16x16x32_bf16 v[80:83], v[144:147], v[188:191], v[80:83]
ds_read_b64_tr_b16 v[166:167], v21 offset:14848
v_mfma_f32_16x16x32_bf16 v[84:87], v[144:147], v[196:199], v[84:87]
v_mfma_f32_16x16x32_bf16 v[88:91], v[144:147], v[168:171], v[88:91]
v_mfma_f32_16x16x32_bf16 v[92:95], v[144:147], v[192:195], v[92:95]
v_mfma_f32_16x16x32_bf16 v[132:135], v[144:147], v[180:183], v[132:135]
v_add_u32 v16, 86016, v10
v_add_u32 v17, 86016, v11
v_add_u32 v18, 86016, v12
v_add_u32 v19, 86016, v13
v_add_u32 v20, 86016, v14
v_add_u32 v21, 86016, v15
s_waitcnt lgkmcnt(0)
s_barrier
ds_read_b64_tr_b16 v[148:149], v20 offset:0
v_mfma_f32_16x16x32_bf16 v[96:99], v[188:191], v[152:155], v[96:99]
ds_read_b64_tr_b16 v[150:151], v20 offset:512
v_mfma_f32_16x16x32_bf16 v[100:103], v[196:199], v[152:155], v[100:103]
ds_read_b128 v[160:163], v16 offset:0
v_mfma_f32_16x16x32_bf16 v[104:107], v[168:171], v[152:155], v[104:107]
ds_read_b128 v[184:187], v16 offset:2048
v_mfma_f32_16x16x32_bf16 v[108:111], v[192:195], v[152:155], v[108:111]
ds_read_b128 v[176:179], v16 offset:4096
v_mfma_f32_16x16x32_bf16 v[136:139], v[180:183], v[152:155], v[136:139]
ds_read_b128 v[172:175], v16 offset:6144
v_mfma_f32_16x16x32_bf16 v[112:115], v[188:191], v[164:167], v[112:115]
ds_read_b64_tr_b16 v[156:157], v21 offset:0
v_mfma_f32_16x16x32_bf16 v[116:119], v[196:199], v[164:167], v[116:119]
ds_read_b64_tr_b16 v[158:159], v21 offset:512
v_mfma_f32_16x16x32_bf16 v[120:123], v[168:171], v[164:167], v[120:123]
v_mfma_f32_16x16x32_bf16 v[124:127], v[192:195], v[164:167], v[124:127]
ds_read_b64_tr_b16 v[144:145], v20 offset:1024
v_mfma_f32_16x16x32_bf16 v[140:143], v[180:183], v[164:167], v[140:143]
ds_read_b64_tr_b16 v[146:147], v20 offset:1536
s_waitcnt lgkmcnt(7)
v_mfma_f32_16x16x32_bf16 v[32:35], v[148:151], v[160:163], v[32:35]
s_waitcnt lgkmcnt(6)
v_mfma_f32_16x16x32_bf16 v[36:39], v[148:151], v[184:187], v[36:39]
s_waitcnt lgkmcnt(5)
v_mfma_f32_16x16x32_bf16 v[40:43], v[148:151], v[176:179], v[40:43]
ds_read_b128 v[152:155], v18
s_waitcnt lgkmcnt(5)
v_mfma_f32_16x16x32_bf16 v[44:47], v[148:151], v[172:175], v[44:47]
ds_read_b64_tr_b16 v[188:189], v21 offset:1024
v_mfma_f32_16x16x32_bf16 v[240:243], v[28:31], v[148:151], v[240:243]
ds_read_b64_tr_b16 v[190:191], v21 offset:1536
s_waitcnt lgkmcnt(5)
v_mfma_f32_16x16x32_bf16 v[48:51], v[156:159], v[160:163], v[48:51]
v_mfma_f32_16x16x32_bf16 v[52:55], v[156:159], v[184:187], v[52:55]
v_mfma_f32_16x16x32_bf16 v[56:59], v[156:159], v[176:179], v[56:59]
v_mfma_f32_16x16x32_bf16 v[60:63], v[156:159], v[172:175], v[60:63]
ds_read_b64_tr_b16 v[196:197], v20 offset:2048
s_waitcnt lgkmcnt(4)
v_mfma_f32_16x16x32_bf16 v[64:67], v[144:147], v[160:163], v[64:67]
ds_read_b64_tr_b16 v[198:199], v20 offset:2560
v_mfma_f32_16x16x32_bf16 v[68:71], v[144:147], v[184:187], v[68:71]
v_mfma_f32_16x16x32_bf16 v[72:75], v[144:147], v[176:179], v[72:75]
v_mfma_f32_16x16x32_bf16 v[76:79], v[144:147], v[172:175], v[76:79]
s_waitcnt lgkmcnt(4)
v_mfma_f32_16x16x32_bf16 v[128:131], v[144:147], v[152:155], v[128:131]
ds_read_b64_tr_b16 v[168:169], v21 offset:2048
s_waitcnt lgkmcnt(3)
v_mfma_f32_16x16x32_bf16 v[80:83], v[188:191], v[160:163], v[80:83]
ds_read_b64_tr_b16 v[170:171], v21 offset:2560
v_mfma_f32_16x16x32_bf16 v[84:87], v[188:191], v[184:187], v[84:87]
v_mfma_f32_16x16x32_bf16 v[88:91], v[188:191], v[176:179], v[88:91]
v_mfma_f32_16x16x32_bf16 v[92:95], v[188:191], v[172:175], v[92:95]
v_mfma_f32_16x16x32_bf16 v[132:135], v[188:191], v[152:155], v[132:135]
ds_read_b64_tr_b16 v[192:193], v20 offset:12288
s_waitcnt lgkmcnt(3)
v_mfma_f32_16x16x32_bf16 v[96:99], v[160:163], v[196:199], v[96:99]
ds_read_b64_tr_b16 v[194:195], v20 offset:12800
v_mfma_f32_16x16x32_bf16 v[100:103], v[184:187], v[196:199], v[100:103]
ds_read_b128 v[164:167], v17 offset:0
v_mfma_f32_16x16x32_bf16 v[104:107], v[176:179], v[196:199], v[104:107]
ds_read_b128 v[180:183], v17 offset:2048
v_mfma_f32_16x16x32_bf16 v[108:111], v[172:175], v[196:199], v[108:111]
ds_read_b128 v[148:151], v17 offset:4096
v_mfma_f32_16x16x32_bf16 v[136:139], v[152:155], v[196:199], v[136:139]
ds_read_b128 v[156:159], v17 offset:6144
s_waitcnt lgkmcnt(6)
v_mfma_f32_16x16x32_bf16 v[112:115], v[160:163], v[168:171], v[112:115]
ds_read_b64_tr_b16 v[144:145], v21 offset:12288
v_mfma_f32_16x16x32_bf16 v[116:119], v[184:187], v[168:171], v[116:119]
ds_read_b64_tr_b16 v[146:147], v21 offset:12800
v_mfma_f32_16x16x32_bf16 v[120:123], v[176:179], v[168:171], v[120:123]
v_mfma_f32_16x16x32_bf16 v[124:127], v[172:175], v[168:171], v[124:127]
ds_read_b64_tr_b16 v[188:189], v20 offset:13312
v_mfma_f32_16x16x32_bf16 v[140:143], v[152:155], v[168:171], v[140:143]
ds_read_b64_tr_b16 v[190:191], v20 offset:13824
s_waitcnt lgkmcnt(7)
v_mfma_f32_16x16x32_bf16 v[32:35], v[192:195], v[164:167], v[32:35]
s_waitcnt lgkmcnt(6)
v_mfma_f32_16x16x32_bf16 v[36:39], v[192:195], v[180:183], v[36:39]
s_waitcnt lgkmcnt(5)
v_mfma_f32_16x16x32_bf16 v[40:43], v[192:195], v[148:151], v[40:43]
ds_read_b128 v[196:199], v19
s_waitcnt lgkmcnt(5)
v_mfma_f32_16x16x32_bf16 v[44:47], v[192:195], v[156:159], v[44:47]
ds_read_b64_tr_b16 v[160:161], v21 offset:13312
v_mfma_f32_16x16x32_bf16 v[240:243], v[28:31], v[192:195], v[240:243]
ds_read_b64_tr_b16 v[162:163], v21 offset:13824
s_waitcnt lgkmcnt(5)
v_mfma_f32_16x16x32_bf16 v[48:51], v[144:147], v[164:167], v[48:51]
v_mfma_f32_16x16x32_bf16 v[52:55], v[144:147], v[180:183], v[52:55]
v_mfma_f32_16x16x32_bf16 v[56:59], v[144:147], v[148:151], v[56:59]
v_mfma_f32_16x16x32_bf16 v[60:63], v[144:147], v[156:159], v[60:63]
ds_read_b64_tr_b16 v[184:185], v20 offset:14336
s_waitcnt lgkmcnt(4)
v_mfma_f32_16x16x32_bf16 v[64:67], v[188:191], v[164:167], v[64:67]
ds_read_b64_tr_b16 v[186:187], v20 offset:14848
v_mfma_f32_16x16x32_bf16 v[68:71], v[188:191], v[180:183], v[68:71]
v_mfma_f32_16x16x32_bf16 v[72:75], v[188:191], v[148:151], v[72:75]
v_mfma_f32_16x16x32_bf16 v[76:79], v[188:191], v[156:159], v[76:79]
s_waitcnt lgkmcnt(4)
v_mfma_f32_16x16x32_bf16 v[128:131], v[188:191], v[196:199], v[128:131]
ds_read_b64_tr_b16 v[176:177], v21 offset:14336
s_waitcnt lgkmcnt(3)
v_mfma_f32_16x16x32_bf16 v[80:83], v[160:163], v[164:167], v[80:83]
ds_read_b64_tr_b16 v[178:179], v21 offset:14848
v_mfma_f32_16x16x32_bf16 v[84:87], v[160:163], v[180:183], v[84:87]
v_mfma_f32_16x16x32_bf16 v[88:91], v[160:163], v[148:151], v[88:91]
v_mfma_f32_16x16x32_bf16 v[92:95], v[160:163], v[156:159], v[92:95]
v_mfma_f32_16x16x32_bf16 v[132:135], v[160:163], v[196:199], v[132:135]
v_add_u32 v16, 43008, v10
v_add_u32 v17, 43008, v11
v_add_u32 v18, 43008, v12
v_add_u32 v19, 43008, v13
v_add_u32 v20, 43008, v14
v_add_u32 v21, 43008, v15
s_waitcnt lgkmcnt(0)
s_barrier
ds_read_b64_tr_b16 v[172:173], v20 offset:0
v_mfma_f32_16x16x32_bf16 v[96:99], v[164:167], v[184:187], v[96:99]
ds_read_b64_tr_b16 v[174:175], v20 offset:512
v_mfma_f32_16x16x32_bf16 v[100:103], v[180:183], v[184:187], v[100:103]
ds_read_b128 v[152:155], v16 offset:0
v_mfma_f32_16x16x32_bf16 v[104:107], v[148:151], v[184:187], v[104:107]
ds_read_b128 v[168:171], v16 offset:2048
v_mfma_f32_16x16x32_bf16 v[108:111], v[156:159], v[184:187], v[108:111]
ds_read_b128 v[192:195], v16 offset:4096
v_mfma_f32_16x16x32_bf16 v[136:139], v[196:199], v[184:187], v[136:139]
ds_read_b128 v[144:147], v16 offset:6144
v_mfma_f32_16x16x32_bf16 v[112:115], v[164:167], v[176:179], v[112:115]
ds_read_b64_tr_b16 v[188:189], v21 offset:0
v_mfma_f32_16x16x32_bf16 v[116:119], v[180:183], v[176:179], v[116:119]
ds_read_b64_tr_b16 v[190:191], v21 offset:512
v_mfma_f32_16x16x32_bf16 v[120:123], v[148:151], v[176:179], v[120:123]
v_mfma_f32_16x16x32_bf16 v[124:127], v[156:159], v[176:179], v[124:127]
ds_read_b64_tr_b16 v[160:161], v20 offset:1024
v_mfma_f32_16x16x32_bf16 v[140:143], v[196:199], v[176:179], v[140:143]
ds_read_b64_tr_b16 v[162:163], v20 offset:1536
s_waitcnt lgkmcnt(7)
v_mfma_f32_16x16x32_bf16 v[32:35], v[172:175], v[152:155], v[32:35]
s_waitcnt lgkmcnt(6)
v_mfma_f32_16x16x32_bf16 v[36:39], v[172:175], v[168:171], v[36:39]
s_waitcnt lgkmcnt(5)
v_mfma_f32_16x16x32_bf16 v[40:43], v[172:175], v[192:195], v[40:43]
ds_read_b128 v[184:187], v18
s_waitcnt lgkmcnt(5)
v_mfma_f32_16x16x32_bf16 v[44:47], v[172:175], v[144:147], v[44:47]
ds_read_b64_tr_b16 v[164:165], v21 offset:1024
v_mfma_f32_16x16x32_bf16 v[240:243], v[28:31], v[172:175], v[240:243]
ds_read_b64_tr_b16 v[166:167], v21 offset:1536
s_waitcnt lgkmcnt(5)
v_mfma_f32_16x16x32_bf16 v[48:51], v[188:191], v[152:155], v[48:51]
v_mfma_f32_16x16x32_bf16 v[52:55], v[188:191], v[168:171], v[52:55]
v_mfma_f32_16x16x32_bf16 v[56:59], v[188:191], v[192:195], v[56:59]
v_mfma_f32_16x16x32_bf16 v[60:63], v[188:191], v[144:147], v[60:63]
ds_read_b64_tr_b16 v[180:181], v20 offset:2048
s_waitcnt lgkmcnt(4)
v_mfma_f32_16x16x32_bf16 v[64:67], v[160:163], v[152:155], v[64:67]
ds_read_b64_tr_b16 v[182:183], v20 offset:2560
v_mfma_f32_16x16x32_bf16 v[68:71], v[160:163], v[168:171], v[68:71]
v_mfma_f32_16x16x32_bf16 v[72:75], v[160:163], v[192:195], v[72:75]
v_mfma_f32_16x16x32_bf16 v[76:79], v[160:163], v[144:147], v[76:79]
s_waitcnt lgkmcnt(4)
v_mfma_f32_16x16x32_bf16 v[128:131], v[160:163], v[184:187], v[128:131]
ds_read_b64_tr_b16 v[148:149], v21 offset:2048
s_waitcnt lgkmcnt(3)
v_mfma_f32_16x16x32_bf16 v[80:83], v[164:167], v[152:155], v[80:83]
ds_read_b64_tr_b16 v[150:151], v21 offset:2560
v_mfma_f32_16x16x32_bf16 v[84:87], v[164:167], v[168:171], v[84:87]
v_mfma_f32_16x16x32_bf16 v[88:91], v[164:167], v[192:195], v[88:91]
v_mfma_f32_16x16x32_bf16 v[92:95], v[164:167], v[144:147], v[92:95]
v_mfma_f32_16x16x32_bf16 v[132:135], v[164:167], v[184:187], v[132:135]
ds_read_b64_tr_b16 v[156:157], v20 offset:12288
s_waitcnt lgkmcnt(3)
v_mfma_f32_16x16x32_bf16 v[96:99], v[152:155], v[180:183], v[96:99]
ds_read_b64_tr_b16 v[158:159], v20 offset:12800
v_mfma_f32_16x16x32_bf16 v[100:103], v[168:171], v[180:183], v[100:103]
ds_read_b128 v[176:179], v17 offset:0
v_mfma_f32_16x16x32_bf16 v[104:107], v[192:195], v[180:183], v[104:107]
ds_read_b128 v[196:199], v17 offset:2048
v_mfma_f32_16x16x32_bf16 v[108:111], v[144:147], v[180:183], v[108:111]
ds_read_b128 v[172:175], v17 offset:4096
v_mfma_f32_16x16x32_bf16 v[136:139], v[184:187], v[180:183], v[136:139]
ds_read_b128 v[188:191], v17 offset:6144
s_waitcnt lgkmcnt(6)
v_mfma_f32_16x16x32_bf16 v[112:115], v[152:155], v[148:151], v[112:115]
ds_read_b64_tr_b16 v[160:161], v21 offset:12288
v_mfma_f32_16x16x32_bf16 v[116:119], v[168:171], v[148:151], v[116:119]
ds_read_b64_tr_b16 v[162:163], v21 offset:12800
v_mfma_f32_16x16x32_bf16 v[120:123], v[192:195], v[148:151], v[120:123]
v_mfma_f32_16x16x32_bf16 v[124:127], v[144:147], v[148:151], v[124:127]
ds_read_b64_tr_b16 v[164:165], v20 offset:13312
v_mfma_f32_16x16x32_bf16 v[140:143], v[184:187], v[148:151], v[140:143]
ds_read_b64_tr_b16 v[166:167], v20 offset:13824
s_waitcnt lgkmcnt(7)
v_mfma_f32_16x16x32_bf16 v[32:35], v[156:159], v[176:179], v[32:35]
s_waitcnt lgkmcnt(6)
v_mfma_f32_16x16x32_bf16 v[36:39], v[156:159], v[196:199], v[36:39]
s_waitcnt lgkmcnt(5)
v_mfma_f32_16x16x32_bf16 v[40:43], v[156:159], v[172:175], v[40:43]
ds_read_b128 v[180:183], v19
s_waitcnt lgkmcnt(5)
v_mfma_f32_16x16x32_bf16 v[44:47], v[156:159], v[188:191], v[44:47]
ds_read_b64_tr_b16 v[152:153], v21 offset:13312
v_mfma_f32_16x16x32_bf16 v[240:243], v[28:31], v[156:159], v[240:243]
ds_read_b64_tr_b16 v[154:155], v21 offset:13824
s_waitcnt lgkmcnt(5)
v_mfma_f32_16x16x32_bf16 v[48:51], v[160:163], v[176:179], v[48:51]
v_mfma_f32_16x16x32_bf16 v[52:55], v[160:163], v[196:199], v[52:55]
v_mfma_f32_16x16x32_bf16 v[56:59], v[160:163], v[172:175], v[56:59]
v_mfma_f32_16x16x32_bf16 v[60:63], v[160:163], v[188:191], v[60:63]
ds_read_b64_tr_b16 v[168:169], v20 offset:14336
s_waitcnt lgkmcnt(4)
v_mfma_f32_16x16x32_bf16 v[64:67], v[164:167], v[176:179], v[64:67]
ds_read_b64_tr_b16 v[170:171], v20 offset:14848
v_mfma_f32_16x16x32_bf16 v[68:71], v[164:167], v[196:199], v[68:71]
v_mfma_f32_16x16x32_bf16 v[72:75], v[164:167], v[172:175], v[72:75]
v_mfma_f32_16x16x32_bf16 v[76:79], v[164:167], v[188:191], v[76:79]
s_waitcnt lgkmcnt(4)
v_mfma_f32_16x16x32_bf16 v[128:131], v[164:167], v[180:183], v[128:131]
ds_read_b64_tr_b16 v[192:193], v21 offset:14336
s_waitcnt lgkmcnt(3)
v_mfma_f32_16x16x32_bf16 v[80:83], v[152:155], v[176:179], v[80:83]
ds_read_b64_tr_b16 v[194:195], v21 offset:14848
v_mfma_f32_16x16x32_bf16 v[84:87], v[152:155], v[196:199], v[84:87]
v_mfma_f32_16x16x32_bf16 v[88:91], v[152:155], v[172:175], v[88:91]
v_mfma_f32_16x16x32_bf16 v[92:95], v[152:155], v[188:191], v[92:95]
v_mfma_f32_16x16x32_bf16 v[132:135], v[152:155], v[180:183], v[132:135]
v_add_u32 v16, 0, v10
v_add_u32 v17, 0, v11
v_add_u32 v18, 0, v12
v_add_u32 v19, 0, v13
v_add_u32 v20, 0, v14
v_add_u32 v21, 0, v15
s_waitcnt lgkmcnt(0)
s_barrier
ds_read_b64_tr_b16 v[144:145], v20 offset:0
v_mfma_f32_16x16x32_bf16 v[96:99], v[176:179], v[168:171], v[96:99]
ds_read_b64_tr_b16 v[146:147], v20 offset:512
v_mfma_f32_16x16x32_bf16 v[100:103], v[196:199], v[168:171], v[100:103]
ds_read_b128 v[148:151], v16 offset:0
v_mfma_f32_16x16x32_bf16 v[104:107], v[172:175], v[168:171], v[104:107]
ds_read_b128 v[184:187], v16 offset:2048
v_mfma_f32_16x16x32_bf16 v[108:111], v[188:191], v[168:171], v[108:111]
ds_read_b128 v[156:159], v16 offset:4096
v_mfma_f32_16x16x32_bf16 v[136:139], v[180:183], v[168:171], v[136:139]
ds_read_b128 v[160:163], v16 offset:6144
v_mfma_f32_16x16x32_bf16 v[112:115], v[176:179], v[192:195], v[112:115]
ds_read_b64_tr_b16 v[164:165], v21 offset:0
v_mfma_f32_16x16x32_bf16 v[116:119], v[196:199], v[192:195], v[116:119]
ds_read_b64_tr_b16 v[166:167], v21 offset:512
v_mfma_f32_16x16x32_bf16 v[120:123], v[172:175], v[192:195], v[120:123]
v_mfma_f32_16x16x32_bf16 v[124:127], v[188:191], v[192:195], v[124:127]
ds_read_b64_tr_b16 v[152:153], v20 offset:1024
v_mfma_f32_16x16x32_bf16 v[140:143], v[180:183], v[192:195], v[140:143]
ds_read_b64_tr_b16 v[154:155], v20 offset:1536
s_waitcnt lgkmcnt(7)
v_mfma_f32_16x16x32_bf16 v[32:35], v[144:147], v[148:151], v[32:35]
s_waitcnt lgkmcnt(6)
v_mfma_f32_16x16x32_bf16 v[36:39], v[144:147], v[184:187], v[36:39]
s_waitcnt lgkmcnt(5)
v_mfma_f32_16x16x32_bf16 v[40:43], v[144:147], v[156:159], v[40:43]
ds_read_b128 v[168:171], v18
s_waitcnt lgkmcnt(5)
v_mfma_f32_16x16x32_bf16 v[44:47], v[144:147], v[160:163], v[44:47]
ds_read_b64_tr_b16 v[176:177], v21 offset:1024
v_mfma_f32_16x16x32_bf16 v[240:243], v[28:31], v[144:147], v[240:243]
ds_read_b64_tr_b16 v[178:179], v21 offset:1536
s_waitcnt lgkmcnt(5)
v_mfma_f32_16x16x32_bf16 v[48:51], v[164:167], v[148:151], v[48:51]
v_mfma_f32_16x16x32_bf16 v[52:55], v[164:167], v[184:187], v[52:55]
v_mfma_f32_16x16x32_bf16 v[56:59], v[164:167], v[156:159], v[56:59]
v_mfma_f32_16x16x32_bf16 v[60:63], v[164:167], v[160:163], v[60:63]
ds_read_b64_tr_b16 v[196:197], v20 offset:2048
s_waitcnt lgkmcnt(4)
v_mfma_f32_16x16x32_bf16 v[64:67], v[152:155], v[148:151], v[64:67]
ds_read_b64_tr_b16 v[198:199], v20 offset:2560
v_mfma_f32_16x16x32_bf16 v[68:71], v[152:155], v[184:187], v[68:71]
v_mfma_f32_16x16x32_bf16 v[72:75], v[152:155], v[156:159], v[72:75]
v_mfma_f32_16x16x32_bf16 v[76:79], v[152:155], v[160:163], v[76:79]
s_waitcnt lgkmcnt(4)
v_mfma_f32_16x16x32_bf16 v[128:131], v[152:155], v[168:171], v[128:131]
ds_read_b64_tr_b16 v[172:173], v21 offset:2048
s_waitcnt lgkmcnt(3)
v_mfma_f32_16x16x32_bf16 v[80:83], v[176:179], v[148:151], v[80:83]
ds_read_b64_tr_b16 v[174:175], v21 offset:2560
v_mfma_f32_16x16x32_bf16 v[84:87], v[176:179], v[184:187], v[84:87]
v_mfma_f32_16x16x32_bf16 v[88:91], v[176:179], v[156:159], v[88:91]
v_mfma_f32_16x16x32_bf16 v[92:95], v[176:179], v[160:163], v[92:95]
v_mfma_f32_16x16x32_bf16 v[132:135], v[176:179], v[168:171], v[132:135]
ds_read_b64_tr_b16 v[188:189], v20 offset:12288
s_waitcnt lgkmcnt(3)
v_mfma_f32_16x16x32_bf16 v[96:99], v[148:151], v[196:199], v[96:99]
ds_read_b64_tr_b16 v[190:191], v20 offset:12800
v_mfma_f32_16x16x32_bf16 v[100:103], v[184:187], v[196:199], v[100:103]
ds_read_b128 v[180:183], v17 offset:0
v_mfma_f32_16x16x32_bf16 v[104:107], v[156:159], v[196:199], v[104:107]
ds_read_b128 v[192:195], v17 offset:2048
v_mfma_f32_16x16x32_bf16 v[108:111], v[160:163], v[196:199], v[108:111]
ds_read_b128 v[144:147], v17 offset:4096
v_mfma_f32_16x16x32_bf16 v[136:139], v[168:171], v[196:199], v[136:139]
ds_read_b128 v[164:167], v17 offset:6144
s_waitcnt lgkmcnt(6)
v_mfma_f32_16x16x32_bf16 v[112:115], v[148:151], v[172:175], v[112:115]
ds_read_b64_tr_b16 v[152:153], v21 offset:12288
v_mfma_f32_16x16x32_bf16 v[116:119], v[184:187], v[172:175], v[116:119]
ds_read_b64_tr_b16 v[154:155], v21 offset:12800
v_mfma_f32_16x16x32_bf16 v[120:123], v[156:159], v[172:175], v[120:123]
v_mfma_f32_16x16x32_bf16 v[124:127], v[160:163], v[172:175], v[124:127]
ds_read_b64_tr_b16 v[176:177], v20 offset:13312
v_mfma_f32_16x16x32_bf16 v[140:143], v[168:171], v[172:175], v[140:143]
ds_read_b64_tr_b16 v[178:179], v20 offset:13824
s_waitcnt lgkmcnt(7)
v_mfma_f32_16x16x32_bf16 v[32:35], v[188:191], v[180:183], v[32:35]
s_waitcnt lgkmcnt(6)
v_mfma_f32_16x16x32_bf16 v[36:39], v[188:191], v[192:195], v[36:39]
s_waitcnt lgkmcnt(5)
v_mfma_f32_16x16x32_bf16 v[40:43], v[188:191], v[144:147], v[40:43]
ds_read_b128 v[196:199], v19
s_waitcnt lgkmcnt(5)
v_mfma_f32_16x16x32_bf16 v[44:47], v[188:191], v[164:167], v[44:47]
ds_read_b64_tr_b16 v[148:149], v21 offset:13312
v_mfma_f32_16x16x32_bf16 v[240:243], v[28:31], v[188:191], v[240:243]
ds_read_b64_tr_b16 v[150:151], v21 offset:13824
s_waitcnt lgkmcnt(5)
v_mfma_f32_16x16x32_bf16 v[48:51], v[152:155], v[180:183], v[48:51]
v_mfma_f32_16x16x32_bf16 v[52:55], v[152:155], v[192:195], v[52:55]
v_mfma_f32_16x16x32_bf16 v[56:59], v[152:155], v[144:147], v[56:59]
v_mfma_f32_16x16x32_bf16 v[60:63], v[152:155], v[164:167], v[60:63]
ds_read_b64_tr_b16 v[184:185], v20 offset:14336
s_waitcnt lgkmcnt(4)
v_mfma_f32_16x16x32_bf16 v[64:67], v[176:179], v[180:183], v[64:67]
ds_read_b64_tr_b16 v[186:187], v20 offset:14848
v_mfma_f32_16x16x32_bf16 v[68:71], v[176:179], v[192:195], v[68:71]
v_mfma_f32_16x16x32_bf16 v[72:75], v[176:179], v[144:147], v[72:75]
v_mfma_f32_16x16x32_bf16 v[76:79], v[176:179], v[164:167], v[76:79]
s_waitcnt lgkmcnt(4)
v_mfma_f32_16x16x32_bf16 v[128:131], v[176:179], v[196:199], v[128:131]
ds_read_b64_tr_b16 v[156:157], v21 offset:14336
s_waitcnt lgkmcnt(3)
v_mfma_f32_16x16x32_bf16 v[80:83], v[148:151], v[180:183], v[80:83]
ds_read_b64_tr_b16 v[158:159], v21 offset:14848
v_mfma_f32_16x16x32_bf16 v[84:87], v[148:151], v[192:195], v[84:87]
v_mfma_f32_16x16x32_bf16 v[88:91], v[148:151], v[144:147], v[88:91]
v_mfma_f32_16x16x32_bf16 v[92:95], v[148:151], v[164:167], v[92:95]
v_mfma_f32_16x16x32_bf16 v[132:135], v[148:151], v[196:199], v[132:135]
v_add_u32 v16, 86016, v10
v_add_u32 v17, 86016, v11
v_add_u32 v18, 86016, v12
v_add_u32 v19, 86016, v13
v_add_u32 v20, 86016, v14
v_add_u32 v21, 86016, v15
s_waitcnt lgkmcnt(0)
s_barrier
ds_read_b64_tr_b16 v[160:161], v20 offset:0
v_mfma_f32_16x16x32_bf16 v[96:99], v[180:183], v[184:187], v[96:99]
ds_read_b64_tr_b16 v[162:163], v20 offset:512
v_mfma_f32_16x16x32_bf16 v[100:103], v[192:195], v[184:187], v[100:103]
ds_read_b128 v[168:171], v16 offset:0
v_mfma_f32_16x16x32_bf16 v[104:107], v[144:147], v[184:187], v[104:107]
ds_read_b128 v[172:175], v16 offset:2048
v_mfma_f32_16x16x32_bf16 v[108:111], v[164:167], v[184:187], v[108:111]
ds_read_b128 v[188:191], v16 offset:4096
v_mfma_f32_16x16x32_bf16 v[136:139], v[196:199], v[184:187], v[136:139]
ds_read_b128 v[152:155], v16 offset:6144
v_mfma_f32_16x16x32_bf16 v[112:115], v[180:183], v[156:159], v[112:115]
ds_read_b64_tr_b16 v[176:177], v21 offset:0
v_mfma_f32_16x16x32_bf16 v[116:119], v[192:195], v[156:159], v[116:119]
ds_read_b64_tr_b16 v[178:179], v21 offset:512
v_mfma_f32_16x16x32_bf16 v[120:123], v[144:147], v[156:159], v[120:123]
v_mfma_f32_16x16x32_bf16 v[124:127], v[164:167], v[156:159], v[124:127]
ds_read_b64_tr_b16 v[148:149], v20 offset:1024
v_mfma_f32_16x16x32_bf16 v[140:143], v[196:199], v[156:159], v[140:143]
ds_read_b64_tr_b16 v[150:151], v20 offset:1536
s_waitcnt lgkmcnt(7)
v_mfma_f32_16x16x32_bf16 v[32:35], v[160:163], v[168:171], v[32:35]
s_waitcnt lgkmcnt(6)
v_mfma_f32_16x16x32_bf16 v[36:39], v[160:163], v[172:175], v[36:39]
s_waitcnt lgkmcnt(5)
v_mfma_f32_16x16x32_bf16 v[40:43], v[160:163], v[188:191], v[40:43]
ds_read_b128 v[184:187], v18
s_waitcnt lgkmcnt(5)
v_mfma_f32_16x16x32_bf16 v[44:47], v[160:163], v[152:155], v[44:47]
ds_read_b64_tr_b16 v[180:181], v21 offset:1024
v_mfma_f32_16x16x32_bf16 v[240:243], v[28:31], v[160:163], v[240:243]
ds_read_b64_tr_b16 v[182:183], v21 offset:1536
s_waitcnt lgkmcnt(5)
v_mfma_f32_16x16x32_bf16 v[48:51], v[176:179], v[168:171], v[48:51]
v_mfma_f32_16x16x32_bf16 v[52:55], v[176:179], v[172:175], v[52:55]
v_mfma_f32_16x16x32_bf16 v[56:59], v[176:179], v[188:191], v[56:59]
v_mfma_f32_16x16x32_bf16 v[60:63], v[176:179], v[152:155], v[60:63]
ds_read_b64_tr_b16 v[192:193], v20 offset:2048
s_waitcnt lgkmcnt(4)
v_mfma_f32_16x16x32_bf16 v[64:67], v[148:151], v[168:171], v[64:67]
ds_read_b64_tr_b16 v[194:195], v20 offset:2560
v_mfma_f32_16x16x32_bf16 v[68:71], v[148:151], v[172:175], v[68:71]
v_mfma_f32_16x16x32_bf16 v[72:75], v[148:151], v[188:191], v[72:75]
v_mfma_f32_16x16x32_bf16 v[76:79], v[148:151], v[152:155], v[76:79]
s_waitcnt lgkmcnt(4)
v_mfma_f32_16x16x32_bf16 v[128:131], v[148:151], v[184:187], v[128:131]
ds_read_b64_tr_b16 v[144:145], v21 offset:2048
s_waitcnt lgkmcnt(3)
v_mfma_f32_16x16x32_bf16 v[80:83], v[180:183], v[168:171], v[80:83]
ds_read_b64_tr_b16 v[146:147], v21 offset:2560
v_mfma_f32_16x16x32_bf16 v[84:87], v[180:183], v[172:175], v[84:87]
v_mfma_f32_16x16x32_bf16 v[88:91], v[180:183], v[188:191], v[88:91]
v_mfma_f32_16x16x32_bf16 v[92:95], v[180:183], v[152:155], v[92:95]
v_mfma_f32_16x16x32_bf16 v[132:135], v[180:183], v[184:187], v[132:135]
ds_read_b64_tr_b16 v[164:165], v20 offset:12288
s_waitcnt lgkmcnt(3)
v_mfma_f32_16x16x32_bf16 v[96:99], v[168:171], v[192:195], v[96:99]
ds_read_b64_tr_b16 v[166:167], v20 offset:12800
v_mfma_f32_16x16x32_bf16 v[100:103], v[172:175], v[192:195], v[100:103]
ds_read_b128 v[156:159], v17 offset:0
v_mfma_f32_16x16x32_bf16 v[104:107], v[188:191], v[192:195], v[104:107]
ds_read_b128 v[196:199], v17 offset:2048
v_mfma_f32_16x16x32_bf16 v[108:111], v[152:155], v[192:195], v[108:111]
ds_read_b128 v[160:163], v17 offset:4096
v_mfma_f32_16x16x32_bf16 v[136:139], v[184:187], v[192:195], v[136:139]
ds_read_b128 v[176:179], v17 offset:6144
s_waitcnt lgkmcnt(6)
v_mfma_f32_16x16x32_bf16 v[112:115], v[168:171], v[144:147], v[112:115]
ds_read_b64_tr_b16 v[148:149], v21 offset:12288
v_mfma_f32_16x16x32_bf16 v[116:119], v[172:175], v[144:147], v[116:119]
ds_read_b64_tr_b16 v[150:151], v21 offset:12800
v_mfma_f32_16x16x32_bf16 v[120:123], v[188:191], v[144:147], v[120:123]
v_mfma_f32_16x16x32_bf16 v[124:127], v[152:155], v[144:147], v[124:127]
ds_read_b64_tr_b16 v[180:181], v20 offset:13312
v_mfma_f32_16x16x32_bf16 v[140:143], v[184:187], v[144:147], v[140:143]
ds_read_b64_tr_b16 v[182:183], v20 offset:13824
s_waitcnt lgkmcnt(7)
v_mfma_f32_16x16x32_bf16 v[32:35], v[164:167], v[156:159], v[32:35]
s_waitcnt lgkmcnt(6)
v_mfma_f32_16x16x32_bf16 v[36:39], v[164:167], v[196:199], v[36:39]
s_waitcnt lgkmcnt(5)
v_mfma_f32_16x16x32_bf16 v[40:43], v[164:167], v[160:163], v[40:43]
ds_read_b128 v[192:195], v19
s_waitcnt lgkmcnt(5)
v_mfma_f32_16x16x32_bf16 v[44:47], v[164:167], v[176:179], v[44:47]
ds_read_b64_tr_b16 v[168:169], v21 offset:13312
v_mfma_f32_16x16x32_bf16 v[240:243], v[28:31], v[164:167], v[240:243]
ds_read_b64_tr_b16 v[170:171], v21 offset:13824
s_waitcnt lgkmcnt(5)
v_mfma_f32_16x16x32_bf16 v[48:51], v[148:151], v[156:159], v[48:51]
v_mfma_f32_16x16x32_bf16 v[52:55], v[148:151], v[196:199], v[52:55]
v_mfma_f32_16x16x32_bf16 v[56:59], v[148:151], v[160:163], v[56:59]
v_mfma_f32_16x16x32_bf16 v[60:63], v[148:151], v[176:179], v[60:63]
ds_read_b64_tr_b16 v[172:173], v20 offset:14336
s_waitcnt lgkmcnt(4)
v_mfma_f32_16x16x32_bf16 v[64:67], v[180:183], v[156:159], v[64:67]
ds_read_b64_tr_b16 v[174:175], v20 offset:14848
v_mfma_f32_16x16x32_bf16 v[68:71], v[180:183], v[196:199], v[68:71]
v_mfma_f32_16x16x32_bf16 v[72:75], v[180:183], v[160:163], v[72:75]
v_mfma_f32_16x16x32_bf16 v[76:79], v[180:183], v[176:179], v[76:79]
s_waitcnt lgkmcnt(4)
v_mfma_f32_16x16x32_bf16 v[128:131], v[180:183], v[192:195], v[128:131]
ds_read_b64_tr_b16 v[188:189], v21 offset:14336
s_waitcnt lgkmcnt(3)
v_mfma_f32_16x16x32_bf16 v[80:83], v[168:171], v[156:159], v[80:83]
ds_read_b64_tr_b16 v[190:191], v21 offset:14848
v_mfma_f32_16x16x32_bf16 v[84:87], v[168:171], v[196:199], v[84:87]
v_mfma_f32_16x16x32_bf16 v[88:91], v[168:171], v[160:163], v[88:91]
v_mfma_f32_16x16x32_bf16 v[92:95], v[168:171], v[176:179], v[92:95]
v_mfma_f32_16x16x32_bf16 v[132:135], v[168:171], v[192:195], v[132:135]
v_add_u32 v16, 43008, v10
v_add_u32 v17, 43008, v11
v_add_u32 v18, 43008, v12
v_add_u32 v19, 43008, v13
v_add_u32 v20, 43008, v14
v_add_u32 v21, 43008, v15
s_waitcnt lgkmcnt(0)
s_barrier
ds_read_b64_tr_b16 v[152:153], v20 offset:0
v_mfma_f32_16x16x32_bf16 v[96:99], v[156:159], v[172:175], v[96:99]
ds_read_b64_tr_b16 v[154:155], v20 offset:512
v_mfma_f32_16x16x32_bf16 v[100:103], v[196:199], v[172:175], v[100:103]
ds_read_b128 v[144:147], v16 offset:0
v_mfma_f32_16x16x32_bf16 v[104:107], v[160:163], v[172:175], v[104:107]
ds_read_b128 v[184:187], v16 offset:2048
v_mfma_f32_16x16x32_bf16 v[108:111], v[176:179], v[172:175], v[108:111]
ds_read_b128 v[164:167], v16 offset:4096
v_mfma_f32_16x16x32_bf16 v[136:139], v[192:195], v[172:175], v[136:139]
ds_read_b128 v[148:151], v16 offset:6144
v_mfma_f32_16x16x32_bf16 v[112:115], v[156:159], v[188:191], v[112:115]
ds_read_b64_tr_b16 v[180:181], v21 offset:0
v_mfma_f32_16x16x32_bf16 v[116:119], v[196:199], v[188:191], v[116:119]
ds_read_b64_tr_b16 v[182:183], v21 offset:512
v_mfma_f32_16x16x32_bf16 v[120:123], v[160:163], v[188:191], v[120:123]
v_mfma_f32_16x16x32_bf16 v[124:127], v[176:179], v[188:191], v[124:127]
ds_read_b64_tr_b16 v[168:169], v20 offset:1024
v_mfma_f32_16x16x32_bf16 v[140:143], v[192:195], v[188:191], v[140:143]
ds_read_b64_tr_b16 v[170:171], v20 offset:1536
s_waitcnt lgkmcnt(7)
v_mfma_f32_16x16x32_bf16 v[32:35], v[152:155], v[144:147], v[32:35]
s_waitcnt lgkmcnt(6)
v_mfma_f32_16x16x32_bf16 v[36:39], v[152:155], v[184:187], v[36:39]
s_waitcnt lgkmcnt(5)
v_mfma_f32_16x16x32_bf16 v[40:43], v[152:155], v[164:167], v[40:43]
ds_read_b128 v[172:175], v18
s_waitcnt lgkmcnt(5)
v_mfma_f32_16x16x32_bf16 v[44:47], v[152:155], v[148:151], v[44:47]
ds_read_b64_tr_b16 v[156:157], v21 offset:1024
v_mfma_f32_16x16x32_bf16 v[240:243], v[28:31], v[152:155], v[240:243]
ds_read_b64_tr_b16 v[158:159], v21 offset:1536
s_waitcnt lgkmcnt(5)
v_mfma_f32_16x16x32_bf16 v[48:51], v[180:183], v[144:147], v[48:51]
v_mfma_f32_16x16x32_bf16 v[52:55], v[180:183], v[184:187], v[52:55]
v_mfma_f32_16x16x32_bf16 v[56:59], v[180:183], v[164:167], v[56:59]
v_mfma_f32_16x16x32_bf16 v[60:63], v[180:183], v[148:151], v[60:63]
ds_read_b64_tr_b16 v[196:197], v20 offset:2048
s_waitcnt lgkmcnt(4)
v_mfma_f32_16x16x32_bf16 v[64:67], v[168:171], v[144:147], v[64:67]
ds_read_b64_tr_b16 v[198:199], v20 offset:2560
v_mfma_f32_16x16x32_bf16 v[68:71], v[168:171], v[184:187], v[68:71]
v_mfma_f32_16x16x32_bf16 v[72:75], v[168:171], v[164:167], v[72:75]
v_mfma_f32_16x16x32_bf16 v[76:79], v[168:171], v[148:151], v[76:79]
s_waitcnt lgkmcnt(4)
v_mfma_f32_16x16x32_bf16 v[128:131], v[168:171], v[172:175], v[128:131]
ds_read_b64_tr_b16 v[160:161], v21 offset:2048
s_waitcnt lgkmcnt(3)
v_mfma_f32_16x16x32_bf16 v[80:83], v[156:159], v[144:147], v[80:83]
ds_read_b64_tr_b16 v[162:163], v21 offset:2560
v_mfma_f32_16x16x32_bf16 v[84:87], v[156:159], v[184:187], v[84:87]
v_mfma_f32_16x16x32_bf16 v[88:91], v[156:159], v[164:167], v[88:91]
v_mfma_f32_16x16x32_bf16 v[92:95], v[156:159], v[148:151], v[92:95]
v_mfma_f32_16x16x32_bf16 v[132:135], v[156:159], v[172:175], v[132:135]
ds_read_b64_tr_b16 v[176:177], v20 offset:12288
s_waitcnt lgkmcnt(3)
v_mfma_f32_16x16x32_bf16 v[96:99], v[144:147], v[196:199], v[96:99]
ds_read_b64_tr_b16 v[178:179], v20 offset:12800
v_mfma_f32_16x16x32_bf16 v[100:103], v[184:187], v[196:199], v[100:103]
ds_read_b128 v[188:191], v17 offset:0
v_mfma_f32_16x16x32_bf16 v[104:107], v[164:167], v[196:199], v[104:107]
ds_read_b128 v[192:195], v17 offset:2048
v_mfma_f32_16x16x32_bf16 v[108:111], v[148:151], v[196:199], v[108:111]
ds_read_b128 v[152:155], v17 offset:4096
v_mfma_f32_16x16x32_bf16 v[136:139], v[172:175], v[196:199], v[136:139]
ds_read_b128 v[180:183], v17 offset:6144
s_waitcnt lgkmcnt(6)
v_mfma_f32_16x16x32_bf16 v[112:115], v[144:147], v[160:163], v[112:115]
ds_read_b64_tr_b16 v[168:169], v21 offset:12288
v_mfma_f32_16x16x32_bf16 v[116:119], v[184:187], v[160:163], v[116:119]
ds_read_b64_tr_b16 v[170:171], v21 offset:12800
v_mfma_f32_16x16x32_bf16 v[120:123], v[164:167], v[160:163], v[120:123]
v_mfma_f32_16x16x32_bf16 v[124:127], v[148:151], v[160:163], v[124:127]
ds_read_b64_tr_b16 v[156:157], v20 offset:13312
v_mfma_f32_16x16x32_bf16 v[140:143], v[172:175], v[160:163], v[140:143]
ds_read_b64_tr_b16 v[158:159], v20 offset:13824
s_waitcnt lgkmcnt(7)
v_mfma_f32_16x16x32_bf16 v[32:35], v[176:179], v[188:191], v[32:35]
s_waitcnt lgkmcnt(6)
v_mfma_f32_16x16x32_bf16 v[36:39], v[176:179], v[192:195], v[36:39]
s_waitcnt lgkmcnt(5)
v_mfma_f32_16x16x32_bf16 v[40:43], v[176:179], v[152:155], v[40:43]
ds_read_b128 v[196:199], v19
s_waitcnt lgkmcnt(5)
v_mfma_f32_16x16x32_bf16 v[44:47], v[176:179], v[180:183], v[44:47]
ds_read_b64_tr_b16 v[144:145], v21 offset:13312
v_mfma_f32_16x16x32_bf16 v[240:243], v[28:31], v[176:179], v[240:243]
ds_read_b64_tr_b16 v[146:147], v21 offset:13824
s_waitcnt lgkmcnt(5)
v_mfma_f32_16x16x32_bf16 v[48:51], v[168:171], v[188:191], v[48:51]
v_mfma_f32_16x16x32_bf16 v[52:55], v[168:171], v[192:195], v[52:55]
v_mfma_f32_16x16x32_bf16 v[56:59], v[168:171], v[152:155], v[56:59]
v_mfma_f32_16x16x32_bf16 v[60:63], v[168:171], v[180:183], v[60:63]
ds_read_b64_tr_b16 v[184:185], v20 offset:14336
s_waitcnt lgkmcnt(4)
v_mfma_f32_16x16x32_bf16 v[64:67], v[156:159], v[188:191], v[64:67]
ds_read_b64_tr_b16 v[186:187], v20 offset:14848
v_mfma_f32_16x16x32_bf16 v[68:71], v[156:159], v[192:195], v[68:71]
v_mfma_f32_16x16x32_bf16 v[72:75], v[156:159], v[152:155], v[72:75]
v_mfma_f32_16x16x32_bf16 v[76:79], v[156:159], v[180:183], v[76:79]
s_waitcnt lgkmcnt(4)
v_mfma_f32_16x16x32_bf16 v[128:131], v[156:159], v[196:199], v[128:131]
ds_read_b64_tr_b16 v[164:165], v21 offset:14336
s_waitcnt lgkmcnt(3)
v_mfma_f32_16x16x32_bf16 v[80:83], v[144:147], v[188:191], v[80:83]
ds_read_b64_tr_b16 v[166:167], v21 offset:14848
v_mfma_f32_16x16x32_bf16 v[84:87], v[144:147], v[192:195], v[84:87]
v_mfma_f32_16x16x32_bf16 v[88:91], v[144:147], v[152:155], v[88:91]
v_mfma_f32_16x16x32_bf16 v[92:95], v[144:147], v[180:183], v[92:95]
v_mfma_f32_16x16x32_bf16 v[132:135], v[144:147], v[196:199], v[132:135]
s_waitcnt lgkmcnt(2)
v_mfma_f32_16x16x32_bf16 v[96:99], v[188:191], v[184:187], v[96:99]
v_mfma_f32_16x16x32_bf16 v[100:103], v[192:195], v[184:187], v[100:103]
v_mfma_f32_16x16x32_bf16 v[104:107], v[152:155], v[184:187], v[104:107]
v_mfma_f32_16x16x32_bf16 v[108:111], v[180:183], v[184:187], v[108:111]
v_mfma_f32_16x16x32_bf16 v[136:139], v[196:199], v[184:187], v[136:139]
s_waitcnt lgkmcnt(0)
v_mfma_f32_16x16x32_bf16 v[112:115], v[188:191], v[164:167], v[112:115]
v_mfma_f32_16x16x32_bf16 v[116:119], v[192:195], v[164:167], v[116:119]
v_mfma_f32_16x16x32_bf16 v[120:123], v[152:155], v[164:167], v[120:123]
v_mfma_f32_16x16x32_bf16 v[124:127], v[180:183], v[164:167], v[124:127]
v_mfma_f32_16x16x32_bf16 v[140:143], v[196:199], v[164:167], v[140:143]
s_nop 6
ds_write_b32 v221, v240 offset:0
s_branch Lqj_36
Lrh1_35:
v_mov_b32 v208, v204
v_mov_b32 v209, v205
v_mov_b32 v210, v206
v_mov_b32 v211, v207
v_mov_b32 v212, v204
v_mov_b32 v213, v205
v_mov_b32 v214, v206
v_mov_b32 v215, v207
v_mov_b32 v28, 0x3f803f80
v_mov_b32 v29, 0x3f803f80
v_mov_b32 v30, 0x3f803f80
v_mov_b32 v31, 0x3f803f80
v_add_u32 v16, 86016, v10
v_add_u32 v17, 86016, v11
v_add_u32 v18, 86016, v12
v_add_u32 v19, 86016, v13
v_add_u32 v20, 86016, v14
v_add_u32 v21, 86016, v15
s_waitcnt lgkmcnt(0)
s_barrier
ds_read_b64_tr_b16 v[144:145], v20 offset:0
ds_read_b64_tr_b16 v[146:147], v20 offset:512
ds_read_b128 v[148:151], v16 offset:0
ds_read_b128 v[152:155], v16 offset:2048
ds_read_b128 v[156:159], v16 offset:4096
ds_read_b128 v[160:163], v16 offset:6144
ds_read_b64_tr_b16 v[164:165], v21 offset:0
ds_read_b64_tr_b16 v[166:167], v21 offset:512
ds_read_b64_tr_b16 v[168:169], v20 offset:1024
ds_read_b64_tr_b16 v[170:171], v20 offset:1536
s_waitcnt lgkmcnt(7)
v_mfma_f32_16x16x32_bf16 v[32:35], v[144:147], v[148:151], 0
s_waitcnt lgkmcnt(6)
v_mfma_f32_16x16x32_bf16 v[36:39], v[144:147], v[152:155], 0
s_waitcnt lgkmcnt(5)
v_mfma_f32_16x16x32_bf16 v[40:43], v[144:147], v[156:159], 0
s_waitcnt lgkmcnt(4)
v_mfma_f32_16x16x32_bf16 v[44:47], v[144:147], v[160:163], 0
ds_read_b64_tr_b16 v[172:173], v21 offset:1024
s_waitcnt lgkmcnt(3)
v_mfma_f32_16x16x32_bf16 v[48:51], v[164:167], v[148:151], 0
ds_read_b64_tr_b16 v[174:175], v21 offset:1536
v_mfma_f32_16x16x32_bf16 v[52:55], v[164:167], v[152:155], 0
v_mfma_f32_16x16x32_bf16 v[56:59], v[164:167], v[156:159], 0
v_mfma_f32_16x16x32_bf16 v[60:63], v[164:167], v[160:163], 0
v_mfma_f32_16x16x32_bf16 v[128:131], v[28:31], v[164:167], 0
ds_read_b64_tr_b16 v[176:177], v20 offset:2048
s_waitcnt lgkmcnt(3)
v_mfma_f32_16x16x32_bf16 v[64:67], v[168:171], v[148:151], 0
ds_read_b64_tr_b16 v[178:179], v20 offset:2560
v_mfma_f32_16x16x32_bf16 v[68:71], v[168:171], v[152:155], 0
v_mfma_f32_16x16x32_bf16 v[72:75], v[168:171], v[156:159], 0
v_mfma_f32_16x16x32_bf16 v[76:79], v[168:171], v[160:163], 0
v_mfma_f32_16x16x32_bf16 v[132:135], v[28:31], v[168:171], 0
ds_read_b64_tr_b16 v[180:181], v21 offset:2048
s_waitcnt lgkmcnt(3)
v_mfma_f32_16x16x32_bf16 v[80:83], v[172:175], v[148:151], 0
ds_read_b64_tr_b16 v[182:183], v21 offset:2560
v_mfma_f32_16x16x32_bf16 v[84:87], v[172:175], v[152:155], 0
v_mfma_f32_16x16x32_bf16 v[88:91], v[172:175], v[156:159], 0
v_mfma_f32_16x16x32_bf16 v[92:95], v[172:175], v[160:163], 0
v_mfma_f32_16x16x32_bf16 v[136:139], v[28:31], v[172:175], 0
ds_read_b64_tr_b16 v[184:185], v20 offset:12288
s_waitcnt lgkmcnt(3)
v_mfma_f32_16x16x32_bf16 v[96:99], v[148:151], v[176:179], 0
ds_read_b64_tr_b16 v[186:187], v20 offset:12800
v_mfma_f32_16x16x32_bf16 v[100:103], v[152:155], v[176:179], 0
ds_read_b128 v[188:191], v17 offset:0
v_mfma_f32_16x16x32_bf16 v[104:107], v[156:159], v[176:179], 0
ds_read_b128 v[192:195], v17 offset:2048
v_mfma_f32_16x16x32_bf16 v[108:111], v[160:163], v[176:179], 0
ds_read_b128 v[196:199], v17 offset:4096
v_mfma_f32_16x16x32_bf16 v[140:143], v[28:31], v[176:179], 0
ds_read_b128 v[144:147], v17 offset:6144
s_waitcnt lgkmcnt(6)
v_mfma_f32_16x16x32_bf16 v[112:115], v[148:151], v[180:183], 0
ds_read_b64_tr_b16 v[164:165], v21 offset:12288
v_mfma_f32_16x16x32_bf16 v[116:119], v[152:155], v[180:183], 0
ds_read_b64_tr_b16 v[166:167], v21 offset:12800
v_mfma_f32_16x16x32_bf16 v[120:123], v[156:159], v[180:183], 0
v_mfma_f32_16x16x32_bf16 v[124:127], v[160:163], v[180:183], 0
ds_read_b64_tr_b16 v[168:169], v20 offset:13312
v_mfma_f32_16x16x32_bf16 v[244:247], v[28:31], v[180:183], 0
ds_read_b64_tr_b16 v[170:171], v20 offset:13824
s_waitcnt lgkmcnt(7)
v_mfma_f32_16x16x32_bf16 v[32:35], v[184:187], v[188:191], v[32:35]
s_waitcnt lgkmcnt(6)
v_mfma_f32_16x16x32_bf16 v[36:39], v[184:187], v[192:195], v[36:39]
s_waitcnt lgkmcnt(5)
v_mfma_f32_16x16x32_bf16 v[40:43], v[184:187], v[196:199], v[40:43]
s_waitcnt lgkmcnt(4)
v_mfma_f32_16x16x32_bf16 v[44:47], v[184:187], v[144:147], v[44:47]
ds_read_b64_tr_b16 v[172:173], v21 offset:13312
s_waitcnt lgkmcnt(3)
v_mfma_f32_16x16x32_bf16 v[48:51], v[164:167], v[188:191], v[48:51]
ds_read_b64_tr_b16 v[174:175], v21 offset:13824
v_mfma_f32_16x16x32_bf16 v[52:55], v[164:167], v[192:195], v[52:55]
v_mfma_f32_16x16x32_bf16 v[56:59], v[164:167], v[196:199], v[56:59]
v_mfma_f32_16x16x32_bf16 v[60:63], v[164:167], v[144:147], v[60:63]
v_mfma_f32_16x16x32_bf16 v[128:131], v[28:31], v[164:167], v[128:131]
ds_read_b64_tr_b16 v[176:177], v20 offset:14336
s_waitcnt lgkmcnt(3)
v_mfma_f32_16x16x32_bf16 v[64:67], v[168:171], v[188:191], v[64:67]
ds_read_b64_tr_b16 v[178:179], v20 offset:14848
v_mfma_f32_16x16x32_bf16 v[68:71], v[168:171], v[192:195], v[68:71]
v_mfma_f32_16x16x32_bf16 v[72:75], v[168:171], v[196:199], v[72:75]
v_mfma_f32_16x16x32_bf16 v[76:79], v[168:171], v[144:147], v[76:79]
v_mfma_f32_16x16x32_bf16 v[132:135], v[28:31], v[168:171], v[132:135]
ds_read_b64_tr_b16 v[148:149], v21 offset:14336
s_waitcnt lgkmcnt(3)
v_mfma_f32_16x16x32_bf16 v[80:83], v[172:175], v[188:191], v[80:83]
ds_read_b64_tr_b16 v[150:151], v21 offset:14848
v_mfma_f32_16x16x32_bf16 v[84:87], v[172:175], v[192:195], v[84:87]
v_mfma_f32_16x16x32_bf16 v[88:91], v[172:175], v[196:199], v[88:91]
v_mfma_f32_16x16x32_bf16 v[92:95], v[172:175], v[144:147], v[92:95]
v_mfma_f32_16x16x32_bf16 v[136:139], v[28:31], v[172:175], v[136:139]
v_add_u32 v16, 43008, v10
v_add_u32 v17, 43008, v11
v_add_u32 v18, 43008, v12
v_add_u32 v19, 43008, v13
v_add_u32 v20, 43008, v14
v_add_u32 v21, 43008, v15
s_waitcnt lgkmcnt(0)
s_barrier
ds_read_b64_tr_b16 v[152:153], v20 offset:0
v_mfma_f32_16x16x32_bf16 v[96:99], v[188:191], v[176:179], v[96:99]
ds_read_b64_tr_b16 v[154:155], v20 offset:512
v_mfma_f32_16x16x32_bf16 v[100:103], v[192:195], v[176:179], v[100:103]
ds_read_b128 v[156:159], v16 offset:0
v_mfma_f32_16x16x32_bf16 v[104:107], v[196:199], v[176:179], v[104:107]
ds_read_b128 v[160:163], v16 offset:2048
v_mfma_f32_16x16x32_bf16 v[108:111], v[144:147], v[176:179], v[108:111]
ds_read_b128 v[180:183], v16 offset:4096
v_mfma_f32_16x16x32_bf16 v[140:143], v[28:31], v[176:179], v[140:143]
ds_read_b128 v[184:187], v16 offset:6144
v_mfma_f32_16x16x32_bf16 v[112:115], v[188:191], v[148:151], v[112:115]
ds_read_b64_tr_b16 v[164:165], v21 offset:0
v_mfma_f32_16x16x32_bf16 v[116:119], v[192:195], v[148:151], v[116:119]
ds_read_b64_tr_b16 v[166:167], v21 offset:512
v_mfma_f32_16x16x32_bf16 v[120:123], v[196:199], v[148:151], v[120:123]
v_mfma_f32_16x16x32_bf16 v[124:127], v[144:147], v[148:151], v[124:127]
ds_read_b64_tr_b16 v[168:169], v20 offset:1024
v_mfma_f32_16x16x32_bf16 v[244:247], v[28:31], v[148:151], v[244:247]
ds_read_b64_tr_b16 v[170:171], v20 offset:1536
s_waitcnt lgkmcnt(7)
v_mfma_f32_16x16x32_bf16 v[32:35], v[152:155], v[156:159], v[32:35]
s_waitcnt lgkmcnt(6)
v_mfma_f32_16x16x32_bf16 v[36:39], v[152:155], v[160:163], v[36:39]
s_waitcnt lgkmcnt(5)
v_mfma_f32_16x16x32_bf16 v[40:43], v[152:155], v[180:183], v[40:43]
s_waitcnt lgkmcnt(4)
v_mfma_f32_16x16x32_bf16 v[44:47], v[152:155], v[184:187], v[44:47]
ds_read_b64_tr_b16 v[172:173], v21 offset:1024
s_waitcnt lgkmcnt(3)
v_mfma_f32_16x16x32_bf16 v[48:51], v[164:167], v[156:159], v[48:51]
ds_read_b64_tr_b16 v[174:175], v21 offset:1536
v_mfma_f32_16x16x32_bf16 v[52:55], v[164:167], v[160:163], v[52:55]
v_mfma_f32_16x16x32_bf16 v[56:59], v[164:167], v[180:183], v[56:59]
v_mfma_f32_16x16x32_bf16 v[60:63], v[164:167], v[184:187], v[60:63]
v_mfma_f32_16x16x32_bf16 v[128:131], v[28:31], v[164:167], v[128:131]
ds_read_b64_tr_b16 v[176:177], v20 offset:2048
s_waitcnt lgkmcnt(3)
v_mfma_f32_16x16x32_bf16 v[64:67], v[168:171], v[156:159], v[64:67]
ds_read_b64_tr_b16 v[178:179], v20 offset:2560
v_mfma_f32_16x16x32_bf16 v[68:71], v[168:171], v[160:163], v[68:71]
v_mfma_f32_16x16x32_bf16 v[72:75], v[168:171], v[180:183], v[72:75]
v_mfma_f32_16x16x32_bf16 v[76:79], v[168:171], v[184:187], v[76:79]
v_mfma_f32_16x16x32_bf16 v[132:135], v[28:31], v[168:171], v[132:135]
ds_read_b64_tr_b16 v[188:189], v21 offset:2048
s_waitcnt lgkmcnt(3)
v_mfma_f32_16x16x32_bf16 v[80:83], v[172:175], v[156:159], v[80:83]
ds_read_b64_tr_b16 v[190:191], v21 offset:2560
v_mfma_f32_16x16x32_bf16 v[84:87], v[172:175], v[160:163], v[84:87]
v_mfma_f32_16x16x32_bf16 v[88:91], v[172:175], v[180:183], v[88:91]
v_mfma_f32_16x16x32_bf16 v[92:95], v[172:175], v[184:187], v[92:95]
v_mfma_f32_16x16x32_bf16 v[136:139], v[28:31], v[172:175], v[136:139]
ds_read_b64_tr_b16 v[192:193], v20 offset:12288
s_waitcnt lgkmcnt(3)
v_mfma_f32_16x16x32_bf16 v[96:99], v[156:159], v[176:179], v[96:99]
ds_read_b64_tr_b16 v[194:195], v20 offset:12800
v_mfma_f32_16x16x32_bf16 v[100:103], v[160:163], v[176:179], v[100:103]
ds_read_b128 v[196:199], v17 offset:0
v_mfma_f32_16x16x32_bf16 v[104:107], v[180:183], v[176:179], v[104:107]
ds_read_b128 v[144:147], v17 offset:2048
v_mfma_f32_16x16x32_bf16 v[108:111], v[184:187], v[176:179], v[108:111]
ds_read_b128 v[148:151], v17 offset:4096
v_mfma_f32_16x16x32_bf16 v[140:143], v[28:31], v[176:179], v[140:143]
ds_read_b128 v[152:155], v17 offset:6144
s_waitcnt lgkmcnt(6)
v_mfma_f32_16x16x32_bf16 v[112:115], v[156:159], v[188:191], v[112:115]
ds_read_b64_tr_b16 v[164:165], v21 offset:12288
v_mfma_f32_16x16x32_bf16 v[116:119], v[160:163], v[188:191], v[116:119]
ds_read_b64_tr_b16 v[166:167], v21 offset:12800
v_mfma_f32_16x16x32_bf16 v[120:123], v[180:183], v[188:191], v[120:123]
v_mfma_f32_16x16x32_bf16 v[124:127], v[184:187], v[188:191], v[124:127]
ds_read_b64_tr_b16 v[168:169], v20 offset:13312
v_mfma_f32_16x16x32_bf16 v[244:247], v[28:31], v[188:191], v[244:247]
ds_read_b64_tr_b16 v[170:171], v20 offset:13824
s_waitcnt lgkmcnt(7)
v_mfma_f32_16x16x32_bf16 v[32:35], v[192:195], v[196:199], v[32:35]
s_waitcnt lgkmcnt(6)
v_mfma_f32_16x16x32_bf16 v[36:39], v[192:195], v[144:147], v[36:39]
s_waitcnt lgkmcnt(5)
v_mfma_f32_16x16x32_bf16 v[40:43], v[192:195], v[148:151], v[40:43]
s_waitcnt lgkmcnt(4)
v_mfma_f32_16x16x32_bf16 v[44:47], v[192:195], v[152:155], v[44:47]
ds_read_b64_tr_b16 v[172:173], v21 offset:13312
s_waitcnt lgkmcnt(3)
v_mfma_f32_16x16x32_bf16 v[48:51], v[164:167], v[196:199], v[48:51]
ds_read_b64_tr_b16 v[174:175], v21 offset:13824
v_mfma_f32_16x16x32_bf16 v[52:55], v[164:167], v[144:147], v[52:55]
v_mfma_f32_16x16x32_bf16 v[56:59], v[164:167], v[148:151], v[56:59]
v_mfma_f32_16x16x32_bf16 v[60:63], v[164:167], v[152:155], v[60:63]
v_mfma_f32_16x16x32_bf16 v[128:131], v[28:31], v[164:167], v[128:131]
ds_read_b64_tr_b16 v[176:177], v20 offset:14336
s_waitcnt lgkmcnt(3)
v_mfma_f32_16x16x32_bf16 v[64:67], v[168:171], v[196:199], v[64:67]
ds_read_b64_tr_b16 v[178:179], v20 offset:14848
v_mfma_f32_16x16x32_bf16 v[68:71], v[168:171], v[144:147], v[68:71]
v_mfma_f32_16x16x32_bf16 v[72:75], v[168:171], v[148:151], v[72:75]
v_mfma_f32_16x16x32_bf16 v[76:79], v[168:171], v[152:155], v[76:79]
v_mfma_f32_16x16x32_bf16 v[132:135], v[28:31], v[168:171], v[132:135]
ds_read_b64_tr_b16 v[156:157], v21 offset:14336
s_waitcnt lgkmcnt(3)
v_mfma_f32_16x16x32_bf16 v[80:83], v[172:175], v[196:199], v[80:83]
ds_read_b64_tr_b16 v[158:159], v21 offset:14848
v_mfma_f32_16x16x32_bf16 v[84:87], v[172:175], v[144:147], v[84:87]
v_mfma_f32_16x16x32_bf16 v[88:91], v[172:175], v[148:151], v[88:91]
v_mfma_f32_16x16x32_bf16 v[92:95], v[172:175], v[152:155], v[92:95]
v_mfma_f32_16x16x32_bf16 v[136:139], v[28:31], v[172:175], v[136:139]
v_add_u32 v16, 0, v10
v_add_u32 v17, 0, v11
v_add_u32 v18, 0, v12
v_add_u32 v19, 0, v13
v_add_u32 v20, 0, v14
v_add_u32 v21, 0, v15
s_waitcnt lgkmcnt(0)
s_barrier
ds_read_b64_tr_b16 v[160:161], v20 offset:0
v_mfma_f32_16x16x32_bf16 v[96:99], v[196:199], v[176:179], v[96:99]
ds_read_b64_tr_b16 v[162:163], v20 offset:512
v_mfma_f32_16x16x32_bf16 v[100:103], v[144:147], v[176:179], v[100:103]
ds_read_b128 v[180:183], v16 offset:0
v_mfma_f32_16x16x32_bf16 v[104:107], v[148:151], v[176:179], v[104:107]
ds_read_b128 v[184:187], v16 offset:2048
v_mfma_f32_16x16x32_bf16 v[108:111], v[152:155], v[176:179], v[108:111]
ds_read_b128 v[188:191], v16 offset:4096
v_mfma_f32_16x16x32_bf16 v[140:143], v[28:31], v[176:179], v[140:143]
ds_read_b128 v[192:195], v16 offset:6144
v_mfma_f32_16x16x32_bf16 v[112:115], v[196:199], v[156:159], v[112:115]
ds_read_b64_tr_b16 v[164:165], v21 offset:0
v_mfma_f32_16x16x32_bf16 v[116:119], v[144:147], v[156:159], v[116:119]
ds_read_b64_tr_b16 v[166:167], v21 offset:512
v_mfma_f32_16x16x32_bf16 v[120:123], v[148:151], v[156:159], v[120:123]
v_mfma_f32_16x16x32_bf16 v[124:127], v[152:155], v[156:159], v[124:127]
ds_read_b64_tr_b16 v[168:169], v20 offset:1024
v_mfma_f32_16x16x32_bf16 v[244:247], v[28:31], v[156:159], v[244:247]
ds_read_b64_tr_b16 v[170:171], v20 offset:1536
s_waitcnt lgkmcnt(7)
v_mfma_f32_16x16x32_bf16 v[32:35], v[160:163], v[180:183], v[32:35]
s_waitcnt lgkmcnt(6)
v_mfma_f32_16x16x32_bf16 v[36:39], v[160:163], v[184:187], v[36:39]
s_waitcnt lgkmcnt(5)
v_mfma_f32_16x16x32_bf16 v[40:43], v[160:163], v[188:191], v[40:43]
s_waitcnt lgkmcnt(4)
v_mfma_f32_16x16x32_bf16 v[44:47], v[160:163], v[192:195], v[44:47]
ds_read_b64_tr_b16 v[172:173], v21 offset:1024
s_waitcnt lgkmcnt(3)
v_mfma_f32_16x16x32_bf16 v[48:51], v[164:167], v[180:183], v[48:51]
ds_read_b64_tr_b16 v[174:175], v21 offset:1536
v_mfma_f32_16x16x32_bf16 v[52:55], v[164:167], v[184:187], v[52:55]
v_mfma_f32_16x16x32_bf16 v[56:59], v[164:167], v[188:191], v[56:59]
v_mfma_f32_16x16x32_bf16 v[60:63], v[164:167], v[192:195], v[60:63]
v_mfma_f32_16x16x32_bf16 v[128:131], v[28:31], v[164:167], v[128:131]
ds_read_b64_tr_b16 v[176:177], v20 offset:2048
s_waitcnt lgkmcnt(3)
v_mfma_f32_16x16x32_bf16 v[64:67], v[168:171], v[180:183], v[64:67]
ds_read_b64_tr_b16 v[178:179], v20 offset:2560
v_mfma_f32_16x16x32_bf16 v[68:71], v[168:171], v[184:187], v[68:71]
v_mfma_f32_16x16x32_bf16 v[72:75], v[168:171], v[188:191], v[72:75]
v_mfma_f32_16x16x32_bf16 v[76:79], v[168:171], v[192:195], v[76:79]
v_mfma_f32_16x16x32_bf16 v[132:135], v[28:31], v[168:171], v[132:135]
ds_read_b64_tr_b16 v[196:197], v21 offset:2048
s_waitcnt lgkmcnt(3)
v_mfma_f32_16x16x32_bf16 v[80:83], v[172:175], v[180:183], v[80:83]
ds_read_b64_tr_b16 v[198:199], v21 offset:2560
v_mfma_f32_16x16x32_bf16 v[84:87], v[172:175], v[184:187], v[84:87]
v_mfma_f32_16x16x32_bf16 v[88:91], v[172:175], v[188:191], v[88:91]
v_mfma_f32_16x16x32_bf16 v[92:95], v[172:175], v[192:195], v[92:95]
v_mfma_f32_16x16x32_bf16 v[136:139], v[28:31], v[172:175], v[136:139]
ds_read_b64_tr_b16 v[144:145], v20 offset:12288
s_waitcnt lgkmcnt(3)
v_mfma_f32_16x16x32_bf16 v[96:99], v[180:183], v[176:179], v[96:99]
ds_read_b64_tr_b16 v[146:147], v20 offset:12800
v_mfma_f32_16x16x32_bf16 v[100:103], v[184:187], v[176:179], v[100:103]
ds_read_b128 v[148:151], v17 offset:0
v_mfma_f32_16x16x32_bf16 v[104:107], v[188:191], v[176:179], v[104:107]
ds_read_b128 v[152:155], v17 offset:2048
v_mfma_f32_16x16x32_bf16 v[108:111], v[192:195], v[176:179], v[108:111]
ds_read_b128 v[156:159], v17 offset:4096
v_mfma_f32_16x16x32_bf16 v[140:143], v[28:31], v[176:179], v[140:143]
ds_read_b128 v[160:163], v17 offset:6144
s_waitcnt lgkmcnt(6)
v_mfma_f32_16x16x32_bf16 v[112:115], v[180:183], v[196:199], v[112:115]
ds_read_b64_tr_b16 v[164:165], v21 offset:12288
v_mfma_f32_16x16x32_bf16 v[116:119], v[184:187], v[196:199], v[116:119]
ds_read_b64_tr_b16 v[166:167], v21 offset:12800
v_mfma_f32_16x16x32_bf16 v[120:123], v[188:191], v[196:199], v[120:123]
v_mfma_f32_16x16x32_bf16 v[124:127], v[192:195], v[196:199], v[124:127]
ds_read_b64_tr_b16 v[168:169], v20 offset:13312
v_mfma_f32_16x16x32_bf16 v[244:247], v[28:31], v[196:199], v[244:247]
ds_read_b64_tr_b16 v[170:171], v20 offset:13824
s_waitcnt lgkmcnt(7)
v_mfma_f32_16x16x32_bf16 v[32:35], v[144:147], v[148:151], v[32:35]
s_waitcnt lgkmcnt(6)
v_mfma_f32_16x16x32_bf16 v[36:39], v[144:147], v[152:155], v[36:39]
s_waitcnt lgkmcnt(5)
v_mfma_f32_16x16x32_bf16 v[40:43], v[144:147], v[156:159], v[40:43]
s_waitcnt lgkmcnt(4)
v_mfma_f32_16x16x32_bf16 v[44:47], v[144:147], v[160:163], v[44:47]
ds_read_b64_tr_b16 v[172:173], v21 offset:13312
s_waitcnt lgkmcnt(3)
v_mfma_f32_16x16x32_bf16 v[48:51], v[164:167], v[148:151], v[48:51]
ds_read_b64_tr_b16 v[174:175], v21 offset:13824
v_mfma_f32_16x16x32_bf16 v[52:55], v[164:167], v[152:155], v[52:55]
v_mfma_f32_16x16x32_bf16 v[56:59], v[164:167], v[156:159], v[56:59]
v_mfma_f32_16x16x32_bf16 v[60:63], v[164:167], v[160:163], v[60:63]
v_mfma_f32_16x16x32_bf16 v[128:131], v[28:31], v[164:167], v[128:131]
ds_read_b64_tr_b16 v[176:177], v20 offset:14336
s_waitcnt lgkmcnt(3)
v_mfma_f32_16x16x32_bf16 v[64:67], v[168:171], v[148:151], v[64:67]
ds_read_b64_tr_b16 v[178:179], v20 offset:14848
v_mfma_f32_16x16x32_bf16 v[68:71], v[168:171], v[152:155], v[68:71]
v_mfma_f32_16x16x32_bf16 v[72:75], v[168:171], v[156:159], v[72:75]
v_mfma_f32_16x16x32_bf16 v[76:79], v[168:171], v[160:163], v[76:79]
v_mfma_f32_16x16x32_bf16 v[132:135], v[28:31], v[168:171], v[132:135]
ds_read_b64_tr_b16 v[180:181], v21 offset:14336
s_waitcnt lgkmcnt(3)
v_mfma_f32_16x16x32_bf16 v[80:83], v[172:175], v[148:151], v[80:83]
ds_read_b64_tr_b16 v[182:183], v21 offset:14848
v_mfma_f32_16x16x32_bf16 v[84:87], v[172:175], v[152:155], v[84:87]
v_mfma_f32_16x16x32_bf16 v[88:91], v[172:175], v[156:159], v[88:91]
v_mfma_f32_16x16x32_bf16 v[92:95], v[172:175], v[160:163], v[92:95]
v_mfma_f32_16x16x32_bf16 v[136:139], v[28:31], v[172:175], v[136:139]
v_add_u32 v16, 86016, v10
v_add_u32 v17, 86016, v11
v_add_u32 v18, 86016, v12
v_add_u32 v19, 86016, v13
v_add_u32 v20, 86016, v14
v_add_u32 v21, 86016, v15
s_waitcnt lgkmcnt(0)
s_barrier
ds_read_b64_tr_b16 v[184:185], v20 offset:0
v_mfma_f32_16x16x32_bf16 v[96:99], v[148:151], v[176:179], v[96:99]
ds_read_b64_tr_b16 v[186:187], v20 offset:512
v_mfma_f32_16x16x32_bf16 v[100:103], v[152:155], v[176:179], v[100:103]
ds_read_b128 v[188:191], v16 offset:0
v_mfma_f32_16x16x32_bf16 v[104:107], v[156:159], v[176:179], v[104:107]
ds_read_b128 v[192:195], v16 offset:2048
v_mfma_f32_16x16x32_bf16 v[108:111], v[160:163], v[176:179], v[108:111]
ds_read_b128 v[196:199], v16 offset:4096
v_mfma_f32_16x16x32_bf16 v[140:143], v[28:31], v[176:179], v[140:143]
ds_read_b128 v[144:147], v16 offset:6144
v_mfma_f32_16x16x32_bf16 v[112:115], v[148:151], v[180:183], v[112:115]
ds_read_b64_tr_b16 v[164:165], v21 offset:0
v_mfma_f32_16x16x32_bf16 v[116:119], v[152:155], v[180:183], v[116:119]
ds_read_b64_tr_b16 v[166:167], v21 offset:512
v_mfma_f32_16x16x32_bf16 v[120:123], v[156:159], v[180:183], v[120:123]
v_mfma_f32_16x16x32_bf16 v[124:127], v[160:163], v[180:183], v[124:127]
ds_read_b64_tr_b16 v[168:169], v20 offset:1024
v_mfma_f32_16x16x32_bf16 v[244:247], v[28:31], v[180:183], v[244:247]
ds_read_b64_tr_b16 v[170:171], v20 offset:1536
s_waitcnt lgkmcnt(7)
v_mfma_f32_16x16x32_bf16 v[32:35], v[184:187], v[188:191], v[32:35]
s_waitcnt lgkmcnt(6)
v_mfma_f32_16x16x32_bf16 v[36:39], v[184:187], v[192:195], v[36:39]
s_waitcnt lgkmcnt(5)
v_mfma_f32_16x16x32_bf16 v[40:43], v[184:187], v[196:199], v[40:43]
s_waitcnt lgkmcnt(4)
v_mfma_f32_16x16x32_bf16 v[44:47], v[184:187], v[144:147], v[44:47]
ds_read_b64_tr_b16 v[172:173], v21 offset:1024
s_waitcnt lgkmcnt(3)
v_mfma_f32_16x16x32_bf16 v[48:51], v[164:167], v[188:191], v[48:51]
ds_read_b64_tr_b16 v[174:175], v21 offset:1536
v_mfma_f32_16x16x32_bf16 v[52:55], v[164:167], v[192:195], v[52:55]
v_mfma_f32_16x16x32_bf16 v[56:59], v[164:167], v[196:199], v[56:59]
v_mfma_f32_16x16x32_bf16 v[60:63], v[164:167], v[144:147], v[60:63]
v_mfma_f32_16x16x32_bf16 v[128:131], v[28:31], v[164:167], v[128:131]
ds_read_b64_tr_b16 v[176:177], v20 offset:2048
s_waitcnt lgkmcnt(3)
v_mfma_f32_16x16x32_bf16 v[64:67], v[168:171], v[188:191], v[64:67]
ds_read_b64_tr_b16 v[178:179], v20 offset:2560
v_mfma_f32_16x16x32_bf16 v[68:71], v[168:171], v[192:195], v[68:71]
v_mfma_f32_16x16x32_bf16 v[72:75], v[168:171], v[196:199], v[72:75]
v_mfma_f32_16x16x32_bf16 v[76:79], v[168:171], v[144:147], v[76:79]
v_mfma_f32_16x16x32_bf16 v[132:135], v[28:31], v[168:171], v[132:135]
ds_read_b64_tr_b16 v[148:149], v21 offset:2048
s_waitcnt lgkmcnt(3)
v_mfma_f32_16x16x32_bf16 v[80:83], v[172:175], v[188:191], v[80:83]
ds_read_b64_tr_b16 v[150:151], v21 offset:2560
v_mfma_f32_16x16x32_bf16 v[84:87], v[172:175], v[192:195], v[84:87]
v_mfma_f32_16x16x32_bf16 v[88:91], v[172:175], v[196:199], v[88:91]
v_mfma_f32_16x16x32_bf16 v[92:95], v[172:175], v[144:147], v[92:95]
v_mfma_f32_16x16x32_bf16 v[136:139], v[28:31], v[172:175], v[136:139]
ds_read_b64_tr_b16 v[152:153], v20 offset:12288
s_waitcnt lgkmcnt(3)
v_mfma_f32_16x16x32_bf16 v[96:99], v[188:191], v[176:179], v[96:99]
ds_read_b64_tr_b16 v[154:155], v20 offset:12800
v_mfma_f32_16x16x32_bf16 v[100:103], v[192:195], v[176:179], v[100:103]
ds_read_b128 v[156:159], v17 offset:0
v_mfma_f32_16x16x32_bf16 v[104:107], v[196:199], v[176:179], v[104:107]
ds_read_b128 v[160:163], v17 offset:2048
v_mfma_f32_16x16x32_bf16 v[108:111], v[144:147], v[176:179], v[108:111]
ds_read_b128 v[180:183], v17 offset:4096
v_mfma_f32_16x16x32_bf16 v[140:143], v[28:31], v[176:179], v[140:143]
ds_read_b128 v[184:187], v17 offset:6144
s_waitcnt lgkmcnt(6)
v_mfma_f32_16x16x32_bf16 v[112:115], v[188:191], v[148:151], v[112:115]
ds_read_b64_tr_b16 v[164:165], v21 offset:12288
v_mfma_f32_16x16x32_bf16 v[116:119], v[192:195], v[148:151], v[116:119]
ds_read_b64_tr_b16 v[166:167], v21 offset:12800
v_mfma_f32_16x16x32_bf16 v[120:123], v[196:199], v[148:151], v[120:123]
v_mfma_f32_16x16x32_bf16 v[124:127], v[144:147], v[148:151], v[124:127]
ds_read_b64_tr_b16 v[168:169], v20 offset:13312
v_mfma_f32_16x16x32_bf16 v[244:247], v[28:31], v[148:151], v[244:247]
ds_read_b64_tr_b16 v[170:171], v20 offset:13824
s_waitcnt lgkmcnt(7)
v_mfma_f32_16x16x32_bf16 v[32:35], v[152:155], v[156:159], v[32:35]
s_waitcnt lgkmcnt(6)
v_mfma_f32_16x16x32_bf16 v[36:39], v[152:155], v[160:163], v[36:39]
s_waitcnt lgkmcnt(5)
v_mfma_f32_16x16x32_bf16 v[40:43], v[152:155], v[180:183], v[40:43]
s_waitcnt lgkmcnt(4)
v_mfma_f32_16x16x32_bf16 v[44:47], v[152:155], v[184:187], v[44:47]
ds_read_b64_tr_b16 v[172:173], v21 offset:13312
s_waitcnt lgkmcnt(3)
v_mfma_f32_16x16x32_bf16 v[48:51], v[164:167], v[156:159], v[48:51]
ds_read_b64_tr_b16 v[174:175], v21 offset:13824
v_mfma_f32_16x16x32_bf16 v[52:55], v[164:167], v[160:163], v[52:55]
v_mfma_f32_16x16x32_bf16 v[56:59], v[164:167], v[180:183], v[56:59]
v_mfma_f32_16x16x32_bf16 v[60:63], v[164:167], v[184:187], v[60:63]
v_mfma_f32_16x16x32_bf16 v[128:131], v[28:31], v[164:167], v[128:131]
ds_read_b64_tr_b16 v[176:177], v20 offset:14336
s_waitcnt lgkmcnt(3)
v_mfma_f32_16x16x32_bf16 v[64:67], v[168:171], v[156:159], v[64:67]
ds_read_b64_tr_b16 v[178:179], v20 offset:14848
v_mfma_f32_16x16x32_bf16 v[68:71], v[168:171], v[160:163], v[68:71]
v_mfma_f32_16x16x32_bf16 v[72:75], v[168:171], v[180:183], v[72:75]
v_mfma_f32_16x16x32_bf16 v[76:79], v[168:171], v[184:187], v[76:79]
v_mfma_f32_16x16x32_bf16 v[132:135], v[28:31], v[168:171], v[132:135]
ds_read_b64_tr_b16 v[188:189], v21 offset:14336
s_waitcnt lgkmcnt(3)
v_mfma_f32_16x16x32_bf16 v[80:83], v[172:175], v[156:159], v[80:83]
ds_read_b64_tr_b16 v[190:191], v21 offset:14848
v_mfma_f32_16x16x32_bf16 v[84:87], v[172:175], v[160:163], v[84:87]
v_mfma_f32_16x16x32_bf16 v[88:91], v[172:175], v[180:183], v[88:91]
v_mfma_f32_16x16x32_bf16 v[92:95], v[172:175], v[184:187], v[92:95]
v_mfma_f32_16x16x32_bf16 v[136:139], v[28:31], v[172:175], v[136:139]
v_add_u32 v16, 43008, v10
v_add_u32 v17, 43008, v11
v_add_u32 v18, 43008, v12
v_add_u32 v19, 43008, v13
v_add_u32 v20, 43008, v14
v_add_u32 v21, 43008, v15
s_waitcnt lgkmcnt(0)
s_barrier
ds_read_b64_tr_b16 v[192:193], v20 offset:0
v_mfma_f32_16x16x32_bf16 v[96:99], v[156:159], v[176:179], v[96:99]
ds_read_b64_tr_b16 v[194:195], v20 offset:512
v_mfma_f32_16x16x32_bf16 v[100:103], v[160:163], v[176:179], v[100:103]
ds_read_b128 v[196:199], v16 offset:0
v_mfma_f32_16x16x32_bf16 v[104:107], v[180:183], v[176:179], v[104:107]
ds_read_b128 v[144:147], v16 offset:2048
v_mfma_f32_16x16x32_bf16 v[108:111], v[184:187], v[176:179], v[108:111]
ds_read_b128 v[148:151], v16 offset:4096
v_mfma_f32_16x16x32_bf16 v[140:143], v[28:31], v[176:179], v[140:143]
ds_read_b128 v[152:155], v16 offset:6144
v_mfma_f32_16x16x32_bf16 v[112:115], v[156:159], v[188:191], v[112:115]
ds_read_b64_tr_b16 v[164:165], v21 offset:0
v_mfma_f32_16x16x32_bf16 v[116:119], v[160:163], v[188:191], v[116:119]
ds_read_b64_tr_b16 v[166:167], v21 offset:512
v_mfma_f32_16x16x32_bf16 v[120:123], v[180:183], v[188:191], v[120:123]
v_mfma_f32_16x16x32_bf16 v[124:127], v[184:187], v[188:191], v[124:127]
ds_read_b64_tr_b16 v[168:169], v20 offset:1024
v_mfma_f32_16x16x32_bf16 v[244:247], v[28:31], v[188:191], v[244:247]
ds_read_b64_tr_b16 v[170:171], v20 offset:1536
s_waitcnt lgkmcnt(7)
v_mfma_f32_16x16x32_bf16 v[32:35], v[192:195], v[196:199], v[32:35]
s_waitcnt lgkmcnt(6)
v_mfma_f32_16x16x32_bf16 v[36:39], v[192:195], v[144:147], v[36:39]
s_waitcnt lgkmcnt(5)
v_mfma_f32_16x16x32_bf16 v[40:43], v[192:195], v[148:151], v[40:43]
s_waitcnt lgkmcnt(4)
v_mfma_f32_16x16x32_bf16 v[44:47], v[192:195], v[152:155], v[44:47]
ds_read_b64_tr_b16 v[172:173], v21 offset:1024
s_waitcnt lgkmcnt(3)
v_mfma_f32_16x16x32_bf16 v[48:51], v[164:167], v[196:199], v[48:51]
ds_read_b64_tr_b16 v[174:175], v21 offset:1536
v_mfma_f32_16x16x32_bf16 v[52:55], v[164:167], v[144:147], v[52:55]
v_mfma_f32_16x16x32_bf16 v[56:59], v[164:167], v[148:151], v[56:59]
v_mfma_f32_16x16x32_bf16 v[60:63], v[164:167], v[152:155], v[60:63]
v_mfma_f32_16x16x32_bf16 v[128:131], v[28:31], v[164:167], v[128:131]
ds_read_b64_tr_b16 v[176:177], v20 offset:2048
s_waitcnt lgkmcnt(3)
v_mfma_f32_16x16x32_bf16 v[64:67], v[168:171], v[196:199], v[64:67]
ds_read_b64_tr_b16 v[178:179], v20 offset:2560
v_mfma_f32_16x16x32_bf16 v[68:71], v[168:171], v[144:147], v[68:71]
v_mfma_f32_16x16x32_bf16 v[72:75], v[168:171], v[148:151], v[72:75]
v_mfma_f32_16x16x32_bf16 v[76:79], v[168:171], v[152:155], v[76:79]
v_mfma_f32_16x16x32_bf16 v[132:135], v[28:31], v[168:171], v[132:135]
ds_read_b64_tr_b16 v[156:157], v21 offset:2048
s_waitcnt lgkmcnt(3)
v_mfma_f32_16x16x32_bf16 v[80:83], v[172:175], v[196:199], v[80:83]
ds_read_b64_tr_b16 v[158:159], v21 offset:2560
v_mfma_f32_16x16x32_bf16 v[84:87], v[172:175], v[144:147], v[84:87]
v_mfma_f32_16x16x32_bf16 v[88:91], v[172:175], v[148:151], v[88:91]
v_mfma_f32_16x16x32_bf16 v[92:95], v[172:175], v[152:155], v[92:95]
v_mfma_f32_16x16x32_bf16 v[136:139], v[28:31], v[172:175], v[136:139]
ds_read_b64_tr_b16 v[160:161], v20 offset:12288
s_waitcnt lgkmcnt(3)
v_mfma_f32_16x16x32_bf16 v[96:99], v[196:199], v[176:179], v[96:99]
ds_read_b64_tr_b16 v[162:163], v20 offset:12800
v_mfma_f32_16x16x32_bf16 v[100:103], v[144:147], v[176:179], v[100:103]
ds_read_b128 v[180:183], v17 offset:0
v_mfma_f32_16x16x32_bf16 v[104:107], v[148:151], v[176:179], v[104:107]
ds_read_b128 v[184:187], v17 offset:2048
v_mfma_f32_16x16x32_bf16 v[108:111], v[152:155], v[176:179], v[108:111]
ds_read_b128 v[188:191], v17 offset:4096
v_mfma_f32_16x16x32_bf16 v[140:143], v[28:31], v[176:179], v[140:143]
ds_read_b128 v[192:195], v17 offset:6144
s_waitcnt lgkmcnt(6)
v_mfma_f32_16x16x32_bf16 v[112:115], v[196:199], v[156:159], v[112:115]
ds_read_b64_tr_b16 v[164:165], v21 offset:12288
v_mfma_f32_16x16x32_bf16 v[116:119], v[144:147], v[156:159], v[116:119]
ds_read_b64_tr_b16 v[166:167], v21 offset:12800
v_mfma_f32_16x16x32_bf16 v[120:123], v[148:151], v[156:159], v[120:123]
v_mfma_f32_16x16x32_bf16 v[124:127], v[152:155], v[156:159], v[124:127]
ds_read_b64_tr_b16 v[168:169], v20 offset:13312
v_mfma_f32_16x16x32_bf16 v[244:247], v[28:31], v[156:159], v[244:247]
ds_read_b64_tr_b16 v[170:171], v20 offset:13824
s_waitcnt lgkmcnt(7)
v_mfma_f32_16x16x32_bf16 v[32:35], v[160:163], v[180:183], v[32:35]
s_waitcnt lgkmcnt(6)
v_mfma_f32_16x16x32_bf16 v[36:39], v[160:163], v[184:187], v[36:39]
s_waitcnt lgkmcnt(5)
v_mfma_f32_16x16x32_bf16 v[40:43], v[160:163], v[188:191], v[40:43]
s_waitcnt lgkmcnt(4)
v_mfma_f32_16x16x32_bf16 v[44:47], v[160:163], v[192:195], v[44:47]
ds_read_b64_tr_b16 v[172:173], v21 offset:13312
s_waitcnt lgkmcnt(3)
v_mfma_f32_16x16x32_bf16 v[48:51], v[164:167], v[180:183], v[48:51]
ds_read_b64_tr_b16 v[174:175], v21 offset:13824
v_mfma_f32_16x16x32_bf16 v[52:55], v[164:167], v[184:187], v[52:55]
v_mfma_f32_16x16x32_bf16 v[56:59], v[164:167], v[188:191], v[56:59]
v_mfma_f32_16x16x32_bf16 v[60:63], v[164:167], v[192:195], v[60:63]
v_mfma_f32_16x16x32_bf16 v[128:131], v[28:31], v[164:167], v[128:131]
ds_read_b64_tr_b16 v[176:177], v20 offset:14336
s_waitcnt lgkmcnt(3)
v_mfma_f32_16x16x32_bf16 v[64:67], v[168:171], v[180:183], v[64:67]
ds_read_b64_tr_b16 v[178:179], v20 offset:14848
v_mfma_f32_16x16x32_bf16 v[68:71], v[168:171], v[184:187], v[68:71]
v_mfma_f32_16x16x32_bf16 v[72:75], v[168:171], v[188:191], v[72:75]
v_mfma_f32_16x16x32_bf16 v[76:79], v[168:171], v[192:195], v[76:79]
v_mfma_f32_16x16x32_bf16 v[132:135], v[28:31], v[168:171], v[132:135]
ds_read_b64_tr_b16 v[196:197], v21 offset:14336
s_waitcnt lgkmcnt(3)
v_mfma_f32_16x16x32_bf16 v[80:83], v[172:175], v[180:183], v[80:83]
ds_read_b64_tr_b16 v[198:199], v21 offset:14848
v_mfma_f32_16x16x32_bf16 v[84:87], v[172:175], v[184:187], v[84:87]
v_mfma_f32_16x16x32_bf16 v[88:91], v[172:175], v[188:191], v[88:91]
v_mfma_f32_16x16x32_bf16 v[92:95], v[172:175], v[192:195], v[92:95]
v_mfma_f32_16x16x32_bf16 v[136:139], v[28:31], v[172:175], v[136:139]
v_add_u32 v16, 0, v10
v_add_u32 v17, 0, v11
v_add_u32 v18, 0, v12
v_add_u32 v19, 0, v13
v_add_u32 v20, 0, v14
v_add_u32 v21, 0, v15
s_waitcnt lgkmcnt(0)
s_barrier
ds_read_b64_tr_b16 v[144:145], v20 offset:0
v_mfma_f32_16x16x32_bf16 v[96:99], v[180:183], v[176:179], v[96:99]
ds_read_b64_tr_b16 v[146:147], v20 offset:512
v_mfma_f32_16x16x32_bf16 v[100:103], v[184:187], v[176:179], v[100:103]
ds_read_b128 v[148:151], v16 offset:0
v_mfma_f32_16x16x32_bf16 v[104:107], v[188:191], v[176:179], v[104:107]
ds_read_b128 v[152:155], v16 offset:2048
v_mfma_f32_16x16x32_bf16 v[108:111], v[192:195], v[176:179], v[108:111]
ds_read_b128 v[156:159], v16 offset:4096
v_mfma_f32_16x16x32_bf16 v[140:143], v[28:31], v[176:179], v[140:143]
ds_read_b128 v[160:163], v16 offset:6144
v_mfma_f32_16x16x32_bf16 v[112:115], v[180:183], v[196:199], v[112:115]
ds_read_b64_tr_b16 v[164:165], v21 offset:0
v_mfma_f32_16x16x32_bf16 v[116:119], v[184:187], v[196:199], v[116:119]
ds_read_b64_tr_b16 v[166:167], v21 offset:512
v_mfma_f32_16x16x32_bf16 v[120:123], v[188:191], v[196:199], v[120:123]
v_mfma_f32_16x16x32_bf16 v[124:127], v[192:195], v[196:199], v[124:127]
ds_read_b64_tr_b16 v[168:169], v20 offset:1024
v_mfma_f32_16x16x32_bf16 v[244:247], v[28:31], v[196:199], v[244:247]
ds_read_b64_tr_b16 v[170:171], v20 offset:1536
s_waitcnt lgkmcnt(7)
v_mfma_f32_16x16x32_bf16 v[32:35], v[144:147], v[148:151], v[32:35]
s_waitcnt lgkmcnt(6)
v_mfma_f32_16x16x32_bf16 v[36:39], v[144:147], v[152:155], v[36:39]
s_waitcnt lgkmcnt(5)
v_mfma_f32_16x16x32_bf16 v[40:43], v[144:147], v[156:159], v[40:43]
s_waitcnt lgkmcnt(4)
v_mfma_f32_16x16x32_bf16 v[44:47], v[144:147], v[160:163], v[44:47]
ds_read_b64_tr_b16 v[172:173], v21 offset:1024
s_waitcnt lgkmcnt(3)
v_mfma_f32_16x16x32_bf16 v[48:51], v[164:167], v[148:151], v[48:51]
ds_read_b64_tr_b16 v[174:175], v21 offset:1536
v_mfma_f32_16x16x32_bf16 v[52:55], v[164:167], v[152:155], v[52:55]
v_mfma_f32_16x16x32_bf16 v[56:59], v[164:167], v[156:159], v[56:59]
v_mfma_f32_16x16x32_bf16 v[60:63], v[164:167], v[160:163], v[60:63]
v_mfma_f32_16x16x32_bf16 v[128:131], v[28:31], v[164:167], v[128:131]
ds_read_b64_tr_b16 v[176:177], v20 offset:2048
s_waitcnt lgkmcnt(3)
v_mfma_f32_16x16x32_bf16 v[64:67], v[168:171], v[148:151], v[64:67]
ds_read_b64_tr_b16 v[178:179], v20 offset:2560
v_mfma_f32_16x16x32_bf16 v[68:71], v[168:171], v[152:155], v[68:71]
v_mfma_f32_16x16x32_bf16 v[72:75], v[168:171], v[156:159], v[72:75]
v_mfma_f32_16x16x32_bf16 v[76:79], v[168:171], v[160:163], v[76:79]
v_mfma_f32_16x16x32_bf16 v[132:135], v[28:31], v[168:171], v[132:135]
ds_read_b64_tr_b16 v[180:181], v21 offset:2048
s_waitcnt lgkmcnt(3)
v_mfma_f32_16x16x32_bf16 v[80:83], v[172:175], v[148:151], v[80:83]
ds_read_b64_tr_b16 v[182:183], v21 offset:2560
v_mfma_f32_16x16x32_bf16 v[84:87], v[172:175], v[152:155], v[84:87]
v_mfma_f32_16x16x32_bf16 v[88:91], v[172:175], v[156:159], v[88:91]
v_mfma_f32_16x16x32_bf16 v[92:95], v[172:175], v[160:163], v[92:95]
v_mfma_f32_16x16x32_bf16 v[136:139], v[28:31], v[172:175], v[136:139]
ds_read_b64_tr_b16 v[184:185], v20 offset:12288
s_waitcnt lgkmcnt(3)
v_mfma_f32_16x16x32_bf16 v[96:99], v[148:151], v[176:179], v[96:99]
ds_read_b64_tr_b16 v[186:187], v20 offset:12800
v_mfma_f32_16x16x32_bf16 v[100:103], v[152:155], v[176:179], v[100:103]
ds_read_b128 v[188:191], v17 offset:0
v_mfma_f32_16x16x32_bf16 v[104:107], v[156:159], v[176:179], v[104:107]
ds_read_b128 v[192:195], v17 offset:2048
v_mfma_f32_16x16x32_bf16 v[108:111], v[160:163], v[176:179], v[108:111]
ds_read_b128 v[196:199], v17 offset:4096
v_mfma_f32_16x16x32_bf16 v[140:143], v[28:31], v[176:179], v[140:143]
ds_read_b128 v[144:147], v17 offset:6144
s_waitcnt lgkmcnt(6)
v_mfma_f32_16x16x32_bf16 v[112:115], v[148:151], v[180:183], v[112:115]
ds_read_b64_tr_b16 v[164:165], v21 offset:12288
v_mfma_f32_16x16x32_bf16 v[116:119], v[152:155], v[180:183], v[116:119]
ds_read_b64_tr_b16 v[166:167], v21 offset:12800
v_mfma_f32_16x16x32_bf16 v[120:123], v[156:159], v[180:183], v[120:123]
v_mfma_f32_16x16x32_bf16 v[124:127], v[160:163], v[180:183], v[124:127]
ds_read_b64_tr_b16 v[168:169], v20 offset:13312
v_mfma_f32_16x16x32_bf16 v[244:247], v[28:31], v[180:183], v[244:247]
ds_read_b64_tr_b16 v[170:171], v20 offset:13824
s_waitcnt lgkmcnt(7)
v_mfma_f32_16x16x32_bf16 v[32:35], v[184:187], v[188:191], v[32:35]
s_waitcnt lgkmcnt(6)
v_mfma_f32_16x16x32_bf16 v[36:39], v[184:187], v[192:195], v[36:39]
s_waitcnt lgkmcnt(5)
v_mfma_f32_16x16x32_bf16 v[40:43], v[184:187], v[196:199], v[40:43]
s_waitcnt lgkmcnt(4)
v_mfma_f32_16x16x32_bf16 v[44:47], v[184:187], v[144:147], v[44:47]
ds_read_b64_tr_b16 v[172:173], v21 offset:13312
s_waitcnt lgkmcnt(3)
v_mfma_f32_16x16x32_bf16 v[48:51], v[164:167], v[188:191], v[48:51]
ds_read_b64_tr_b16 v[174:175], v21 offset:13824
v_mfma_f32_16x16x32_bf16 v[52:55], v[164:167], v[192:195], v[52:55]
v_mfma_f32_16x16x32_bf16 v[56:59], v[164:167], v[196:199], v[56:59]
v_mfma_f32_16x16x32_bf16 v[60:63], v[164:167], v[144:147], v[60:63]
v_mfma_f32_16x16x32_bf16 v[128:131], v[28:31], v[164:167], v[128:131]
ds_read_b64_tr_b16 v[176:177], v20 offset:14336
s_waitcnt lgkmcnt(3)
v_mfma_f32_16x16x32_bf16 v[64:67], v[168:171], v[188:191], v[64:67]
ds_read_b64_tr_b16 v[178:179], v20 offset:14848
v_mfma_f32_16x16x32_bf16 v[68:71], v[168:171], v[192:195], v[68:71]
v_mfma_f32_16x16x32_bf16 v[72:75], v[168:171], v[196:199], v[72:75]
v_mfma_f32_16x16x32_bf16 v[76:79], v[168:171], v[144:147], v[76:79]
v_mfma_f32_16x16x32_bf16 v[132:135], v[28:31], v[168:171], v[132:135]
ds_read_b64_tr_b16 v[148:149], v21 offset:14336
s_waitcnt lgkmcnt(3)
v_mfma_f32_16x16x32_bf16 v[80:83], v[172:175], v[188:191], v[80:83]
ds_read_b64_tr_b16 v[150:151], v21 offset:14848
v_mfma_f32_16x16x32_bf16 v[84:87], v[172:175], v[192:195], v[84:87]
v_mfma_f32_16x16x32_bf16 v[88:91], v[172:175], v[196:199], v[88:91]
v_mfma_f32_16x16x32_bf16 v[92:95], v[172:175], v[144:147], v[92:95]
v_mfma_f32_16x16x32_bf16 v[136:139], v[28:31], v[172:175], v[136:139]
v_add_u32 v16, 86016, v10
v_add_u32 v17, 86016, v11
v_add_u32 v18, 86016, v12
v_add_u32 v19, 86016, v13
v_add_u32 v20, 86016, v14
v_add_u32 v21, 86016, v15
s_waitcnt lgkmcnt(0)
s_barrier
ds_read_b64_tr_b16 v[152:153], v20 offset:0
v_mfma_f32_16x16x32_bf16 v[96:99], v[188:191], v[176:179], v[96:99]
ds_read_b64_tr_b16 v[154:155], v20 offset:512
v_mfma_f32_16x16x32_bf16 v[100:103], v[192:195], v[176:179], v[100:103]
ds_read_b128 v[156:159], v16 offset:0
v_mfma_f32_16x16x32_bf16 v[104:107], v[196:199], v[176:179], v[104:107]
ds_read_b128 v[160:163], v16 offset:2048
v_mfma_f32_16x16x32_bf16 v[108:111], v[144:147], v[176:179], v[108:111]
ds_read_b128 v[180:183], v16 offset:4096
v_mfma_f32_16x16x32_bf16 v[140:143], v[28:31], v[176:179], v[140:143]
ds_read_b128 v[184:187], v16 offset:6144
v_mfma_f32_16x16x32_bf16 v[112:115], v[188:191], v[148:151], v[112:115]
ds_read_b64_tr_b16 v[164:165], v21 offset:0
v_mfma_f32_16x16x32_bf16 v[116:119], v[192:195], v[148:151], v[116:119]
ds_read_b64_tr_b16 v[166:167], v21 offset:512
v_mfma_f32_16x16x32_bf16 v[120:123], v[196:199], v[148:151], v[120:123]
v_mfma_f32_16x16x32_bf16 v[124:127], v[144:147], v[148:151], v[124:127]
ds_read_b64_tr_b16 v[168:169], v20 offset:1024
v_mfma_f32_16x16x32_bf16 v[244:247], v[28:31], v[148:151], v[244:247]
ds_read_b64_tr_b16 v[170:171], v20 offset:1536
s_waitcnt lgkmcnt(7)
v_mfma_f32_16x16x32_bf16 v[32:35], v[152:155], v[156:159], v[32:35]
s_waitcnt lgkmcnt(6)
v_mfma_f32_16x16x32_bf16 v[36:39], v[152:155], v[160:163], v[36:39]
s_waitcnt lgkmcnt(5)
v_mfma_f32_16x16x32_bf16 v[40:43], v[152:155], v[180:183], v[40:43]
s_waitcnt lgkmcnt(4)
v_mfma_f32_16x16x32_bf16 v[44:47], v[152:155], v[184:187], v[44:47]
ds_read_b64_tr_b16 v[172:173], v21 offset:1024
s_waitcnt lgkmcnt(3)
v_mfma_f32_16x16x32_bf16 v[48:51], v[164:167], v[156:159], v[48:51]
ds_read_b64_tr_b16 v[174:175], v21 offset:1536
v_mfma_f32_16x16x32_bf16 v[52:55], v[164:167], v[160:163], v[52:55]
v_mfma_f32_16x16x32_bf16 v[56:59], v[164:167], v[180:183], v[56:59]
v_mfma_f32_16x16x32_bf16 v[60:63], v[164:167], v[184:187], v[60:63]
v_mfma_f32_16x16x32_bf16 v[128:131], v[28:31], v[164:167], v[128:131]
ds_read_b64_tr_b16 v[176:177], v20 offset:2048
s_waitcnt lgkmcnt(3)
v_mfma_f32_16x16x32_bf16 v[64:67], v[168:171], v[156:159], v[64:67]
ds_read_b64_tr_b16 v[178:179], v20 offset:2560
v_mfma_f32_16x16x32_bf16 v[68:71], v[168:171], v[160:163], v[68:71]
v_mfma_f32_16x16x32_bf16 v[72:75], v[168:171], v[180:183], v[72:75]
v_mfma_f32_16x16x32_bf16 v[76:79], v[168:171], v[184:187], v[76:79]
v_mfma_f32_16x16x32_bf16 v[132:135], v[28:31], v[168:171], v[132:135]
ds_read_b64_tr_b16 v[188:189], v21 offset:2048
s_waitcnt lgkmcnt(3)
v_mfma_f32_16x16x32_bf16 v[80:83], v[172:175], v[156:159], v[80:83]
ds_read_b64_tr_b16 v[190:191], v21 offset:2560
v_mfma_f32_16x16x32_bf16 v[84:87], v[172:175], v[160:163], v[84:87]
v_mfma_f32_16x16x32_bf16 v[88:91], v[172:175], v[180:183], v[88:91]
v_mfma_f32_16x16x32_bf16 v[92:95], v[172:175], v[184:187], v[92:95]
v_mfma_f32_16x16x32_bf16 v[136:139], v[28:31], v[172:175], v[136:139]
ds_read_b64_tr_b16 v[192:193], v20 offset:12288
s_waitcnt lgkmcnt(3)
v_mfma_f32_16x16x32_bf16 v[96:99], v[156:159], v[176:179], v[96:99]
ds_read_b64_tr_b16 v[194:195], v20 offset:12800
v_mfma_f32_16x16x32_bf16 v[100:103], v[160:163], v[176:179], v[100:103]
ds_read_b128 v[196:199], v17 offset:0
v_mfma_f32_16x16x32_bf16 v[104:107], v[180:183], v[176:179], v[104:107]
ds_read_b128 v[144:147], v17 offset:2048
v_mfma_f32_16x16x32_bf16 v[108:111], v[184:187], v[176:179], v[108:111]
ds_read_b128 v[148:151], v17 offset:4096
v_mfma_f32_16x16x32_bf16 v[140:143], v[28:31], v[176:179], v[140:143]
ds_read_b128 v[152:155], v17 offset:6144
s_waitcnt lgkmcnt(6)
v_mfma_f32_16x16x32_bf16 v[112:115], v[156:159], v[188:191], v[112:115]
ds_read_b64_tr_b16 v[164:165], v21 offset:12288
v_mfma_f32_16x16x32_bf16 v[116:119], v[160:163], v[188:191], v[116:119]
ds_read_b64_tr_b16 v[166:167], v21 offset:12800
v_mfma_f32_16x16x32_bf16 v[120:123], v[180:183], v[188:191], v[120:123]
v_mfma_f32_16x16x32_bf16 v[124:127], v[184:187], v[188:191], v[124:127]
ds_read_b64_tr_b16 v[168:169], v20 offset:13312
v_mfma_f32_16x16x32_bf16 v[244:247], v[28:31], v[188:191], v[244:247]
ds_read_b64_tr_b16 v[170:171], v20 offset:13824
s_waitcnt lgkmcnt(7)
v_mfma_f32_16x16x32_bf16 v[32:35], v[192:195], v[196:199], v[32:35]
s_waitcnt lgkmcnt(6)
v_mfma_f32_16x16x32_bf16 v[36:39], v[192:195], v[144:147], v[36:39]
s_waitcnt lgkmcnt(5)
v_mfma_f32_16x16x32_bf16 v[40:43], v[192:195], v[148:151], v[40:43]
s_waitcnt lgkmcnt(4)
v_mfma_f32_16x16x32_bf16 v[44:47], v[192:195], v[152:155], v[44:47]
ds_read_b64_tr_b16 v[172:173], v21 offset:13312
s_waitcnt lgkmcnt(3)
v_mfma_f32_16x16x32_bf16 v[48:51], v[164:167], v[196:199], v[48:51]
ds_read_b64_tr_b16 v[174:175], v21 offset:13824
v_mfma_f32_16x16x32_bf16 v[52:55], v[164:167], v[144:147], v[52:55]
v_mfma_f32_16x16x32_bf16 v[56:59], v[164:167], v[148:151], v[56:59]
v_mfma_f32_16x16x32_bf16 v[60:63], v[164:167], v[152:155], v[60:63]
v_mfma_f32_16x16x32_bf16 v[128:131], v[28:31], v[164:167], v[128:131]
ds_read_b64_tr_b16 v[176:177], v20 offset:14336
s_waitcnt lgkmcnt(3)
v_mfma_f32_16x16x32_bf16 v[64:67], v[168:171], v[196:199], v[64:67]
ds_read_b64_tr_b16 v[178:179], v20 offset:14848
v_mfma_f32_16x16x32_bf16 v[68:71], v[168:171], v[144:147], v[68:71]
v_mfma_f32_16x16x32_bf16 v[72:75], v[168:171], v[148:151], v[72:75]
v_mfma_f32_16x16x32_bf16 v[76:79], v[168:171], v[152:155], v[76:79]
v_mfma_f32_16x16x32_bf16 v[132:135], v[28:31], v[168:171], v[132:135]
ds_read_b64_tr_b16 v[156:157], v21 offset:14336
s_waitcnt lgkmcnt(3)
v_mfma_f32_16x16x32_bf16 v[80:83], v[172:175], v[196:199], v[80:83]
ds_read_b64_tr_b16 v[158:159], v21 offset:14848
v_mfma_f32_16x16x32_bf16 v[84:87], v[172:175], v[144:147], v[84:87]
v_mfma_f32_16x16x32_bf16 v[88:91], v[172:175], v[148:151], v[88:91]
v_mfma_f32_16x16x32_bf16 v[92:95], v[172:175], v[152:155], v[92:95]
v_mfma_f32_16x16x32_bf16 v[136:139], v[28:31], v[172:175], v[136:139]
v_add_u32 v16, 43008, v10
v_add_u32 v17, 43008, v11
v_add_u32 v18, 43008, v12
v_add_u32 v19, 43008, v13
v_add_u32 v20, 43008, v14
v_add_u32 v21, 43008, v15
s_waitcnt lgkmcnt(0)
s_barrier
ds_read_b64_tr_b16 v[160:161], v20 offset:0
v_mfma_f32_16x16x32_bf16 v[96:99], v[196:199], v[176:179], v[96:99]
ds_read_b64_tr_b16 v[162:163], v20 offset:512
v_mfma_f32_16x16x32_bf16 v[100:103], v[144:147], v[176:179], v[100:103]
ds_read_b128 v[180:183], v16 offset:0
v_mfma_f32_16x16x32_bf16 v[104:107], v[148:151], v[176:179], v[104:107]
ds_read_b128 v[184:187], v16 offset:2048
v_mfma_f32_16x16x32_bf16 v[108:111], v[152:155], v[176:179], v[108:111]
ds_read_b128 v[188:191], v16 offset:4096
v_mfma_f32_16x16x32_bf16 v[140:143], v[28:31], v[176:179], v[140:143]
ds_read_b128 v[192:195], v16 offset:6144
v_mfma_f32_16x16x32_bf16 v[112:115], v[196:199], v[156:159], v[112:115]
ds_read_b64_tr_b16 v[164:165], v21 offset:0
v_mfma_f32_16x16x32_bf16 v[116:119], v[144:147], v[156:159], v[116:119]
ds_read_b64_tr_b16 v[166:167], v21 offset:512
v_mfma_f32_16x16x32_bf16 v[120:123], v[148:151], v[156:159], v[120:123]
v_mfma_f32_16x16x32_bf16 v[124:127], v[152:155], v[156:159], v[124:127]
ds_read_b64_tr_b16 v[168:169], v20 offset:1024
v_mfma_f32_16x16x32_bf16 v[244:247], v[28:31], v[156:159], v[244:247]
ds_read_b64_tr_b16 v[170:171], v20 offset:1536
s_waitcnt lgkmcnt(7)
v_mfma_f32_16x16x32_bf16 v[32:35], v[160:163], v[180:183], v[32:35]
s_waitcnt lgkmcnt(6)
v_mfma_f32_16x16x32_bf16 v[36:39], v[160:163], v[184:187], v[36:39]
s_waitcnt lgkmcnt(5)
v_mfma_f32_16x16x32_bf16 v[40:43], v[160:163], v[188:191], v[40:43]
s_waitcnt lgkmcnt(4)
v_mfma_f32_16x16x32_bf16 v[44:47], v[160:163], v[192:195], v[44:47]
ds_read_b64_tr_b16 v[172:173], v21 offset:1024
s_waitcnt lgkmcnt(3)
v_mfma_f32_16x16x32_bf16 v[48:51], v[164:167], v[180:183], v[48:51]
ds_read_b64_tr_b16 v[174:175], v21 offset:1536
v_mfma_f32_16x16x32_bf16 v[52:55], v[164:167], v[184:187], v[52:55]
v_mfma_f32_16x16x32_bf16 v[56:59], v[164:167], v[188:191], v[56:59]
v_mfma_f32_16x16x32_bf16 v[60:63], v[164:167], v[192:195], v[60:63]
v_mfma_f32_16x16x32_bf16 v[128:131], v[28:31], v[164:167], v[128:131]
ds_read_b64_tr_b16 v[176:177], v20 offset:2048
s_waitcnt lgkmcnt(3)
v_mfma_f32_16x16x32_bf16 v[64:67], v[168:171], v[180:183], v[64:67]
ds_read_b64_tr_b16 v[178:179], v20 offset:2560
v_mfma_f32_16x16x32_bf16 v[68:71], v[168:171], v[184:187], v[68:71]
v_mfma_f32_16x16x32_bf16 v[72:75], v[168:171], v[188:191], v[72:75]
v_mfma_f32_16x16x32_bf16 v[76:79], v[168:171], v[192:195], v[76:79]
v_mfma_f32_16x16x32_bf16 v[132:135], v[28:31], v[168:171], v[132:135]
ds_read_b64_tr_b16 v[196:197], v21 offset:2048
s_waitcnt lgkmcnt(3)
v_mfma_f32_16x16x32_bf16 v[80:83], v[172:175], v[180:183], v[80:83]
ds_read_b64_tr_b16 v[198:199], v21 offset:2560
v_mfma_f32_16x16x32_bf16 v[84:87], v[172:175], v[184:187], v[84:87]
v_mfma_f32_16x16x32_bf16 v[88:91], v[172:175], v[188:191], v[88:91]
v_mfma_f32_16x16x32_bf16 v[92:95], v[172:175], v[192:195], v[92:95]
v_mfma_f32_16x16x32_bf16 v[136:139], v[28:31], v[172:175], v[136:139]
ds_read_b64_tr_b16 v[144:145], v20 offset:12288
s_waitcnt lgkmcnt(3)
v_mfma_f32_16x16x32_bf16 v[96:99], v[180:183], v[176:179], v[96:99]
ds_read_b64_tr_b16 v[146:147], v20 offset:12800
v_mfma_f32_16x16x32_bf16 v[100:103], v[184:187], v[176:179], v[100:103]
ds_read_b128 v[148:151], v17 offset:0
v_mfma_f32_16x16x32_bf16 v[104:107], v[188:191], v[176:179], v[104:107]
ds_read_b128 v[152:155], v17 offset:2048
v_mfma_f32_16x16x32_bf16 v[108:111], v[192:195], v[176:179], v[108:111]
ds_read_b128 v[156:159], v17 offset:4096
v_mfma_f32_16x16x32_bf16 v[140:143], v[28:31], v[176:179], v[140:143]
ds_read_b128 v[160:163], v17 offset:6144
s_waitcnt lgkmcnt(6)
v_mfma_f32_16x16x32_bf16 v[112:115], v[180:183], v[196:199], v[112:115]
ds_read_b64_tr_b16 v[164:165], v21 offset:12288
v_mfma_f32_16x16x32_bf16 v[116:119], v[184:187], v[196:199], v[116:119]
ds_read_b64_tr_b16 v[166:167], v21 offset:12800
v_mfma_f32_16x16x32_bf16 v[120:123], v[188:191], v[196:199], v[120:123]
v_mfma_f32_16x16x32_bf16 v[124:127], v[192:195], v[196:199], v[124:127]
ds_read_b64_tr_b16 v[168:169], v20 offset:13312
v_mfma_f32_16x16x32_bf16 v[244:247], v[28:31], v[196:199], v[244:247]
ds_read_b64_tr_b16 v[170:171], v20 offset:13824
s_waitcnt lgkmcnt(7)
v_mfma_f32_16x16x32_bf16 v[32:35], v[144:147], v[148:151], v[32:35]
s_waitcnt lgkmcnt(6)
v_mfma_f32_16x16x32_bf16 v[36:39], v[144:147], v[152:155], v[36:39]
s_waitcnt lgkmcnt(5)
v_mfma_f32_16x16x32_bf16 v[40:43], v[144:147], v[156:159], v[40:43]
s_waitcnt lgkmcnt(4)
v_mfma_f32_16x16x32_bf16 v[44:47], v[144:147], v[160:163], v[44:47]
ds_read_b64_tr_b16 v[172:173], v21 offset:13312
s_waitcnt lgkmcnt(3)
v_mfma_f32_16x16x32_bf16 v[48:51], v[164:167], v[148:151], v[48:51]
ds_read_b64_tr_b16 v[174:175], v21 offset:13824
v_mfma_f32_16x16x32_bf16 v[52:55], v[164:167], v[152:155], v[52:55]
v_mfma_f32_16x16x32_bf16 v[56:59], v[164:167], v[156:159], v[56:59]
v_mfma_f32_16x16x32_bf16 v[60:63], v[164:167], v[160:163], v[60:63]
v_mfma_f32_16x16x32_bf16 v[128:131], v[28:31], v[164:167], v[128:131]
ds_read_b64_tr_b16 v[176:177], v20 offset:14336
s_waitcnt lgkmcnt(3)
v_mfma_f32_16x16x32_bf16 v[64:67], v[168:171], v[148:151], v[64:67]
ds_read_b64_tr_b16 v[178:179], v20 offset:14848
v_mfma_f32_16x16x32_bf16 v[68:71], v[168:171], v[152:155], v[68:71]
v_mfma_f32_16x16x32_bf16 v[72:75], v[168:171], v[156:159], v[72:75]
v_mfma_f32_16x16x32_bf16 v[76:79], v[168:171], v[160:163], v[76:79]
v_mfma_f32_16x16x32_bf16 v[132:135], v[28:31], v[168:171], v[132:135]
ds_read_b64_tr_b16 v[180:181], v21 offset:14336
s_waitcnt lgkmcnt(3)
v_mfma_f32_16x16x32_bf16 v[80:83], v[172:175], v[148:151], v[80:83]
ds_read_b64_tr_b16 v[182:183], v21 offset:14848
v_mfma_f32_16x16x32_bf16 v[84:87], v[172:175], v[152:155], v[84:87]
v_mfma_f32_16x16x32_bf16 v[88:91], v[172:175], v[156:159], v[88:91]
v_mfma_f32_16x16x32_bf16 v[92:95], v[172:175], v[160:163], v[92:95]
v_mfma_f32_16x16x32_bf16 v[136:139], v[28:31], v[172:175], v[136:139]
s_waitcnt lgkmcnt(2)
v_mfma_f32_16x16x32_bf16 v[96:99], v[148:151], v[176:179], v[96:99]
v_mfma_f32_16x16x32_bf16 v[100:103], v[152:155], v[176:179], v[100:103]
v_mfma_f32_16x16x32_bf16 v[104:107], v[156:159], v[176:179], v[104:107]
v_mfma_f32_16x16x32_bf16 v[108:111], v[160:163], v[176:179], v[108:111]
v_mfma_f32_16x16x32_bf16 v[140:143], v[28:31], v[176:179], v[140:143]
s_waitcnt lgkmcnt(0)
v_mfma_f32_16x16x32_bf16 v[112:115], v[148:151], v[180:183], v[112:115]
v_mfma_f32_16x16x32_bf16 v[116:119], v[152:155], v[180:183], v[116:119]
v_mfma_f32_16x16x32_bf16 v[120:123], v[156:159], v[180:183], v[120:123]
v_mfma_f32_16x16x32_bf16 v[124:127], v[160:163], v[180:183], v[124:127]
v_mfma_f32_16x16x32_bf16 v[244:247], v[28:31], v[180:183], v[244:247]
s_nop 6
ds_write_b32 v221, v128 offset:64
ds_write_b32 v221, v132 offset:256
ds_write_b32 v221, v136 offset:320
ds_write_b32 v221, v140 offset:512
ds_write_b32 v221, v244 offset:576
Lqj_36:
v_mov_b32_e64 v26, 1
s_waitcnt lgkmcnt(0)
ds_write_b32 v7, v26
s_mov_b32 s63, 0
Llw_37:
ds_read_b32 v27, v8
s_add_u32 s63, s63, 1
s_waitcnt lgkmcnt(0)
v_cmp_ne_u32 vcc, 0, v27
s_cbranch_vccnz Llk_38
s_cmp_lt_u32 s63, 0x100000
s_cbranch_scc1 Llw_37
Llk_38:
ds_read_b128 v[152:155], v220 offset:256
ds_read_b128 v[156:159], v220 offset:320
ds_read_b32 v162, v219 offset:0
ds_read_b32 v166, v219 offset:640
ds_read_b32 v163, v219 offset:64
ds_read_b32 v167, v219 offset:704
ds_read_b32 v164, v219 offset:128
ds_read_b32 v168, v219 offset:768
ds_read_b32 v165, v219 offset:192
ds_read_b32 v169, v219 offset:832
ds_read_b32 v160, v221 offset:512
ds_read_b32 v161, v221 offset:576
s_waitcnt lgkmcnt(2)
ds_read_b128 v[172:175], v218 offset:0
ds_read_b128 v[10:13], v218 offset:640
ds_read_b128 v[176:179], v218 offset:64
ds_read_b128 v[14:17], v218 offset:704
ds_read_b128 v[180:183], v218 offset:128
ds_read_b128 v[18:21], v218 offset:768
ds_read_b128 v[184:187], v218 offset:192
ds_read_b128 v[22:25], v218 offset:832
ds_read_b128 v[144:147], v220 offset:0
ds_read_b128 v[148:151], v220 offset:64
s_nop 0
v_pk_fma_f32 v[72:73], v[152:153], v[164:165], v[72:73] op_sel:[0,0,0] op_sel_hi:[1,0,1] neg_lo:[1,0,0] neg_hi:[1,0,0]
v_pk_fma_f32 v[74:75], v[154:155], v[164:165], v[74:75] op_sel:[0,0,0] op_sel_hi:[1,0,1] neg_lo:[1,0,0] neg_hi:[1,0,0]
v_pk_mul_f32 v[72:73], v[72:73], v[168:169] op_sel:[0,0] op_sel_hi:[1,0]
v_pk_mul_f32 v[74:75], v[74:75], v[168:169] op_sel:[0,0] op_sel_hi:[1,0]
v_pk_fma_f32 v[88:89], v[156:157], v[164:165], v[88:89] op_sel:[0,0,0] op_sel_hi:[1,0,1] neg_lo:[1,0,0] neg_hi:[1,0,0]
v_pk_fma_f32 v[90:91], v[158:159], v[164:165], v[90:91] op_sel:[0,0,0] op_sel_hi:[1,0,1] neg_lo:[1,0,0] neg_hi:[1,0,0]
v_pk_mul_f32 v[88:89], v[88:89], v[168:169] op_sel:[0,0] op_sel_hi:[1,0]
v_pk_mul_f32 v[90:91], v[90:91], v[168:169] op_sel:[0,0] op_sel_hi:[1,0]
v_cvt_pk_bf16_f32 v240, v72, v73
v_cvt_pk_bf16_f32 v241, v74, v75
v_cvt_pk_bf16_f32 v242, v88, v89
v_cvt_pk_bf16_f32 v243, v90, v91
v_pk_fma_f32 v[76:77], v[152:153], v[164:165], v[76:77] op_sel:[0,1,0] op_sel_hi:[1,1,1] neg_lo:[1,0,0] neg_hi:[1,0,0]
v_pk_fma_f32 v[78:79], v[154:155], v[164:165], v[78:79] op_sel:[0,1,0] op_sel_hi:[1,1,1] neg_lo:[1,0,0] neg_hi:[1,0,0]
v_pk_mul_f32 v[76:77], v[76:77], v[168:169] op_sel:[0,1] op_sel_hi:[1,1]
v_pk_mul_f32 v[78:79], v[78:79], v[168:169] op_sel:[0,1] op_sel_hi:[1,1]
v_pk_fma_f32 v[92:93], v[156:157], v[164:165], v[92:93] op_sel:[0,1,0] op_sel_hi:[1,1,1] neg_lo:[1,0,0] neg_hi:[1,0,0]
v_pk_fma_f32 v[94:95], v[158:159], v[164:165], v[94:95] op_sel:[0,1,0] op_sel_hi:[1,1,1] neg_lo:[1,0,0] neg_hi:[1,0,0]
v_pk_mul_f32 v[92:93], v[92:93], v[168:169] op_sel:[0,1] op_sel_hi:[1,1]
v_pk_mul_f32 v[94:95], v[94:95], v[168:169] op_sel:[0,1] op_sel_hi:[1,1]
v_cvt_pk_bf16_f32 v248, v76, v77
v_cvt_pk_bf16_f32 v249, v78, v79
v_cvt_pk_bf16_f32 v250, v92, v93
v_cvt_pk_bf16_f32 v251, v94, v95
v_pk_fma_f32 v[64:65], v[152:153], v[162:163], v[64:65] op_sel:[0,0,0] op_sel_hi:[1,0,1] neg_lo:[1,0,0] neg_hi:[1,0,0]
v_pk_fma_f32 v[66:67], v[154:155], v[162:163], v[66:67] op_sel:[0,0,0] op_sel_hi:[1,0,1] neg_lo:[1,0,0] neg_hi:[1,0,0]
v_pk_mul_f32 v[64:65], v[64:65], v[166:167] op_sel:[0,0] op_sel_hi:[1,0]
v_pk_mul_f32 v[66:67], v[66:67], v[166:167] op_sel:[0,0] op_sel_hi:[1,0]
v_pk_fma_f32 v[80:81], v[156:157], v[162:163], v[80:81] op_sel:[0,0,0] op_sel_hi:[1,0,1] neg_lo:[1,0,0] neg_hi:[1,0,0]
v_pk_fma_f32 v[82:83], v[158:159], v[162:163], v[82:83] op_sel:[0,0,0] op_sel_hi:[1,0,1] neg_lo:[1,0,0] neg_hi:[1,0,0]
v_pk_mul_f32 v[80:81], v[80:81], v[166:167] op_sel:[0,0] op_sel_hi:[1,0]
v_pk_mul_f32 v[82:83], v[82:83], v[166:167] op_sel:[0,0] op_sel_hi:[1,0]
v_cvt_pk_bf16_f32 v224, v64, v65
v_cvt_pk_bf16_f32 v225, v66, v67
v_cvt_pk_bf16_f32 v226, v80, v81
v_cvt_pk_bf16_f32 v227, v82, v83
v_pk_fma_f32 v[68:69], v[152:153], v[162:163], v[68:69] op_sel:[0,1,0] op_sel_hi:[1,1,1] neg_lo:[1,0,0] neg_hi:[1,0,0]
v_pk_fma_f32 v[70:71], v[154:155], v[162:163], v[70:71] op_sel:[0,1,0] op_sel_hi:[1,1,1] neg_lo:[1,0,0] neg_hi:[1,0,0]
v_pk_mul_f32 v[68:69], v[68:69], v[166:167] op_sel:[0,1] op_sel_hi:[1,1]
v_pk_mul_f32 v[70:71], v[70:71], v[166:167] op_sel:[0,1] op_sel_hi:[1,1]
v_pk_fma_f32 v[84:85], v[156:157], v[162:163], v[84:85] op_sel:[0,1,0] op_sel_hi:[1,1,1] neg_lo:[1,0,0] neg_hi:[1,0,0]
v_pk_fma_f32 v[86:87], v[158:159], v[162:163], v[86:87] op_sel:[0,1,0] op_sel_hi:[1,1,1] neg_lo:[1,0,0] neg_hi:[1,0,0]
v_pk_mul_f32 v[84:85], v[84:85], v[166:167] op_sel:[0,1] op_sel_hi:[1,1]
v_pk_mul_f32 v[86:87], v[86:87], v[166:167] op_sel:[0,1] op_sel_hi:[1,1]
v_cvt_pk_bf16_f32 v232, v68, v69
v_cvt_pk_bf16_f32 v233, v70, v71
v_cvt_pk_bf16_f32 v234, v84, v85
v_cvt_pk_bf16_f32 v235, v86, v87
s_waitcnt lgkmcnt(0)
s_nop 0
v_pk_fma_f32 v[104:105], v[180:181], v[160:161], v[104:105] op_sel:[0,0,0] op_sel_hi:[1,0,1] neg_lo:[1,0,0] neg_hi:[1,0,0]
v_pk_fma_f32 v[106:107], v[182:183], v[160:161], v[106:107] op_sel:[0,0,0] op_sel_hi:[1,0,1] neg_lo:[1,0,0] neg_hi:[1,0,0]
v_pk_mul_f32 v[104:105], v[104:105], v[18:19]
v_pk_mul_f32 v[106:107], v[106:107], v[20:21]
v_pk_fma_f32 v[120:121], v[180:181], v[160:161], v[120:121] op_sel:[0,1,0] op_sel_hi:[1,1,1] neg_lo:[1,0,0] neg_hi:[1,0,0]
v_pk_fma_f32 v[122:123], v[182:183], v[160:161], v[122:123] op_sel:[0,1,0] op_sel_hi:[1,1,1] neg_lo:[1,0,0] neg_hi:[1,0,0]
v_pk_mul_f32 v[120:121], v[120:121], v[18:19]
v_pk_mul_f32 v[122:123], v[122:123], v[20:21]
v_cvt_pk_bf16_f32 v244, v104, v105
v_cvt_pk_bf16_f32 v245, v106, v107
v_cvt_pk_bf16_f32 v246, v120, v121
v_cvt_pk_bf16_f32 v247, v122, v123
v_pk_fma_f32 v[108:109], v[184:185], v[160:161], v[108:109] op_sel:[0,0,0] op_sel_hi:[1,0,1] neg_lo:[1,0,0] neg_hi:[1,0,0]
v_pk_fma_f32 v[110:111], v[186:187], v[160:161], v[110:111] op_sel:[0,0,0] op_sel_hi:[1,0,1] neg_lo:[1,0,0] neg_hi:[1,0,0]
v_pk_mul_f32 v[108:109], v[108:109], v[22:23]
v_pk_mul_f32 v[110:111], v[110:111], v[24:25]
v_pk_fma_f32 v[124:125], v[184:185], v[160:161], v[124:125] op_sel:[0,1,0] op_sel_hi:[1,1,1] neg_lo:[1,0,0] neg_hi:[1,0,0]
v_pk_fma_f32 v[126:127], v[186:187], v[160:161], v[126:127] op_sel:[0,1,0] op_sel_hi:[1,1,1] neg_lo:[1,0,0] neg_hi:[1,0,0]
v_pk_mul_f32 v[124:125], v[124:125], v[22:23]
v_pk_mul_f32 v[126:127], v[126:127], v[24:25]
v_cvt_pk_bf16_f32 v252, v108, v109
v_cvt_pk_bf16_f32 v253, v110, v111
v_cvt_pk_bf16_f32 v254, v124, v125
v_cvt_pk_bf16_f32 v255, v126, v127
s_cmp_lg_u32 s5, 0
s_cbranch_scc1 Lx_39
ds_write_b128 v223, v[240:243] offset:0
ds_write_b128 v223, v[244:247] offset:1024
ds_write_b128 v223, v[248:251] offset:2048
ds_write_b128 v223, v[252:255] offset:3072
ds_write_b32 v9, v26
ds_read_b32 v26, v219 offset:512
ds_read_b32 v27, v219 offset:1152
ds_read_b128 v[188:191], v218 offset:512
ds_read_b128 v[192:195], v218 offset:1152
Lx_39:
v_pk_fma_f32 v[96:97], v[172:173], v[160:161], v[96:97] op_sel:[0,0,0] op_sel_hi:[1,0,1] neg_lo:[1,0,0] neg_hi:[1,0,0]
v_pk_fma_f32 v[98:99], v[174:175], v[160:161], v[98:99] op_sel:[0,0,0] op_sel_hi:[1,0,1] neg_lo:[1,0,0] neg_hi:[1,0,0]
v_pk_mul_f32 v[96:97], v[96:97], v[10:11]
v_pk_mul_f32 v[98:99], v[98:99], v[12:13]
v_pk_fma_f32 v[112:113], v[172:173], v[160:161], v[112:113] op_sel:[0,1,0] op_sel_hi:[1,1,1] neg_lo:[1,0,0] neg_hi:[1,0,0]
v_pk_fma_f32 v[114:115], v[174:175], v[160:161], v[114:115] op_sel:[0,1,0] op_sel_hi:[1,1,1] neg_lo:[1,0,0] neg_hi:[1,0,0]
v_pk_mul_f32 v[112:113], v[112:113], v[10:11]
v_pk_mul_f32 v[114:115], v[114:115], v[12:13]
v_cvt_pk_bf16_f32 v228, v96, v97
v_cvt_pk_bf16_f32 v229, v98, v99
v_cvt_pk_bf16_f32 v230, v112, v113
v_cvt_pk_bf16_f32 v231, v114, v115
v_pk_fma_f32 v[100:101], v[176:177], v[160:161], v[100:101] op_sel:[0,0,0] op_sel_hi:[1,0,1] neg_lo:[1,0,0] neg_hi:[1,0,0]
v_pk_fma_f32 v[102:103], v[178:179], v[160:161], v[102:103] op_sel:[0,0,0] op_sel_hi:[1,0,1] neg_lo:[1,0,0] neg_hi:[1,0,0]
v_pk_mul_f32 v[100:101], v[100:101], v[14:15]
v_pk_mul_f32 v[102:103], v[102:103], v[16:17]
v_pk_fma_f32 v[116:117], v[176:177], v[160:161], v[116:117] op_sel:[0,1,0] op_sel_hi:[1,1,1] neg_lo:[1,0,0] neg_hi:[1,0,0]
v_pk_fma_f32 v[118:119], v[178:179], v[160:161], v[118:119] op_sel:[0,1,0] op_sel_hi:[1,1,1] neg_lo:[1,0,0] neg_hi:[1,0,0]
v_pk_mul_f32 v[116:117], v[116:117], v[14:15]
v_pk_mul_f32 v[118:119], v[118:119], v[16:17]
v_cvt_pk_bf16_f32 v236, v100, v101
v_cvt_pk_bf16_f32 v237, v102, v103
v_cvt_pk_bf16_f32 v238, v116, v117
v_cvt_pk_bf16_f32 v239, v118, v119
s_cmp_lg_u32 s5, 0
s_cbranch_scc1 Lnh_40
s_waitcnt lgkmcnt(0)
s_nop 0
v_pk_fma_f32 v[128:129], v[152:153], v[26:27], v[128:129] op_sel:[0,0,0] op_sel_hi:[1,0,1] neg_lo:[1,0,0] neg_hi:[1,0,0]
v_pk_fma_f32 v[130:131], v[154:155], v[26:27], v[130:131] op_sel:[0,0,0] op_sel_hi:[1,0,1] neg_lo:[1,0,0] neg_hi:[1,0,0]
v_pk_mul_f32 v[128:129], v[128:129], v[26:27] op_sel:[0,1] op_sel_hi:[1,1]
v_pk_mul_f32 v[130:131], v[130:131], v[26:27] op_sel:[0,1] op_sel_hi:[1,1]
v_pk_fma_f32 v[136:137], v[188:189], v[160:161], v[136:137] op_sel:[0,0,0] op_sel_hi:[1,0,1] neg_lo:[1,0,0] neg_hi:[1,0,0]
v_pk_fma_f32 v[138:139], v[190:191], v[160:161], v[138:139] op_sel:[0,0,0] op_sel_hi:[1,0,1] neg_lo:[1,0,0] neg_hi:[1,0,0]
v_pk_mul_f32 v[136:137], v[136:137], v[192:193]
v_pk_mul_f32 v[138:139], v[138:139], v[194:195]
v_pk_fma_f32 v[132:133], v[156:157], v[26:27], v[132:133] op_sel:[0,0,0] op_sel_hi:[1,0,1] neg_lo:[1,0,0] neg_hi:[1,0,0]
v_pk_fma_f32 v[134:135], v[158:159], v[26:27], v[134:135] op_sel:[0,0,0] op_sel_hi:[1,0,1] neg_lo:[1,0,0] neg_hi:[1,0,0]
v_pk_mul_f32 v[132:133], v[132:133], v[26:27] op_sel:[0,1] op_sel_hi:[1,1]
v_pk_mul_f32 v[134:135], v[134:135], v[26:27] op_sel:[0,1] op_sel_hi:[1,1]
v_pk_fma_f32 v[140:141], v[188:189], v[160:161], v[140:141] op_sel:[0,1,0] op_sel_hi:[1,1,1] neg_lo:[1,0,0] neg_hi:[1,0,0]
v_pk_fma_f32 v[142:143], v[190:191], v[160:161], v[142:143] op_sel:[0,1,0] op_sel_hi:[1,1,1] neg_lo:[1,0,0] neg_hi:[1,0,0]
v_pk_mul_f32 v[140:141], v[140:141], v[192:193]
v_pk_mul_f32 v[142:143], v[142:143], v[194:195]
v_cvt_pk_bf16_f32 v64, v128, v129
v_cvt_pk_bf16_f32 v65, v130, v131
v_cvt_pk_bf16_f32 v68, v136, v137
v_cvt_pk_bf16_f32 v69, v138, v139
v_cvt_pk_bf16_f32 v72, v128, v129
v_cvt_pk_bf16_f32 v73, v130, v131
v_cvt_pk_bf16_f32 v76, v136, v137
v_cvt_pk_bf16_f32 v77, v138, v139
v_cvt_pk_bf16_f32 v66, v132, v133
v_cvt_pk_bf16_f32 v67, v134, v135
v_cvt_pk_bf16_f32 v70, v140, v141
v_cvt_pk_bf16_f32 v71, v142, v143
v_cvt_pk_bf16_f32 v74, v132, v133
v_cvt_pk_bf16_f32 v75, v134, v135
v_cvt_pk_bf16_f32 v78, v140, v141
v_cvt_pk_bf16_f32 v79, v142, v143
Lnh_40:
v_pk_fma_f32 v[32:33], v[144:145], v[162:163], v[32:33] op_sel:[0,0,0] op_sel_hi:[1,0,1] neg_lo:[1,0,0] neg_hi:[1,0,0]
v_pk_fma_f32 v[34:35], v[146:147], v[162:163], v[34:35] op_sel:[0,0,0] op_sel_hi:[1,0,1] neg_lo:[1,0,0] neg_hi:[1,0,0]
v_pk_fma_f32 v[36:37], v[144:145], v[162:163], v[36:37] op_sel:[0,1,0] op_sel_hi:[1,1,1] neg_lo:[1,0,0] neg_hi:[1,0,0]
v_pk_fma_f32 v[38:39], v[146:147], v[162:163], v[38:39] op_sel:[0,1,0] op_sel_hi:[1,1,1] neg_lo:[1,0,0] neg_hi:[1,0,0]
v_pk_fma_f32 v[40:41], v[144:145], v[164:165], v[40:41] op_sel:[0,0,0] op_sel_hi:[1,0,1] neg_lo:[1,0,0] neg_hi:[1,0,0]
v_pk_fma_f32 v[42:43], v[146:147], v[164:165], v[42:43] op_sel:[0,0,0] op_sel_hi:[1,0,1] neg_lo:[1,0,0] neg_hi:[1,0,0]
v_pk_fma_f32 v[44:45], v[144:145], v[164:165], v[44:45] op_sel:[0,1,0] op_sel_hi:[1,1,1] neg_lo:[1,0,0] neg_hi:[1,0,0]
v_pk_fma_f32 v[46:47], v[146:147], v[164:165], v[46:47] op_sel:[0,1,0] op_sel_hi:[1,1,1] neg_lo:[1,0,0] neg_hi:[1,0,0]
v_pk_fma_f32 v[48:49], v[148:149], v[162:163], v[48:49] op_sel:[0,0,0] op_sel_hi:[1,0,1] neg_lo:[1,0,0] neg_hi:[1,0,0]
v_pk_fma_f32 v[50:51], v[150:151], v[162:163], v[50:51] op_sel:[0,0,0] op_sel_hi:[1,0,1] neg_lo:[1,0,0] neg_hi:[1,0,0]
v_pk_fma_f32 v[52:53], v[148:149], v[162:163], v[52:53] op_sel:[0,1,0] op_sel_hi:[1,1,1] neg_lo:[1,0,0] neg_hi:[1,0,0]
v_pk_fma_f32 v[54:55], v[150:151], v[162:163], v[54:55] op_sel:[0,1,0] op_sel_hi:[1,1,1] neg_lo:[1,0,0] neg_hi:[1,0,0]
v_pk_fma_f32 v[56:57], v[148:149], v[164:165], v[56:57] op_sel:[0,0,0] op_sel_hi:[1,0,1] neg_lo:[1,0,0] neg_hi:[1,0,0]
v_pk_fma_f32 v[58:59], v[150:151], v[164:165], v[58:59] op_sel:[0,0,0] op_sel_hi:[1,0,1] neg_lo:[1,0,0] neg_hi:[1,0,0]
v_pk_fma_f32 v[60:61], v[148:149], v[164:165], v[60:61] op_sel:[0,1,0] op_sel_hi:[1,1,1] neg_lo:[1,0,0] neg_hi:[1,0,0]
v_pk_fma_f32 v[62:63], v[150:151], v[164:165], v[62:63] op_sel:[0,1,0] op_sel_hi:[1,1,1] neg_lo:[1,0,0] neg_hi:[1,0,0]
v_cvt_pk_bf16_f32 v96, v32, v33
v_cvt_pk_bf16_f32 v97, v34, v35
v_cvt_pk_bf16_f32 v98, v36, v37
v_cvt_pk_bf16_f32 v99, v38, v39
v_cvt_pk_bf16_f32 v100, v40, v41
v_cvt_pk_bf16_f32 v101, v42, v43
v_cvt_pk_bf16_f32 v102, v44, v45
v_cvt_pk_bf16_f32 v103, v46, v47
v_cvt_pk_bf16_f32 v104, v48, v49
v_cvt_pk_bf16_f32 v105, v50, v51
v_cvt_pk_bf16_f32 v106, v52, v53
v_cvt_pk_bf16_f32 v107, v54, v55
v_cvt_pk_bf16_f32 v108, v56, v57
v_cvt_pk_bf16_f32 v109, v58, v59
v_cvt_pk_bf16_f32 v110, v60, v61
v_cvt_pk_bf16_f32 v111, v62, v63
v_mul_f32 v10, 0x3eb8aa3b, v166
v_mul_f32 v11, 0x3eb8aa3b, v167
v_mul_f32 v12, 0x3eb8aa3b, v168
v_mul_f32 v13, 0x3eb8aa3b, v169
v_mov_b32 v14, 0x3f803f80
v_mov_b32 v15, 0x3f803f80
s_cmp_eq_u32 s5, 0
s_cbranch_scc1 Lp_41
s_mov_b32 s63, 0
Llw_42:
ds_read_b32 v27, v9
s_add_u32 s63, s63, 1
s_waitcnt lgkmcnt(0)
v_cmp_ne_u32 vcc, 0, v27
s_cbranch_vccnz Llk_43
s_cmp_lt_u32 s63, 0x100000
s_cbranch_scc1 Llw_42
Llk_43:
ds_read_b128 v[64:67], v223 offset:0
ds_read_b128 v[68:71], v223 offset:1024
ds_read_b128 v[72:75], v223 offset:2048
ds_read_b128 v[76:79], v223 offset:3072
Lp_41:
v_mfma_f32_16x16x16_bf16 v[112:115], v[224:225], v[96:97], v[200:203]
v_mfma_f32_16x16x16_bf16 v[116:119], v[232:233], v[98:99], v[200:203]
v_mfma_f32_16x16x16_bf16 v[120:123], v[240:241], v[100:101], v[200:203]
v_mfma_f32_16x16x16_bf16 v[124:127], v[248:249], v[102:103], v[200:203]
v_mfma_f32_16x16x16_bf16 v[128:131], v[226:227], v[104:105], v[200:203]
v_mfma_f32_16x16x16_bf16 v[132:135], v[234:235], v[106:107], v[200:203]
v_mfma_f32_16x16x16_bf16 v[136:139], v[242:243], v[108:109], v[200:203]
v_mfma_f32_16x16x16_bf16 v[140:143], v[250:251], v[110:111], v[200:203]
v_mfma_f32_16x16x16_bf16 v[152:155], v[224:225], v[100:101], v[204:207]
v_mfma_f32_16x16x16_bf16 v[156:159], v[232:233], v[102:103], v[204:207]
v_mfma_f32_16x16x16_bf16 v[168:171], v[226:227], v[108:109], v[204:207]
v_mfma_f32_16x16x16_bf16 v[172:175], v[234:235], v[110:111], v[204:207]
s_waitcnt lgkmcnt(0)
v_mfma_f32_16x16x16_bf16 v[144:147], v[64:65], v[96:97], v[208:211]
v_mfma_f32_16x16x16_bf16 v[148:151], v[72:73], v[98:99], v[212:215]
v_mfma_f32_16x16x16_bf16 v[160:163], v[66:67], v[104:105], v[208:211]
v_mfma_f32_16x16x16_bf16 v[164:167], v[74:75], v[106:107], v[212:215]
v_max_f32 v120, v120, v152
v_max_f32 v121, v121, v153
v_max_f32 v122, v122, v154
v_max_f32 v123, v123, v155
v_max_f32 v124, v124, v156
v_max_f32 v125, v125, v157
v_max_f32 v126, v126, v158
v_max_f32 v127, v127, v159
v_max_f32 v136, v136, v168
v_max_f32 v137, v137, v169
v_max_f32 v138, v138, v170
v_max_f32 v139, v139, v171
v_max_f32 v140, v140, v172
v_max_f32 v141, v141, v173
v_max_f32 v142, v142, v174
v_max_f32 v143, v143, v175
v_max_f32 v112, v112, v144
v_max_f32 v113, v113, v145
v_max_f32 v114, v114, v146
v_max_f32 v115, v115, v147
v_max_f32 v116, v116, v148
v_max_f32 v117, v117, v149
v_max_f32 v118, v118, v150
v_max_f32 v119, v119, v151
v_max_f32 v128, v128, v160
v_max_f32 v129, v129, v161
v_max_f32 v130, v130, v162
v_max_f32 v131, v131, v163
v_max_f32 v132, v132, v164
v_max_f32 v133, v133, v165
v_max_f32 v134, v134, v166
v_max_f32_e64 v135, v135, v167
v_max3_f32 v32, v112, v113, v114
v_max3_f32 v33, v116, v117, v118
v_max3_f32 v34, v120, v121, v122
v_max3_f32 v35, v124, v125, v126
v_max3_f32 v36, v128, v129, v130
v_max3_f32 v37, v132, v133, v134
v_max3_f32 v38, v136, v137, v138
v_max3_f32 v39, v140, v141, v142
v_max_f32 v32, v32, v115
v_max_f32 v33, v33, v119
v_max_f32 v34, v34, v123
v_max_f32 v35, v35, v127
v_max_f32 v36, v36, v131
v_max_f32 v37, v37, v135
v_max_f32 v38, v38, v139
v_max_f32 v39, v39, v143
s_nop 0
v_permlane32_swap_b32 v32, v33
v_permlane32_swap_b32 v34, v35
v_permlane32_swap_b32 v36, v37
v_permlane32_swap_b32 v38, v39
v_max_f32 v32, v32, v33
v_max_f32 v34, v34, v35
v_max_f32 v36, v36, v37
v_max_f32 v38, v38, v39
s_nop 0
v_permlane16_swap_b32 v32, v34
v_permlane16_swap_b32 v36, v38
v_max_f32 v32, v32, v34
v_max_f32 v36, v36, v38
v_mov_b32 v34, v32
v_mov_b32 v38, v36
s_nop 1
v_permlane16_swap_b32 v32, v34
v_permlane16_swap_b32 v36, v38
v_mov_b32 v33, v32
v_mov_b32 v35, v34
v_mov_b32 v37, v36
v_mov_b32 v39, v38
s_nop 0
v_permlane32_swap_b32 v32, v33
v_permlane32_swap_b32 v34, v35
v_permlane32_swap_b32 v36, v37
v_permlane32_swap_b32 v38, v39
v_pk_mul_f32 v[32:33], v[32:33], v[10:11]
v_pk_mul_f32 v[34:35], v[34:35], v[12:13]
v_pk_mul_f32 v[36:37], v[36:37], v[10:11]
v_pk_mul_f32 v[38:39], v[38:39], v[12:13]
v_pk_fma_f32 v[112:113], v[112:113], v[10:11], v[32:33] op_sel:[0,0,0] op_sel_hi:[1,0,0] neg_lo:[0,0,1] neg_hi:[0,0,1]
v_pk_fma_f32 v[114:115], v[114:115], v[10:11], v[32:33] op_sel:[0,0,0] op_sel_hi:[1,0,0] neg_lo:[0,0,1] neg_hi:[0,0,1]
v_pk_fma_f32 v[116:117], v[116:117], v[10:11], v[32:33] op_sel:[0,1,1] op_sel_hi:[1,1,1] neg_lo:[0,0,1] neg_hi:[0,0,1]
v_pk_fma_f32 v[118:119], v[118:119], v[10:11], v[32:33] op_sel:[0,1,1] op_sel_hi:[1,1,1] neg_lo:[0,0,1] neg_hi:[0,0,1]
v_pk_fma_f32 v[120:121], v[120:121], v[12:13], v[34:35] op_sel:[0,0,0] op_sel_hi:[1,0,0] neg_lo:[0,0,1] neg_hi:[0,0,1]
v_pk_fma_f32 v[122:123], v[122:123], v[12:13], v[34:35] op_sel:[0,0,0] op_sel_hi:[1,0,0] neg_lo:[0,0,1] neg_hi:[0,0,1]
v_pk_fma_f32 v[124:125], v[124:125], v[12:13], v[34:35] op_sel:[0,1,1] op_sel_hi:[1,1,1] neg_lo:[0,0,1] neg_hi:[0,0,1]
v_pk_fma_f32 v[126:127], v[126:127], v[12:13], v[34:35] op_sel:[0,1,1] op_sel_hi:[1,1,1] neg_lo:[0,0,1] neg_hi:[0,0,1]
v_pk_fma_f32 v[128:129], v[128:129], v[10:11], v[36:37] op_sel:[0,0,0] op_sel_hi:[1,0,0] neg_lo:[0,0,1] neg_hi:[0,0,1]
v_pk_fma_f32 v[130:131], v[130:131], v[10:11], v[36:37] op_sel:[0,0,0] op_sel_hi:[1,0,0] neg_lo:[0,0,1] neg_hi:[0,0,1]
v_pk_fma_f32 v[132:133], v[132:133], v[10:11], v[36:37] op_sel:[0,1,1] op_sel_hi:[1,1,1] neg_lo:[0,0,1] neg_hi:[0,0,1]
v_pk_fma_f32 v[134:135], v[134:135], v[10:11], v[36:37] op_sel:[0,1,1] op_sel_hi:[1,1,1] neg_lo:[0,0,1] neg_hi:[0,0,1]
v_pk_fma_f32 v[136:137], v[136:137], v[12:13], v[38:39] op_sel:[0,0,0] op_sel_hi:[1,0,0] neg_lo:[0,0,1] neg_hi:[0,0,1]
v_pk_fma_f32 v[138:139], v[138:139], v[12:13], v[38:39] op_sel:[0,0,0] op_sel_hi:[1,0,0] neg_lo:[0,0,1] neg_hi:[0,0,1]
v_pk_fma_f32 v[140:141], v[140:141], v[12:13], v[38:39] op_sel:[0,1,1] op_sel_hi:[1,1,1] neg_lo:[0,0,1] neg_hi:[0,0,1]
v_pk_fma_f32 v[142:143], v[142:143], v[12:13], v[38:39] op_sel:[0,1,1] op_sel_hi:[1,1,1] neg_lo:[0,0,1] neg_hi:[0,0,1]
v_exp_f32 v112, v112
v_exp_f32 v113, v113
v_exp_f32 v114, v114
v_exp_f32 v115, v115
v_exp_f32 v116, v116
v_exp_f32 v117, v117
v_exp_f32 v118, v118
v_exp_f32 v119, v119
v_exp_f32 v120, v120
v_exp_f32 v121, v121
v_exp_f32 v122, v122
v_exp_f32 v123, v123
v_exp_f32 v124, v124
v_exp_f32 v125, v125
v_exp_f32 v126, v126
v_exp_f32 v127, v127
v_exp_f32 v128, v128
v_exp_f32 v129, v129
v_exp_f32 v130, v130
v_exp_f32 v131, v131
v_exp_f32 v132, v132
v_exp_f32 v133, v133
v_exp_f32 v134, v134
v_exp_f32 v135, v135
v_exp_f32 v136, v136
v_exp_f32 v137, v137
v_exp_f32 v138, v138
v_exp_f32 v139, v139
v_exp_f32 v140, v140
v_exp_f32 v141, v141
v_exp_f32 v142, v142
v_exp_f32 v143, v143
v_cvt_pk_bf16_f32 v160, v112, v113
v_cvt_pk_bf16_f32 v161, v114, v115
v_cvt_pk_bf16_f32 v162, v116, v117
v_cvt_pk_bf16_f32 v163, v118, v119
v_cvt_pk_bf16_f32 v164, v120, v121
v_cvt_pk_bf16_f32 v165, v122, v123
v_cvt_pk_bf16_f32 v166, v124, v125
v_cvt_pk_bf16_f32 v167, v126, v127
v_cvt_pk_bf16_f32 v168, v128, v129
v_cvt_pk_bf16_f32 v169, v130, v131
v_cvt_pk_bf16_f32 v170, v132, v133
v_cvt_pk_bf16_f32 v171, v134, v135
v_cvt_pk_bf16_f32 v172, v136, v137
v_cvt_pk_bf16_f32 v173, v138, v139
v_cvt_pk_bf16_f32 v174, v140, v141
v_cvt_pk_bf16_f32 v175, v142, v143
v_mfma_f32_16x16x16_bf16 v[112:115], v[14:15], v[160:161], 0
v_and_b32 v144, v216, v160
v_and_b32 v145, v217, v161
v_mfma_f32_16x16x16_bf16 v[116:119], v[14:15], v[162:163], 0
v_and_b32 v146, v216, v162
v_and_b32 v147, v217, v163
v_mfma_f32_16x16x16_bf16 v[120:123], v[14:15], v[164:165], 0
v_and_b32 v148, v216, v164
v_and_b32 v149, v217, v165
v_mfma_f32_16x16x16_bf16 v[124:127], v[14:15], v[166:167], 0
v_and_b32 v150, v216, v166
v_and_b32 v151, v217, v167
v_mfma_f32_16x16x16_bf16 v[128:131], v[14:15], v[168:169], 0
v_and_b32 v152, v216, v168
v_and_b32 v153, v217, v169
v_mfma_f32_16x16x16_bf16 v[132:135], v[14:15], v[170:171], 0
v_and_b32 v154, v216, v170
v_and_b32 v155, v217, v171
v_mfma_f32_16x16x16_bf16 v[136:139], v[14:15], v[172:173], 0
v_and_b32 v156, v216, v172
v_and_b32 v157, v217, v173
v_mfma_f32_16x16x16_bf16 v[140:143], v[14:15], v[174:175], 0
v_and_b32 v158, v216, v174
v_and_b32 v159, v217, v175
v_xor_b32 v160, v144, v160
v_xor_b32 v161, v145, v161
v_mfma_f32_16x16x16_bf16 v[176:179], v[228:229], v[144:145], 0
v_xor_b32 v162, v146, v162
v_xor_b32 v163, v147, v163
v_mfma_f32_16x16x16_bf16 v[180:183], v[236:237], v[146:147], 0
v_xor_b32 v164, v148, v164
v_xor_b32 v165, v149, v165
v_mfma_f32_16x16x16_bf16 v[184:187], v[244:245], v[148:149], 0
v_xor_b32 v166, v150, v166
v_xor_b32 v167, v151, v167
v_mfma_f32_16x16x16_bf16 v[188:191], v[252:253], v[150:151], 0
v_xor_b32 v168, v152, v168
v_xor_b32 v169, v153, v169
v_mfma_f32_16x16x16_bf16 v[192:195], v[230:231], v[152:153], 0
v_xor_b32 v170, v154, v170
v_xor_b32 v171, v155, v171
v_mfma_f32_16x16x16_bf16 v[196:199], v[238:239], v[154:155], 0
v_xor_b32 v172, v156, v172
v_xor_b32 v173, v157, v173
v_mfma_f32_16x16x16_bf16 v[200:203], v[246:247], v[156:157], 0
v_xor_b32 v174, v158, v174
v_xor_b32 v175, v159, v175
v_mfma_f32_16x16x16_bf16 v[204:207], v[254:255], v[158:159], 0
v_mfma_f32_16x16x16_bf16 v[176:179], v[68:69], v[160:161], v[176:179]
v_rcp_f32_e64 v32, v112
v_mfma_f32_16x16x16_bf16 v[180:183], v[76:77], v[162:163], v[180:183]
v_rcp_f32_e64 v33, v116
v_mfma_f32_16x16x16_bf16 v[184:187], v[228:229], v[164:165], v[184:187]
v_rcp_f32_e64 v34, v120
v_mfma_f32_16x16x16_bf16 v[188:191], v[236:237], v[166:167], v[188:191]
v_rcp_f32_e64 v35, v124
v_mfma_f32_16x16x16_bf16 v[192:195], v[70:71], v[168:169], v[192:195]
v_rcp_f32_e64 v36, v128
v_mfma_f32_16x16x16_bf16 v[196:199], v[78:79], v[170:171], v[196:199]
v_rcp_f32_e64 v37, v132
v_mfma_f32_16x16x16_bf16 v[200:203], v[230:231], v[172:173], v[200:203]
v_rcp_f32_e64 v38, v136
v_mfma_f32_16x16x16_bf16 v[204:207], v[238:239], v[174:175], v[204:207]
v_rcp_f32 v39, v140
s_nop 1
v_pk_mul_f32 v[176:177], v[176:177], v[32:33] op_sel:[0,0] op_sel_hi:[1,0]
v_pk_mul_f32 v[178:179], v[178:179], v[32:33] op_sel:[0,0] op_sel_hi:[1,0]
v_pk_mul_f32 v[180:181], v[180:181], v[32:33] op_sel:[0,1] op_sel_hi:[1,1]
v_pk_mul_f32 v[182:183], v[182:183], v[32:33] op_sel:[0,1] op_sel_hi:[1,1]
v_pk_mul_f32 v[184:185], v[184:185], v[34:35] op_sel:[0,0] op_sel_hi:[1,0]
v_pk_mul_f32 v[186:187], v[186:187], v[34:35] op_sel:[0,0] op_sel_hi:[1,0]
v_pk_mul_f32 v[188:189], v[188:189], v[34:35] op_sel:[0,1] op_sel_hi:[1,1]
v_pk_mul_f32 v[190:191], v[190:191], v[34:35] op_sel:[0,1] op_sel_hi:[1,1]
v_pk_mul_f32 v[192:193], v[192:193], v[36:37] op_sel:[0,0] op_sel_hi:[1,0]
v_pk_mul_f32 v[194:195], v[194:195], v[36:37] op_sel:[0,0] op_sel_hi:[1,0]
v_pk_mul_f32 v[196:197], v[196:197], v[36:37] op_sel:[0,1] op_sel_hi:[1,1]
v_pk_mul_f32 v[198:199], v[198:199], v[36:37] op_sel:[0,1] op_sel_hi:[1,1]
v_pk_mul_f32 v[200:201], v[200:201], v[38:39] op_sel:[0,0] op_sel_hi:[1,0]
v_pk_mul_f32 v[202:203], v[202:203], v[38:39] op_sel:[0,0] op_sel_hi:[1,0]
v_pk_mul_f32 v[204:205], v[204:205], v[38:39] op_sel:[0,1] op_sel_hi:[1,1]
v_pk_mul_f32 v[206:207], v[206:207], v[38:39] op_sel:[0,1] op_sel_hi:[1,1]
v_cvt_pk_bf16_f32 v112, v176, v177
v_cvt_pk_bf16_f32 v113, v178, v179
v_cvt_pk_bf16_f32 v114, v192, v193
v_cvt_pk_bf16_f32 v115, v194, v195
v_cvt_pk_bf16_f32 v116, v180, v181
v_cvt_pk_bf16_f32 v117, v182, v183
v_cvt_pk_bf16_f32 v118, v196, v197
v_cvt_pk_bf16_f32 v119, v198, v199
v_cvt_pk_bf16_f32 v120, v184, v185
v_cvt_pk_bf16_f32 v121, v186, v187
v_cvt_pk_bf16_f32 v122, v200, v201
v_cvt_pk_bf16_f32 v123, v202, v203
v_cvt_pk_bf16_f32 v124, v188, v189
v_cvt_pk_bf16_f32 v125, v190, v191
v_cvt_pk_bf16_f32 v126, v204, v205
v_cvt_pk_bf16_f32 v127, v206, v207
v_permlane32_swap_b32 v112, v114
v_permlane32_swap_b32 v113, v115
v_permlane32_swap_b32 v116, v118
v_permlane32_swap_b32 v117, v119
v_permlane32_swap_b32 v120, v122
v_permlane32_swap_b32 v121, v123
v_permlane32_swap_b32 v124, v126
v_permlane32_swap_b32 v125, v127
s_waitcnt vmcnt(1)
s_mov_b32 s64, s53
s_mov_b32 s65, s54
buffer_store_dwordx4 v[112:115], v4, s[16:19], s53 offen offset:0 sc1
buffer_store_dwordx4 v[116:119], v4, s[16:19], s53 offen offset:256 sc1
buffer_store_dwordx4 v[120:123], v4, s[16:19], s54 offen offset:0 sc1
buffer_store_dwordx4 v[124:127], v4, s[16:19], s54 offen offset:256 sc1
s_lshl_b32 s61, s6, 3
s_add_u32 s61, s61, s7
s_lshl_b32 s61, s61, 2
s_add_u32 s61, s61, s4
s_lshl_b32 s61, s61, 7
s_add_u32 s75, s61, 22249472
s_branch LF_cb
LF_cz:
s_lshl_b32 s61, s4, 12
v_and_b32 v3, 15, v1
v_lshrrev_b32 v30, 4, v1
v_lshrrev_b32 v31, 1, v3
v_xor_b32 v30, v30, v31
v_lshlrev_b32 v3, 7, v3
v_add_u32 v3, s61, v3
v_lshl_add_u32 v10, v30, 4, v3
v_xor_b32_e64 v30, 4, v30
v_lshl_add_u32 v11, v30, 4, v3
v_lshrrev_b32_e64 v3, 4, v1
v_bfe_u32 v30, v1, 2, 2
v_lshl_add_u32 v30, v3, 3, v30
v_mul_u32_u24 v30, 192, v30
v_and_b32_e64 v31, 3, v1
v_lshl_add_u32 v30, v31, 3, v30
v_and_b32 v3, 1, v3
v_lshlrev_b32 v3, 5, v3
v_add_u32 v12, v30, v3
v_sub_u32 v13, v30, v3
s_bitcmp1_b32 s4, 0
s_cselect_b64 vcc, -1, 0
v_cndmask_b32 v18, v12, v13, vcc
s_lshl_b32 s61, s4, 5
s_and_b32 s62, s4, 1
s_lshl_b32 s62, s62, 5
s_add_u32 s62, s62, 128
v_add_u32 v19, s62, v18
v_add_u32 v18, s61, v18
v_mov_b32 v28, 0x3f803f80
v_mov_b32 v29, 0x3f803f80
v_mov_b32 v30, 0x3f803f80
v_mov_b32 v31, 0x3f803f80
s_mul_i32 s55, s7, 6
s_add_u32 s58, s55, 5
s_min_u32 s58, s58, 43
s_sub_u32 s55, s55, 1
s_max_i32 s55, s55, 0
s_sub_u32 s58, s58, s55
s_mul_i32 s55, s7, 6
s_add_u32 s59, s55, 5
s_min_u32 s59, s59, 43
s_sub_u32 s55, s55, 1
s_max_i32 s55, s55, 0
s_sub_u32 s59, s59, s55
s_lshl_b32 s61, s4, 7
s_add_u32 s61, s61, 159744
v_and_b32 v3, 0x30, v1
v_add_u32_e64 v4, s61, v3
v_add_u32 v7, 162688, v3
v_and_b32_e64 v3, 15, v1
v_lshl_add_u32 v5, v3, 2, s61
v_lshlrev_b32_e64 v3, 2, v3
v_add_u32 v6, 162304, v3
v_lshlrev_b32 v8, 4, v1
v_lshlrev_b32_e64 v9, 3, v1
s_lshl_b32 s61, s4, 6
s_and_b32 s62, s4, 1
s_lshl_b32 s62, s62, 6
s_add_u32 s62, s62, 256
v_add_u32 v22, s61, v6
v_add_u32 v23, s62, v6
v_add_u32 v24, s61, v7
v_add_u32 v25, s62, v7
s_lshl_b32 s57, s6, 2
s_add_u32 s57, s57, s4
s_lshl_b32 s53, s7, 6
s_add_u32 s53, s53, s57
s_mul_i32 s53, s53, 6144
s_add_u32 s53, s53, 0
s_mul_i32 s54, s57, 48
s_add_u32 s54, s54, s55
s_lshl_b32 s54, s54, 10
s_add_u32 s54, s54, 4194304
s_lshl_b32 s56, s6, 3
s_add_u32 s56, s56, s7
s_lshl_b32 s56, s56, 2
s_add_u32 s56, s56, s4
s_lshl_b32 s56, s56, 9
s_add_u32 s56, s56, 20971520
v_mov_b32 v48, 0x3f803f80
v_mov_b32 v32, 0
v_mov_b32 v33, 0
v_mov_b32 v34, 0
v_mov_b32 v35, 0
s_lshl_b32 s47, s47, 5
s_add_u32 s47, s47, 21495808
v_lshrrev_b32 v3, 1, v1
s_waitcnt vmcnt(1)
v_dot2_f32_bf16 v32, v40, v48, v32
v_dot2_f32_bf16 v34, v40, v40, v34
v_dot2_f32_bf16 v33, v41, v48, v33
v_dot2_f32_bf16 v35, v41, v41, v35
v_dot2_f32_bf16 v32, v42, v48, v32
v_dot2_f32_bf16 v34, v42, v42, v34
v_dot2_f32_bf16 v33, v43, v48, v33
v_dot2_f32_bf16 v35, v43, v43, v35
v_dot2_f32_bf16 v32, v44, v48, v32
v_dot2_f32_bf16 v34, v44, v44, v34
v_dot2_f32_bf16 v33, v45, v48, v33
v_dot2_f32_bf16 v35, v45, v45, v35
v_dot2_f32_bf16 v32, v46, v48, v32
v_dot2_f32_bf16 v34, v46, v46, v34
v_dot2_f32_bf16 v33, v47, v48, v33
v_dot2_f32_bf16 v35, v47, v47, v35
s_nop 2
v_add_f32 v32, v32, v33
v_add_f32 v34, v34, v35
s_nop 0
v_add_f32_dpp v32, v32, v32 row_ror:8 row_mask:0xf bank_mask:0xf
v_add_f32_dpp v34, v34, v34 row_ror:8 row_mask:0xf bank_mask:0xf
s_nop 0
v_add_f32_dpp v32, v32, v32 row_ror:4 row_mask:0xf bank_mask:0xf
v_add_f32_dpp v34, v34, v34 row_ror:4 row_mask:0xf bank_mask:0xf
s_nop 0
v_add_f32_dpp v32, v32, v32 row_ror:2 row_mask:0xf bank_mask:0xf
v_add_f32_dpp v34, v34, v34 row_ror:2 row_mask:0xf bank_mask:0xf
s_nop 0
v_add_f32_dpp v32, v32, v32 row_ror:1 row_mask:0xf bank_mask:0xf
v_add_f32_dpp v34, v34, v34 row_ror:1 row_mask:0xf bank_mask:0xf
v_mov_b32 v33, v32
v_mov_b32 v35, v34
s_nop 1
v_permlane16_swap_b32 v32, v33
v_permlane16_swap_b32 v34, v35
v_add_f32 v32, v32, v33
v_add_f32 v34, v34, v35
v_mul_f32 v32, 0x3b000000, v32
v_mul_f32 v34, 0x3b000000, v34
v_fma_f32 v34, -v32, v32, v34
v_max_f32_e64 v34, 0, v34
v_add_f32 v34, 0x3727c5ac, v34
s_load_dword s52, s[90:91], 64
s_waitcnt lgkmcnt(0)
s_cmp_lg_u32 s52, 0
s_cbranch_scc1 Lok_45
s_mov_b32 s63, 0
Lspin_44:
s_sleep 2
v_mov_b32 v31, 0
buffer_load_dword v30, v31, s[40:43], 0 offen sc1
s_waitcnt vmcnt(0)
s_add_u32 s63, s63, 1
s_cmp_gt_u32 s63, 32768
s_cbranch_scc1 Lok_45
v_readfirstlane_b32 s52, v30
s_cmp_lg_u32 s52, 0
s_cbranch_scc0 Lspin_44
Lok_45:
v_mov_b32 v33, s52
v_mov_b32 v35, s52
s_mov_b32 exec_lo, 1
s_mov_b32 exec_hi, 1
buffer_store_dwordx4 v[32:35], v3, s[16:19], s47 offen sc1
s_mov_b64 exec, -1
v_mov_b32 v30, 0x3f803f80
v_mov_b32 v31, 0x3f803f80
s_lshl_b32 s61, s4, 2
s_add_u32 s61, s61, 163328
v_mov_b32 v26, s61
v_mov_b32 v27, 0
ds_write_b32 v26, v27
ds_write_b32 v26, v27 offset:16
v_mov_b32 v27, 1
s_waitcnt lgkmcnt(0)
v_add_u32 v14, 0, v10
v_add_u32 v15, 0, v11
v_add_u32 v16, 16384, v12
v_add_u32 v17, 16384, v13
v_add_u32 v20, 16384, v18
v_add_u32 v21, 16384, v19
s_barrier
ds_read_b128 v[128:131], v14 offset:0
ds_read_b64_tr_b16 v[80:81], v16 offset:0
ds_read_b64_tr_b16 v[82:83], v16 offset:768
ds_read_b128 v[132:135], v14 offset:2048
ds_read_b64_tr_b16 v[84:85], v17 offset:32
ds_read_b64_tr_b16 v[86:87], v17 offset:800
ds_read_b64_tr_b16 v[88:89], v16 offset:64
ds_read_b64_tr_b16 v[90:91], v16 offset:832
ds_read_b64_tr_b16 v[92:93], v20 offset:0
ds_read_b64_tr_b16 v[94:95], v20 offset:768
ds_read_b64_tr_b16 v[104:105], v17 offset:96
ds_read_b64_tr_b16 v[106:107], v17 offset:864
ds_read_b64_tr_b16 v[108:109], v16 offset:128
ds_read_b64_tr_b16 v[110:111], v16 offset:896
s_waitcnt lgkmcnt(11)
v_mfma_f32_16x16x32_bf16 v[32:35], v[128:131], v[80:83], 0
ds_read_b64_tr_b16 v[112:113], v17 offset:160
s_waitcnt lgkmcnt(11)
v_mfma_f32_16x16x32_bf16 v[36:39], v[132:135], v[80:83], 0
ds_read_b64_tr_b16 v[114:115], v17 offset:928
s_waitcnt lgkmcnt(10)
v_mfma_f32_16x16x32_bf16 v[40:43], v[128:131], v[84:87], 0
ds_read_b64_tr_b16 v[116:117], v21 offset:0
v_mfma_f32_16x16x32_bf16 v[44:47], v[132:135], v[84:87], 0
ds_read_b64_tr_b16 v[118:119], v21 offset:768
s_waitcnt lgkmcnt(10)
v_mfma_f32_16x16x32_bf16 v[48:51], v[128:131], v[88:91], 0
ds_read_b128 v[136:139], v15 offset:0
v_mfma_f32_16x16x32_bf16 v[52:55], v[132:135], v[88:91], 0
ds_read_b64_tr_b16 v[120:121], v16 offset:6144
s_waitcnt lgkmcnt(10)
v_mfma_f32_16x16x32_bf16 v[96:99], v[28:31], v[92:95], 0
ds_read_b64_tr_b16 v[122:123], v16 offset:6912
s_waitcnt lgkmcnt(9)
v_mfma_f32_16x16x32_bf16 v[56:59], v[128:131], v[104:107], 0
ds_read_b128 v[140:143], v15 offset:2048
v_mfma_f32_16x16x32_bf16 v[60:63], v[132:135], v[104:107], 0
ds_read_b64_tr_b16 v[124:125], v17 offset:6176
s_waitcnt lgkmcnt(9)
v_mfma_f32_16x16x32_bf16 v[64:67], v[128:131], v[108:111], 0
ds_read_b64_tr_b16 v[126:127], v17 offset:6944
v_mfma_f32_16x16x32_bf16 v[68:71], v[132:135], v[108:111], 0
ds_read_b64_tr_b16 v[80:81], v16 offset:6208
s_waitcnt lgkmcnt(9)
v_mfma_f32_16x16x32_bf16 v[72:75], v[128:131], v[112:115], 0
ds_read_b64_tr_b16 v[82:83], v16 offset:6976
v_mfma_f32_16x16x32_bf16 v[76:79], v[132:135], v[112:115], 0
ds_read_b64_tr_b16 v[84:85], v20 offset:6144
s_waitcnt lgkmcnt(9)
v_mfma_f32_16x16x32_bf16 v[100:103], v[28:31], v[116:119], 0
ds_read_b64_tr_b16 v[86:87], v20 offset:6912
s_waitcnt lgkmcnt(7)
v_mfma_f32_16x16x32_bf16 v[32:35], v[136:139], v[120:123], v[32:35]
ds_read_b64_tr_b16 v[88:89], v17 offset:6240
ds_read_b64_tr_b16 v[90:91], v17 offset:7008
s_waitcnt lgkmcnt(8)
v_mfma_f32_16x16x32_bf16 v[36:39], v[140:143], v[120:123], v[36:39]
ds_read_b64_tr_b16 v[92:93], v16 offset:6272
s_waitcnt lgkmcnt(7)
v_mfma_f32_16x16x32_bf16 v[40:43], v[136:139], v[124:127], v[40:43]
ds_read_b64_tr_b16 v[94:95], v16 offset:7040
v_mfma_f32_16x16x32_bf16 v[44:47], v[140:143], v[124:127], v[44:47]
ds_read_b64_tr_b16 v[104:105], v17 offset:6304
s_waitcnt lgkmcnt(7)
v_mfma_f32_16x16x32_bf16 v[48:51], v[136:139], v[80:83], v[48:51]
ds_read_b64_tr_b16 v[106:107], v17 offset:7072
v_mfma_f32_16x16x32_bf16 v[52:55], v[140:143], v[80:83], v[52:55]
ds_read_b64_tr_b16 v[108:109], v21 offset:6144
s_waitcnt lgkmcnt(7)
v_mfma_f32_16x16x32_bf16 v[96:99], v[28:31], v[84:87], v[96:99]
ds_read_b64_tr_b16 v[110:111], v21 offset:6912
s_waitcnt lgkmcnt(6)
v_mfma_f32_16x16x32_bf16 v[56:59], v[136:139], v[88:91], v[56:59]
v_mfma_f32_16x16x32_bf16 v[60:63], v[140:143], v[88:91], v[60:63]
s_waitcnt lgkmcnt(4)
v_mfma_f32_16x16x32_bf16 v[64:67], v[136:139], v[92:95], v[64:67]
s_nop 0
v_add_u32 v14, 28672, v10
v_add_u32 v15, 28672, v11
v_add_u32 v16, 45056, v12
v_add_u32 v17, 45056, v13
v_add_u32 v20, 45056, v18
v_add_u32 v21, 45056, v19
s_waitcnt lgkmcnt(0)
s_barrier
ds_read_b128 v[144:147], v14 offset:0
ds_read_b64_tr_b16 v[112:113], v16 offset:0
v_mfma_f32_16x16x32_bf16 v[68:71], v[140:143], v[92:95], v[68:71]
ds_read_b64_tr_b16 v[114:115], v16 offset:768
ds_read_b128 v[148:151], v14 offset:2048
v_mfma_f32_16x16x32_bf16 v[72:75], v[136:139], v[104:107], v[72:75]
ds_read_b64_tr_b16 v[116:117], v17 offset:32
ds_read_b64_tr_b16 v[118:119], v17 offset:800
v_mfma_f32_16x16x32_bf16 v[76:79], v[140:143], v[104:107], v[76:79]
ds_read_b64_tr_b16 v[120:121], v16 offset:64
ds_read_b64_tr_b16 v[122:123], v16 offset:832
v_mfma_f32_16x16x32_bf16 v[100:103], v[28:31], v[108:111], v[100:103]
ds_read_b64_tr_b16 v[124:125], v20 offset:0
ds_read_b64_tr_b16 v[126:127], v20 offset:768
s_waitcnt lgkmcnt(7)
v_mfma_f32_16x16x32_bf16 v[32:35], v[144:147], v[112:115], v[32:35]
ds_read_b64_tr_b16 v[80:81], v17 offset:96
ds_read_b64_tr_b16 v[82:83], v17 offset:864
s_waitcnt lgkmcnt(8)
v_mfma_f32_16x16x32_bf16 v[36:39], v[148:151], v[112:115], v[36:39]
ds_read_b64_tr_b16 v[84:85], v16 offset:128
s_waitcnt lgkmcnt(7)
v_mfma_f32_16x16x32_bf16 v[40:43], v[144:147], v[116:119], v[40:43]
ds_read_b64_tr_b16 v[86:87], v16 offset:896
v_mfma_f32_16x16x32_bf16 v[44:47], v[148:151], v[116:119], v[44:47]
ds_read_b64_tr_b16 v[88:89], v17 offset:160
s_waitcnt lgkmcnt(7)
v_mfma_f32_16x16x32_bf16 v[48:51], v[144:147], v[120:123], v[48:51]
ds_read_b64_tr_b16 v[90:91], v17 offset:928
v_mfma_f32_16x16x32_bf16 v[52:55], v[148:151], v[120:123], v[52:55]
ds_read_b64_tr_b16 v[92:93], v21 offset:0
s_waitcnt lgkmcnt(7)
v_mfma_f32_16x16x32_bf16 v[96:99], v[28:31], v[124:127], v[96:99]
ds_read_b64_tr_b16 v[94:95], v21 offset:768
s_waitcnt lgkmcnt(6)
v_mfma_f32_16x16x32_bf16 v[56:59], v[144:147], v[80:83], v[56:59]
ds_read_b128 v[152:155], v15 offset:0
ds_read_b64_tr_b16 v[104:105], v16 offset:6144
v_mfma_f32_16x16x32_bf16 v[60:63], v[148:151], v[80:83], v[60:63]
ds_read_b64_tr_b16 v[106:107], v16 offset:6912
ds_read_b128 v[156:159], v15 offset:2048
s_waitcnt lgkmcnt(8)
v_mfma_f32_16x16x32_bf16 v[64:67], v[144:147], v[84:87], v[64:67]
ds_read_b64_tr_b16 v[108:109], v17 offset:6176
ds_read_b64_tr_b16 v[110:111], v17 offset:6944
v_mfma_f32_16x16x32_bf16 v[68:71], v[148:151], v[84:87], v[68:71]
ds_read_b64_tr_b16 v[112:113], v16 offset:6208
s_waitcnt lgkmcnt(9)
v_mfma_f32_16x16x32_bf16 v[72:75], v[144:147], v[88:91], v[72:75]
ds_read_b64_tr_b16 v[114:115], v16 offset:6976
v_mfma_f32_16x16x32_bf16 v[76:79], v[148:151], v[88:91], v[76:79]
ds_read_b64_tr_b16 v[116:117], v20 offset:6144
s_waitcnt lgkmcnt(9)
v_mfma_f32_16x16x32_bf16 v[100:103], v[28:31], v[92:95], v[100:103]
ds_read_b64_tr_b16 v[118:119], v20 offset:6912
s_waitcnt lgkmcnt(7)
v_mfma_f32_16x16x32_bf16 v[32:35], v[152:155], v[104:107], v[32:35]
ds_read_b64_tr_b16 v[120:121], v17 offset:6240
ds_read_b64_tr_b16 v[122:123], v17 offset:7008
s_waitcnt lgkmcnt(8)
v_mfma_f32_16x16x32_bf16 v[36:39], v[156:159], v[104:107], v[36:39]
ds_read_b64_tr_b16 v[124:125], v16 offset:6272
s_waitcnt lgkmcnt(7)
v_mfma_f32_16x16x32_bf16 v[40:43], v[152:155], v[108:111], v[40:43]
ds_read_b64_tr_b16 v[126:127], v16 offset:7040
v_mfma_f32_16x16x32_bf16 v[44:47], v[156:159], v[108:111], v[44:47]
ds_read_b64_tr_b16 v[80:81], v17 offset:6304
s_waitcnt lgkmcnt(7)
v_mfma_f32_16x16x32_bf16 v[48:51], v[152:155], v[112:115], v[48:51]
ds_read_b64_tr_b16 v[82:83], v17 offset:7072
v_mfma_f32_16x16x32_bf16 v[52:55], v[156:159], v[112:115], v[52:55]
ds_read_b64_tr_b16 v[84:85], v21 offset:6144
s_waitcnt lgkmcnt(7)
v_mfma_f32_16x16x32_bf16 v[96:99], v[28:31], v[116:119], v[96:99]
ds_read_b64_tr_b16 v[86:87], v21 offset:6912
s_waitcnt lgkmcnt(6)
v_mfma_f32_16x16x32_bf16 v[56:59], v[152:155], v[120:123], v[56:59]
v_mfma_f32_16x16x32_bf16 v[60:63], v[156:159], v[120:123], v[60:63]
s_waitcnt lgkmcnt(4)
v_mfma_f32_16x16x32_bf16 v[64:67], v[152:155], v[124:127], v[64:67]
v_add_u32 v14, 57344, v10
v_add_u32 v15, 57344, v11
v_add_u32 v16, 73728, v12
v_add_u32 v17, 73728, v13
v_add_u32 v20, 73728, v18
v_add_u32 v21, 73728, v19
s_waitcnt lgkmcnt(0)
s_barrier
ds_read_b128 v[160:163], v14 offset:0
ds_read_b64_tr_b16 v[88:89], v16 offset:0
v_mfma_f32_16x16x32_bf16 v[68:71], v[156:159], v[124:127], v[68:71]
ds_read_b64_tr_b16 v[90:91], v16 offset:768
ds_read_b128 v[164:167], v14 offset:2048
v_mfma_f32_16x16x32_bf16 v[72:75], v[152:155], v[80:83], v[72:75]
ds_read_b64_tr_b16 v[92:93], v17 offset:32
ds_read_b64_tr_b16 v[94:95], v17 offset:800
v_mfma_f32_16x16x32_bf16 v[76:79], v[156:159], v[80:83], v[76:79]
ds_read_b64_tr_b16 v[104:105], v16 offset:64
ds_read_b64_tr_b16 v[106:107], v16 offset:832
v_mfma_f32_16x16x32_bf16 v[100:103], v[28:31], v[84:87], v[100:103]
ds_read_b64_tr_b16 v[108:109], v20 offset:0
ds_read_b64_tr_b16 v[110:111], v20 offset:768
s_waitcnt lgkmcnt(7)
v_mfma_f32_16x16x32_bf16 v[32:35], v[160:163], v[88:91], v[32:35]
ds_read_b64_tr_b16 v[112:113], v17 offset:96
ds_read_b64_tr_b16 v[114:115], v17 offset:864
s_waitcnt lgkmcnt(8)
v_mfma_f32_16x16x32_bf16 v[36:39], v[164:167], v[88:91], v[36:39]
ds_read_b64_tr_b16 v[116:117], v16 offset:128
s_waitcnt lgkmcnt(7)
v_mfma_f32_16x16x32_bf16 v[40:43], v[160:163], v[92:95], v[40:43]
ds_read_b64_tr_b16 v[118:119], v16 offset:896
v_mfma_f32_16x16x32_bf16 v[44:47], v[164:167], v[92:95], v[44:47]
ds_read_b64_tr_b16 v[120:121], v17 offset:160
s_waitcnt lgkmcnt(7)
v_mfma_f32_16x16x32_bf16 v[48:51], v[160:163], v[104:107], v[48:51]
ds_read_b64_tr_b16 v[122:123], v17 offset:928
v_mfma_f32_16x16x32_bf16 v[52:55], v[164:167], v[104:107], v[52:55]
ds_read_b64_tr_b16 v[124:125], v21 offset:0
s_waitcnt lgkmcnt(7)
v_mfma_f32_16x16x32_bf16 v[96:99], v[28:31], v[108:111], v[96:99]
ds_read_b64_tr_b16 v[126:127], v21 offset:768
s_waitcnt lgkmcnt(6)
v_mfma_f32_16x16x32_bf16 v[56:59], v[160:163], v[112:115], v[56:59]
ds_read_b128 v[168:171], v15 offset:0
ds_read_b64_tr_b16 v[80:81], v16 offset:6144
v_mfma_f32_16x16x32_bf16 v[60:63], v[164:167], v[112:115], v[60:63]
ds_read_b64_tr_b16 v[82:83], v16 offset:6912
ds_read_b128 v[172:175], v15 offset:2048
s_waitcnt lgkmcnt(8)
v_mfma_f32_16x16x32_bf16 v[64:67], v[160:163], v[116:119], v[64:67]
ds_read_b64_tr_b16 v[84:85], v17 offset:6176
ds_read_b64_tr_b16 v[86:87], v17 offset:6944
v_mfma_f32_16x16x32_bf16 v[68:71], v[164:167], v[116:119], v[68:71]
ds_read_b64_tr_b16 v[88:89], v16 offset:6208
s_waitcnt lgkmcnt(9)
v_mfma_f32_16x16x32_bf16 v[72:75], v[160:163], v[120:123], v[72:75]
ds_read_b64_tr_b16 v[90:91], v16 offset:6976
v_mfma_f32_16x16x32_bf16 v[76:79], v[164:167], v[120:123], v[76:79]
ds_read_b64_tr_b16 v[92:93], v20 offset:6144
s_waitcnt lgkmcnt(9)
v_mfma_f32_16x16x32_bf16 v[100:103], v[28:31], v[124:127], v[100:103]
ds_read_b64_tr_b16 v[94:95], v20 offset:6912
s_waitcnt lgkmcnt(7)
v_mfma_f32_16x16x32_bf16 v[32:35], v[168:171], v[80:83], v[32:35]
ds_read_b64_tr_b16 v[104:105], v17 offset:6240
ds_read_b64_tr_b16 v[106:107], v17 offset:7008
s_waitcnt lgkmcnt(8)
v_mfma_f32_16x16x32_bf16 v[36:39], v[172:175], v[80:83], v[36:39]
ds_read_b64_tr_b16 v[108:109], v16 offset:6272
s_waitcnt lgkmcnt(7)
v_mfma_f32_16x16x32_bf16 v[40:43], v[168:171], v[84:87], v[40:43]
ds_read_b64_tr_b16 v[110:111], v16 offset:7040
v_mfma_f32_16x16x32_bf16 v[44:47], v[172:175], v[84:87], v[44:47]
ds_read_b64_tr_b16 v[112:113], v17 offset:6304
s_waitcnt lgkmcnt(7)
v_mfma_f32_16x16x32_bf16 v[48:51], v[168:171], v[88:91], v[48:51]
ds_read_b64_tr_b16 v[114:115], v17 offset:7072
v_mfma_f32_16x16x32_bf16 v[52:55], v[172:175], v[88:91], v[52:55]
ds_read_b64_tr_b16 v[116:117], v21 offset:6144
s_waitcnt lgkmcnt(7)
v_mfma_f32_16x16x32_bf16 v[96:99], v[28:31], v[92:95], v[96:99]
ds_read_b64_tr_b16 v[118:119], v21 offset:6912
s_waitcnt lgkmcnt(6)
v_mfma_f32_16x16x32_bf16 v[56:59], v[168:171], v[104:107], v[56:59]
v_mfma_f32_16x16x32_bf16 v[60:63], v[172:175], v[104:107], v[60:63]
s_waitcnt lgkmcnt(4)
v_mfma_f32_16x16x32_bf16 v[64:67], v[168:171], v[108:111], v[64:67]
v_add_u32 v14, 0, v10
v_add_u32 v15, 0, v11
v_add_u32 v16, 16384, v12
v_add_u32 v17, 16384, v13
v_add_u32 v20, 16384, v18
v_add_u32 v21, 16384, v19
s_waitcnt lgkmcnt(0)
s_barrier
ds_read_b128 v[176:179], v14 offset:0
ds_read_b64_tr_b16 v[120:121], v16 offset:0
v_mfma_f32_16x16x32_bf16 v[68:71], v[172:175], v[108:111], v[68:71]
ds_read_b64_tr_b16 v[122:123], v16 offset:768
ds_read_b128 v[180:183], v14 offset:2048
v_mfma_f32_16x16x32_bf16 v[72:75], v[168:171], v[112:115], v[72:75]
ds_read_b64_tr_b16 v[124:125], v17 offset:32
ds_read_b64_tr_b16 v[126:127], v17 offset:800
v_mfma_f32_16x16x32_bf16 v[76:79], v[172:175], v[112:115], v[76:79]
ds_read_b64_tr_b16 v[80:81], v16 offset:64
ds_read_b64_tr_b16 v[82:83], v16 offset:832
v_mfma_f32_16x16x32_bf16 v[100:103], v[28:31], v[116:119], v[100:103]
ds_read_b64_tr_b16 v[84:85], v20 offset:0
ds_read_b64_tr_b16 v[86:87], v20 offset:768
s_waitcnt lgkmcnt(7)
v_mfma_f32_16x16x32_bf16 v[32:35], v[176:179], v[120:123], v[32:35]
ds_read_b64_tr_b16 v[88:89], v17 offset:96
ds_read_b64_tr_b16 v[90:91], v17 offset:864
s_waitcnt lgkmcnt(8)
v_mfma_f32_16x16x32_bf16 v[36:39], v[180:183], v[120:123], v[36:39]
ds_read_b64_tr_b16 v[92:93], v16 offset:128
s_waitcnt lgkmcnt(7)
v_mfma_f32_16x16x32_bf16 v[40:43], v[176:179], v[124:127], v[40:43]
ds_read_b64_tr_b16 v[94:95], v16 offset:896
v_mfma_f32_16x16x32_bf16 v[44:47], v[180:183], v[124:127], v[44:47]
ds_read_b64_tr_b16 v[104:105], v17 offset:160
s_waitcnt lgkmcnt(7)
v_mfma_f32_16x16x32_bf16 v[48:51], v[176:179], v[80:83], v[48:51]
ds_read_b64_tr_b16 v[106:107], v17 offset:928
v_mfma_f32_16x16x32_bf16 v[52:55], v[180:183], v[80:83], v[52:55]
ds_read_b64_tr_b16 v[108:109], v21 offset:0
s_waitcnt lgkmcnt(7)
v_mfma_f32_16x16x32_bf16 v[96:99], v[28:31], v[84:87], v[96:99]
ds_read_b64_tr_b16 v[110:111], v21 offset:768
s_waitcnt lgkmcnt(6)
v_mfma_f32_16x16x32_bf16 v[56:59], v[176:179], v[88:91], v[56:59]
ds_read_b128 v[184:187], v15 offset:0
ds_read_b64_tr_b16 v[112:113], v16 offset:6144
v_mfma_f32_16x16x32_bf16 v[60:63], v[180:183], v[88:91], v[60:63]
ds_read_b64_tr_b16 v[114:115], v16 offset:6912
ds_read_b128 v[188:191], v15 offset:2048
s_waitcnt lgkmcnt(8)
v_mfma_f32_16x16x32_bf16 v[64:67], v[176:179], v[92:95], v[64:67]
ds_read_b64_tr_b16 v[116:117], v17 offset:6176
ds_read_b64_tr_b16 v[118:119], v17 offset:6944
v_mfma_f32_16x16x32_bf16 v[68:71], v[180:183], v[92:95], v[68:71]
ds_read_b64_tr_b16 v[120:121], v16 offset:6208
s_waitcnt lgkmcnt(9)
v_mfma_f32_16x16x32_bf16 v[72:75], v[176:179], v[104:107], v[72:75]
ds_read_b64_tr_b16 v[122:123], v16 offset:6976
v_mfma_f32_16x16x32_bf16 v[76:79], v[180:183], v[104:107], v[76:79]
ds_read_b64_tr_b16 v[124:125], v20 offset:6144
s_waitcnt lgkmcnt(9)
v_mfma_f32_16x16x32_bf16 v[100:103], v[28:31], v[108:111], v[100:103]
ds_read_b64_tr_b16 v[126:127], v20 offset:6912
s_waitcnt lgkmcnt(7)
v_mfma_f32_16x16x32_bf16 v[32:35], v[184:187], v[112:115], v[32:35]
ds_read_b64_tr_b16 v[80:81], v17 offset:6240
ds_read_b64_tr_b16 v[82:83], v17 offset:7008
s_waitcnt lgkmcnt(8)
v_mfma_f32_16x16x32_bf16 v[36:39], v[188:191], v[112:115], v[36:39]
ds_read_b64_tr_b16 v[84:85], v16 offset:6272
s_waitcnt lgkmcnt(7)
v_mfma_f32_16x16x32_bf16 v[40:43], v[184:187], v[116:119], v[40:43]
ds_read_b64_tr_b16 v[86:87], v16 offset:7040
v_mfma_f32_16x16x32_bf16 v[44:47], v[188:191], v[116:119], v[44:47]
ds_read_b64_tr_b16 v[88:89], v17 offset:6304
s_waitcnt lgkmcnt(7)
v_mfma_f32_16x16x32_bf16 v[48:51], v[184:187], v[120:123], v[48:51]
ds_read_b64_tr_b16 v[90:91], v17 offset:7072
v_mfma_f32_16x16x32_bf16 v[52:55], v[188:191], v[120:123], v[52:55]
ds_read_b64_tr_b16 v[92:93], v21 offset:6144
s_waitcnt lgkmcnt(7)
v_mfma_f32_16x16x32_bf16 v[96:99], v[28:31], v[124:127], v[96:99]
ds_read_b64_tr_b16 v[94:95], v21 offset:6912
s_waitcnt lgkmcnt(6)
v_mfma_f32_16x16x32_bf16 v[56:59], v[184:187], v[80:83], v[56:59]
v_mfma_f32_16x16x32_bf16 v[60:63], v[188:191], v[80:83], v[60:63]
s_waitcnt lgkmcnt(4)
v_mfma_f32_16x16x32_bf16 v[64:67], v[184:187], v[84:87], v[64:67]
v_add_u32 v14, 28672, v10
v_add_u32 v15, 28672, v11
v_add_u32 v16, 45056, v12
v_add_u32 v17, 45056, v13
v_add_u32 v20, 45056, v18
v_add_u32 v21, 45056, v19
s_waitcnt lgkmcnt(0)
s_barrier
ds_read_b128 v[192:195], v14 offset:0
ds_read_b64_tr_b16 v[104:105], v16 offset:0
v_mfma_f32_16x16x32_bf16 v[68:71], v[188:191], v[84:87], v[68:71]
ds_read_b64_tr_b16 v[106:107], v16 offset:768
ds_read_b128 v[196:199], v14 offset:2048
v_mfma_f32_16x16x32_bf16 v[72:75], v[184:187], v[88:91], v[72:75]
ds_read_b64_tr_b16 v[108:109], v17 offset:32
ds_read_b64_tr_b16 v[110:111], v17 offset:800
v_mfma_f32_16x16x32_bf16 v[76:79], v[188:191], v[88:91], v[76:79]
ds_read_b64_tr_b16 v[112:113], v16 offset:64
ds_read_b64_tr_b16 v[114:115], v16 offset:832
v_mfma_f32_16x16x32_bf16 v[100:103], v[28:31], v[92:95], v[100:103]
ds_read_b64_tr_b16 v[116:117], v20 offset:0
ds_read_b64_tr_b16 v[118:119], v20 offset:768
s_waitcnt lgkmcnt(7)
v_mfma_f32_16x16x32_bf16 v[32:35], v[192:195], v[104:107], v[32:35]
ds_read_b64_tr_b16 v[120:121], v17 offset:96
ds_read_b64_tr_b16 v[122:123], v17 offset:864
s_waitcnt lgkmcnt(8)
v_mfma_f32_16x16x32_bf16 v[36:39], v[196:199], v[104:107], v[36:39]
ds_read_b64_tr_b16 v[124:125], v16 offset:128
s_waitcnt lgkmcnt(7)
v_mfma_f32_16x16x32_bf16 v[40:43], v[192:195], v[108:111], v[40:43]
ds_read_b64_tr_b16 v[126:127], v16 offset:896
v_mfma_f32_16x16x32_bf16 v[44:47], v[196:199], v[108:111], v[44:47]
ds_read_b64_tr_b16 v[80:81], v17 offset:160
s_waitcnt lgkmcnt(7)
v_mfma_f32_16x16x32_bf16 v[48:51], v[192:195], v[112:115], v[48:51]
ds_read_b64_tr_b16 v[82:83], v17 offset:928
v_mfma_f32_16x16x32_bf16 v[52:55], v[196:199], v[112:115], v[52:55]
ds_read_b64_tr_b16 v[84:85], v21 offset:0
s_waitcnt lgkmcnt(7)
v_mfma_f32_16x16x32_bf16 v[96:99], v[28:31], v[116:119], v[96:99]
ds_read_b64_tr_b16 v[86:87], v21 offset:768
s_waitcnt lgkmcnt(6)
v_mfma_f32_16x16x32_bf16 v[56:59], v[192:195], v[120:123], v[56:59]
ds_read_b128 v[200:203], v15 offset:0
ds_read_b64_tr_b16 v[88:89], v16 offset:6144
v_mfma_f32_16x16x32_bf16 v[60:63], v[196:199], v[120:123], v[60:63]
ds_read_b64_tr_b16 v[90:91], v16 offset:6912
ds_read_b128 v[204:207], v15 offset:2048
s_waitcnt lgkmcnt(8)
v_mfma_f32_16x16x32_bf16 v[64:67], v[192:195], v[124:127], v[64:67]
ds_read_b64_tr_b16 v[92:93], v17 offset:6176
ds_read_b64_tr_b16 v[94:95], v17 offset:6944
v_mfma_f32_16x16x32_bf16 v[68:71], v[196:199], v[124:127], v[68:71]
ds_read_b64_tr_b16 v[104:105], v16 offset:6208
s_waitcnt lgkmcnt(9)
v_mfma_f32_16x16x32_bf16 v[72:75], v[192:195], v[80:83], v[72:75]
ds_read_b64_tr_b16 v[106:107], v16 offset:6976
v_mfma_f32_16x16x32_bf16 v[76:79], v[196:199], v[80:83], v[76:79]
ds_read_b64_tr_b16 v[108:109], v20 offset:6144
s_waitcnt lgkmcnt(9)
v_mfma_f32_16x16x32_bf16 v[100:103], v[28:31], v[84:87], v[100:103]
ds_read_b64_tr_b16 v[110:111], v20 offset:6912
s_waitcnt lgkmcnt(7)
v_mfma_f32_16x16x32_bf16 v[32:35], v[200:203], v[88:91], v[32:35]
ds_read_b64_tr_b16 v[112:113], v17 offset:6240
ds_read_b64_tr_b16 v[114:115], v17 offset:7008
s_waitcnt lgkmcnt(8)
v_mfma_f32_16x16x32_bf16 v[36:39], v[204:207], v[88:91], v[36:39]
ds_read_b64_tr_b16 v[116:117], v16 offset:6272
s_waitcnt lgkmcnt(7)
v_mfma_f32_16x16x32_bf16 v[40:43], v[200:203], v[92:95], v[40:43]
ds_read_b64_tr_b16 v[118:119], v16 offset:7040
v_mfma_f32_16x16x32_bf16 v[44:47], v[204:207], v[92:95], v[44:47]
ds_read_b64_tr_b16 v[120:121], v17 offset:6304
s_waitcnt lgkmcnt(7)
v_mfma_f32_16x16x32_bf16 v[48:51], v[200:203], v[104:107], v[48:51]
ds_read_b64_tr_b16 v[122:123], v17 offset:7072
v_mfma_f32_16x16x32_bf16 v[52:55], v[204:207], v[104:107], v[52:55]
ds_read_b64_tr_b16 v[124:125], v21 offset:6144
s_waitcnt lgkmcnt(7)
v_mfma_f32_16x16x32_bf16 v[96:99], v[28:31], v[108:111], v[96:99]
ds_read_b64_tr_b16 v[126:127], v21 offset:6912
s_waitcnt lgkmcnt(6)
v_mfma_f32_16x16x32_bf16 v[56:59], v[200:203], v[112:115], v[56:59]
v_mfma_f32_16x16x32_bf16 v[60:63], v[204:207], v[112:115], v[60:63]
s_waitcnt lgkmcnt(4)
v_mfma_f32_16x16x32_bf16 v[64:67], v[200:203], v[116:119], v[64:67]
v_add_u32 v14, 57344, v10
v_add_u32 v15, 57344, v11
v_add_u32 v16, 73728, v12
v_add_u32 v17, 73728, v13
v_add_u32 v20, 73728, v18
v_add_u32 v21, 73728, v19
s_waitcnt lgkmcnt(0)
s_barrier
ds_read_b128 v[208:211], v14 offset:0
ds_read_b64_tr_b16 v[80:81], v16 offset:0
v_mfma_f32_16x16x32_bf16 v[68:71], v[204:207], v[116:119], v[68:71]
ds_read_b64_tr_b16 v[82:83], v16 offset:768
ds_read_b128 v[212:215], v14 offset:2048
v_mfma_f32_16x16x32_bf16 v[72:75], v[200:203], v[120:123], v[72:75]
ds_read_b64_tr_b16 v[84:85], v17 offset:32
ds_read_b64_tr_b16 v[86:87], v17 offset:800
v_mfma_f32_16x16x32_bf16 v[76:79], v[204:207], v[120:123], v[76:79]
ds_read_b64_tr_b16 v[88:89], v16 offset:64
ds_read_b64_tr_b16 v[90:91], v16 offset:832
v_mfma_f32_16x16x32_bf16 v[100:103], v[28:31], v[124:127], v[100:103]
ds_read_b64_tr_b16 v[92:93], v20 offset:0
ds_read_b64_tr_b16 v[94:95], v20 offset:768
s_waitcnt lgkmcnt(7)
v_mfma_f32_16x16x32_bf16 v[32:35], v[208:211], v[80:83], v[32:35]
ds_read_b64_tr_b16 v[104:105], v17 offset:96
ds_read_b64_tr_b16 v[106:107], v17 offset:864
s_waitcnt lgkmcnt(8)
v_mfma_f32_16x16x32_bf16 v[36:39], v[212:215], v[80:83], v[36:39]
ds_read_b64_tr_b16 v[108:109], v16 offset:128
s_waitcnt lgkmcnt(7)
v_mfma_f32_16x16x32_bf16 v[40:43], v[208:211], v[84:87], v[40:43]
ds_read_b64_tr_b16 v[110:111], v16 offset:896
v_mfma_f32_16x16x32_bf16 v[44:47], v[212:215], v[84:87], v[44:47]
ds_read_b64_tr_b16 v[112:113], v17 offset:160
s_waitcnt lgkmcnt(7)
v_mfma_f32_16x16x32_bf16 v[48:51], v[208:211], v[88:91], v[48:51]
ds_read_b64_tr_b16 v[114:115], v17 offset:928
v_mfma_f32_16x16x32_bf16 v[52:55], v[212:215], v[88:91], v[52:55]
ds_read_b64_tr_b16 v[116:117], v21 offset:0
s_waitcnt lgkmcnt(7)
v_mfma_f32_16x16x32_bf16 v[96:99], v[28:31], v[92:95], v[96:99]
ds_read_b64_tr_b16 v[118:119], v21 offset:768
s_waitcnt lgkmcnt(6)
v_mfma_f32_16x16x32_bf16 v[56:59], v[208:211], v[104:107], v[56:59]
ds_read_b128 v[216:219], v15 offset:0
ds_read_b64_tr_b16 v[120:121], v16 offset:6144
v_mfma_f32_16x16x32_bf16 v[60:63], v[212:215], v[104:107], v[60:63]
ds_read_b64_tr_b16 v[122:123], v16 offset:6912
ds_read_b128 v[220:223], v15 offset:2048
s_waitcnt lgkmcnt(8)
v_mfma_f32_16x16x32_bf16 v[64:67], v[208:211], v[108:111], v[64:67]
ds_read_b64_tr_b16 v[124:125], v17 offset:6176
ds_read_b64_tr_b16 v[126:127], v17 offset:6944
v_mfma_f32_16x16x32_bf16 v[68:71], v[212:215], v[108:111], v[68:71]
ds_read_b64_tr_b16 v[80:81], v16 offset:6208
s_waitcnt lgkmcnt(9)
v_mfma_f32_16x16x32_bf16 v[72:75], v[208:211], v[112:115], v[72:75]
ds_read_b64_tr_b16 v[82:83], v16 offset:6976
v_mfma_f32_16x16x32_bf16 v[76:79], v[212:215], v[112:115], v[76:79]
ds_read_b64_tr_b16 v[84:85], v20 offset:6144
s_waitcnt lgkmcnt(9)
v_mfma_f32_16x16x32_bf16 v[100:103], v[28:31], v[116:119], v[100:103]
ds_read_b64_tr_b16 v[86:87], v20 offset:6912
s_waitcnt lgkmcnt(7)
v_mfma_f32_16x16x32_bf16 v[32:35], v[216:219], v[120:123], v[32:35]
ds_read_b64_tr_b16 v[88:89], v17 offset:6240
ds_read_b64_tr_b16 v[90:91], v17 offset:7008
s_waitcnt lgkmcnt(8)
v_mfma_f32_16x16x32_bf16 v[36:39], v[220:223], v[120:123], v[36:39]
ds_read_b64_tr_b16 v[92:93], v16 offset:6272
s_waitcnt lgkmcnt(7)
v_mfma_f32_16x16x32_bf16 v[40:43], v[216:219], v[124:127], v[40:43]
ds_read_b64_tr_b16 v[94:95], v16 offset:7040
v_mfma_f32_16x16x32_bf16 v[44:47], v[220:223], v[124:127], v[44:47]
ds_read_b64_tr_b16 v[104:105], v17 offset:6304
s_waitcnt lgkmcnt(7)
v_mfma_f32_16x16x32_bf16 v[48:51], v[216:219], v[80:83], v[48:51]
ds_read_b64_tr_b16 v[106:107], v17 offset:7072
v_mfma_f32_16x16x32_bf16 v[52:55], v[220:223], v[80:83], v[52:55]
ds_read_b64_tr_b16 v[108:109], v21 offset:6144
s_waitcnt lgkmcnt(7)
v_mfma_f32_16x16x32_bf16 v[96:99], v[28:31], v[84:87], v[96:99]
ds_read_b64_tr_b16 v[110:111], v21 offset:6912
s_waitcnt lgkmcnt(6)
v_mfma_f32_16x16x32_bf16 v[56:59], v[216:219], v[88:91], v[56:59]
v_mfma_f32_16x16x32_bf16 v[60:63], v[220:223], v[88:91], v[60:63]
s_waitcnt lgkmcnt(4)
v_mfma_f32_16x16x32_bf16 v[64:67], v[216:219], v[92:95], v[64:67]
v_add_u32 v14, 0, v10
v_add_u32 v15, 0, v11
v_add_u32 v16, 16384, v12
v_add_u32 v17, 16384, v13
v_add_u32 v20, 16384, v18
v_add_u32 v21, 16384, v19
s_waitcnt lgkmcnt(0)
s_barrier
ds_read_b128 v[224:227], v14 offset:0
ds_read_b64_tr_b16 v[112:113], v16 offset:0
v_mfma_f32_16x16x32_bf16 v[68:71], v[220:223], v[92:95], v[68:71]
ds_read_b64_tr_b16 v[114:115], v16 offset:768
ds_read_b128 v[228:231], v14 offset:2048
v_mfma_f32_16x16x32_bf16 v[72:75], v[216:219], v[104:107], v[72:75]
ds_read_b64_tr_b16 v[116:117], v17 offset:32
ds_read_b64_tr_b16 v[118:119], v17 offset:800
v_mfma_f32_16x16x32_bf16 v[76:79], v[220:223], v[104:107], v[76:79]
ds_read_b64_tr_b16 v[120:121], v16 offset:64
ds_read_b64_tr_b16 v[122:123], v16 offset:832
v_mfma_f32_16x16x32_bf16 v[100:103], v[28:31], v[108:111], v[100:103]
ds_read_b64_tr_b16 v[124:125], v20 offset:0
ds_read_b64_tr_b16 v[126:127], v20 offset:768
s_waitcnt lgkmcnt(7)
v_mfma_f32_16x16x32_bf16 v[32:35], v[224:227], v[112:115], v[32:35]
ds_read_b64_tr_b16 v[80:81], v17 offset:96
ds_read_b64_tr_b16 v[82:83], v17 offset:864
s_waitcnt lgkmcnt(8)
v_mfma_f32_16x16x32_bf16 v[36:39], v[228:231], v[112:115], v[36:39]
ds_read_b64_tr_b16 v[84:85], v16 offset:128
s_waitcnt lgkmcnt(7)
v_mfma_f32_16x16x32_bf16 v[40:43], v[224:227], v[116:119], v[40:43]
ds_read_b64_tr_b16 v[86:87], v16 offset:896
v_mfma_f32_16x16x32_bf16 v[44:47], v[228:231], v[116:119], v[44:47]
ds_read_b64_tr_b16 v[88:89], v17 offset:160
s_waitcnt lgkmcnt(7)
v_mfma_f32_16x16x32_bf16 v[48:51], v[224:227], v[120:123], v[48:51]
ds_read_b64_tr_b16 v[90:91], v17 offset:928
v_mfma_f32_16x16x32_bf16 v[52:55], v[228:231], v[120:123], v[52:55]
ds_read_b64_tr_b16 v[92:93], v21 offset:0
s_waitcnt lgkmcnt(7)
v_mfma_f32_16x16x32_bf16 v[96:99], v[28:31], v[124:127], v[96:99]
ds_read_b64_tr_b16 v[94:95], v21 offset:768
s_waitcnt lgkmcnt(6)
v_mfma_f32_16x16x32_bf16 v[56:59], v[224:227], v[80:83], v[56:59]
ds_read_b128 v[232:235], v15 offset:0
ds_read_b64_tr_b16 v[104:105], v16 offset:6144
v_mfma_f32_16x16x32_bf16 v[60:63], v[228:231], v[80:83], v[60:63]
ds_read_b64_tr_b16 v[106:107], v16 offset:6912
ds_read_b128 v[236:239], v15 offset:2048
s_waitcnt lgkmcnt(8)
v_mfma_f32_16x16x32_bf16 v[64:67], v[224:227], v[84:87], v[64:67]
ds_read_b64_tr_b16 v[108:109], v17 offset:6176
ds_read_b64_tr_b16 v[110:111], v17 offset:6944
v_mfma_f32_16x16x32_bf16 v[68:71], v[228:231], v[84:87], v[68:71]
ds_read_b64_tr_b16 v[112:113], v16 offset:6208
s_waitcnt lgkmcnt(9)
v_mfma_f32_16x16x32_bf16 v[72:75], v[224:227], v[88:91], v[72:75]
ds_read_b64_tr_b16 v[114:115], v16 offset:6976
v_mfma_f32_16x16x32_bf16 v[76:79], v[228:231], v[88:91], v[76:79]
ds_read_b64_tr_b16 v[116:117], v20 offset:6144
s_waitcnt lgkmcnt(9)
v_mfma_f32_16x16x32_bf16 v[100:103], v[28:31], v[92:95], v[100:103]
ds_read_b64_tr_b16 v[118:119], v20 offset:6912
s_waitcnt lgkmcnt(7)
v_mfma_f32_16x16x32_bf16 v[32:35], v[232:235], v[104:107], v[32:35]
ds_read_b64_tr_b16 v[120:121], v17 offset:6240
ds_read_b64_tr_b16 v[122:123], v17 offset:7008
s_waitcnt lgkmcnt(8)
v_mfma_f32_16x16x32_bf16 v[36:39], v[236:239], v[104:107], v[36:39]
ds_read_b64_tr_b16 v[124:125], v16 offset:6272
s_waitcnt lgkmcnt(7)
v_mfma_f32_16x16x32_bf16 v[40:43], v[232:235], v[108:111], v[40:43]
ds_read_b64_tr_b16 v[126:127], v16 offset:7040
v_mfma_f32_16x16x32_bf16 v[44:47], v[236:239], v[108:111], v[44:47]
ds_read_b64_tr_b16 v[80:81], v17 offset:6304
s_waitcnt lgkmcnt(7)
v_mfma_f32_16x16x32_bf16 v[48:51], v[232:235], v[112:115], v[48:51]
ds_read_b64_tr_b16 v[82:83], v17 offset:7072
v_mfma_f32_16x16x32_bf16 v[52:55], v[236:239], v[112:115], v[52:55]
ds_read_b64_tr_b16 v[84:85], v21 offset:6144
s_waitcnt lgkmcnt(7)
v_mfma_f32_16x16x32_bf16 v[96:99], v[28:31], v[116:119], v[96:99]
ds_read_b64_tr_b16 v[86:87], v21 offset:6912
s_waitcnt lgkmcnt(6)
v_mfma_f32_16x16x32_bf16 v[56:59], v[232:235], v[120:123], v[56:59]
v_mfma_f32_16x16x32_bf16 v[60:63], v[236:239], v[120:123], v[60:63]
s_waitcnt lgkmcnt(4)
v_mfma_f32_16x16x32_bf16 v[64:67], v[232:235], v[124:127], v[64:67]
v_add_u32 v14, 28672, v10
v_add_u32 v15, 28672, v11
v_add_u32 v16, 45056, v12
v_add_u32 v17, 45056, v13
v_add_u32 v20, 45056, v18
v_add_u32 v21, 45056, v19
s_waitcnt lgkmcnt(0)
s_barrier
ds_read_b128 v[240:243], v14 offset:0
ds_read_b64_tr_b16 v[88:89], v16 offset:0
v_mfma_f32_16x16x32_bf16 v[68:71], v[236:239], v[124:127], v[68:71]
ds_read_b64_tr_b16 v[90:91], v16 offset:768
ds_read_b128 v[244:247], v14 offset:2048
v_mfma_f32_16x16x32_bf16 v[72:75], v[232:235], v[80:83], v[72:75]
ds_read_b64_tr_b16 v[92:93], v17 offset:32
ds_read_b64_tr_b16 v[94:95], v17 offset:800
v_mfma_f32_16x16x32_bf16 v[76:79], v[236:239], v[80:83], v[76:79]
ds_read_b64_tr_b16 v[104:105], v16 offset:64
ds_read_b64_tr_b16 v[106:107], v16 offset:832
v_mfma_f32_16x16x32_bf16 v[100:103], v[28:31], v[84:87], v[100:103]
ds_read_b64_tr_b16 v[108:109], v20 offset:0
ds_read_b64_tr_b16 v[110:111], v20 offset:768
s_waitcnt lgkmcnt(7)
v_mfma_f32_16x16x32_bf16 v[32:35], v[240:243], v[88:91], v[32:35]
ds_read_b64_tr_b16 v[112:113], v17 offset:96
ds_read_b64_tr_b16 v[114:115], v17 offset:864
s_waitcnt lgkmcnt(8)
v_mfma_f32_16x16x32_bf16 v[36:39], v[244:247], v[88:91], v[36:39]
ds_read_b64_tr_b16 v[116:117], v16 offset:128
s_waitcnt lgkmcnt(7)
v_mfma_f32_16x16x32_bf16 v[40:43], v[240:243], v[92:95], v[40:43]
ds_read_b64_tr_b16 v[118:119], v16 offset:896
v_mfma_f32_16x16x32_bf16 v[44:47], v[244:247], v[92:95], v[44:47]
ds_read_b64_tr_b16 v[120:121], v17 offset:160
s_waitcnt lgkmcnt(7)
v_mfma_f32_16x16x32_bf16 v[48:51], v[240:243], v[104:107], v[48:51]
ds_read_b64_tr_b16 v[122:123], v17 offset:928
v_mfma_f32_16x16x32_bf16 v[52:55], v[244:247], v[104:107], v[52:55]
ds_read_b64_tr_b16 v[124:125], v21 offset:0
s_waitcnt lgkmcnt(7)
v_mfma_f32_16x16x32_bf16 v[96:99], v[28:31], v[108:111], v[96:99]
ds_read_b64_tr_b16 v[126:127], v21 offset:768
s_waitcnt lgkmcnt(6)
v_mfma_f32_16x16x32_bf16 v[56:59], v[240:243], v[112:115], v[56:59]
ds_read_b128 v[248:251], v15 offset:0
ds_read_b64_tr_b16 v[80:81], v16 offset:6144
v_mfma_f32_16x16x32_bf16 v[60:63], v[244:247], v[112:115], v[60:63]
ds_read_b64_tr_b16 v[82:83], v16 offset:6912
ds_read_b128 v[252:255], v15 offset:2048
s_waitcnt lgkmcnt(8)
v_mfma_f32_16x16x32_bf16 v[64:67], v[240:243], v[116:119], v[64:67]
ds_read_b64_tr_b16 v[84:85], v20 offset:6144
ds_read_b64_tr_b16 v[86:87], v20 offset:6912
v_mfma_f32_16x16x32_bf16 v[68:71], v[244:247], v[116:119], v[68:71]
ds_read_b64_tr_b16 v[88:89], v17 offset:6176
ds_read_b64_tr_b16 v[90:91], v17 offset:6944
s_waitcnt lgkmcnt(10)
v_mfma_f32_16x16x32_bf16 v[72:75], v[240:243], v[120:123], v[72:75]
ds_read_b64_tr_b16 v[92:93], v21 offset:6144
v_mfma_f32_16x16x32_bf16 v[76:79], v[244:247], v[120:123], v[76:79]
ds_read_b64_tr_b16 v[94:95], v21 offset:6912
s_waitcnt lgkmcnt(10)
v_mfma_f32_16x16x32_bf16 v[100:103], v[28:31], v[124:127], v[100:103]
ds_read_b64_tr_b16 v[104:105], v16 offset:6208
ds_read_b64_tr_b16 v[106:107], v16 offset:6976
s_waitcnt lgkmcnt(9)
v_mfma_f32_16x16x32_bf16 v[32:35], v[248:251], v[80:83], v[32:35]
ds_read_b64_tr_b16 v[108:109], v17 offset:6240
s_waitcnt lgkmcnt(9)
v_mfma_f32_16x16x32_bf16 v[36:39], v[252:255], v[80:83], v[36:39]
ds_read_b64_tr_b16 v[110:111], v17 offset:7008
s_waitcnt lgkmcnt(8)
v_mfma_f32_16x16x32_bf16 v[96:99], v[28:31], v[84:87], v[96:99]
ds_read_b64_tr_b16 v[112:113], v16 offset:6272
s_waitcnt lgkmcnt(7)
v_mfma_f32_16x16x32_bf16 v[40:43], v[248:251], v[88:91], v[40:43]
ds_read_b64_tr_b16 v[114:115], v16 offset:7040
v_mfma_f32_16x16x32_bf16 v[44:47], v[252:255], v[88:91], v[44:47]
ds_read_b64_tr_b16 v[116:117], v17 offset:6304
s_waitcnt lgkmcnt(7)
v_mfma_f32_16x16x32_bf16 v[100:103], v[28:31], v[92:95], v[100:103]
ds_read_b64_tr_b16 v[118:119], v17 offset:7072
s_waitcnt lgkmcnt(6)
v_mfma_f32_16x16x32_bf16 v[48:51], v[248:251], v[104:107], v[48:51]
v_mfma_f32_16x16x32_bf16 v[52:55], v[252:255], v[104:107], v[52:55]
s_waitcnt lgkmcnt(4)
v_mfma_f32_16x16x32_bf16 v[56:59], v[248:251], v[108:111], v[56:59]
v_mfma_f32_16x16x32_bf16 v[60:63], v[252:255], v[108:111], v[60:63]
s_waitcnt lgkmcnt(2)
v_mfma_f32_16x16x32_bf16 v[64:67], v[248:251], v[112:115], v[64:67]
v_mfma_f32_16x16x32_bf16 v[68:71], v[252:255], v[112:115], v[68:71]
s_waitcnt lgkmcnt(0)
v_mfma_f32_16x16x32_bf16 v[72:75], v[248:251], v[116:119], v[72:75]
v_mfma_f32_16x16x32_bf16 v[76:79], v[252:255], v[116:119], v[76:79]
ds_write_b32 v22, v96
ds_write_b32 v23, v100
ds_write_b32 v26, v27
v_mov_b32 v3, 163328
ds_read_b128 v[80:83], v4 offset:0
ds_read_b128 v[84:87], v4 offset:640
ds_read_b128 v[88:91], v4 offset:1280
ds_read_b128 v[92:95], v4 offset:1920
ds_read_b128 v[96:99], v4 offset:64
ds_read_b128 v[100:103], v4 offset:704
ds_read_b128 v[104:107], v4 offset:1344
ds_read_b128 v[108:111], v4 offset:1984
s_mov_b32 s63, 0
Llw_46:
ds_read_b128 v[112:115], v3
s_add_u32 s63, s63, 1
s_waitcnt lgkmcnt(0)
v_and_b32 v112, v112, v113
v_and_b32 v114, v114, v115
v_and_b32 v112, v112, v114
v_cmp_ne_u32 vcc, 0, v112
s_cbranch_vccnz Llk_47
s_cmp_lt_u32 s63, 0x100000
s_cbranch_scc1 Llw_46
Llk_47:
ds_read_b32 v10, v6 offset:0
ds_read_b32 v11, v6 offset:64
ds_read_b32 v14, v6 offset:128
ds_read_b32 v15, v6 offset:192
ds_read_b32 v16, v6 offset:256
ds_read_b32 v17, v6 offset:320
s_lshl_b32 s61, s4, 12
v_add_u32 v30, s61, v8
s_waitcnt lgkmcnt(0)
s_cmp_gt_u32 s58, 0
s_cbranch_scc0 Lz2skip_48
v_pk_fma_f32 v[32:33], v[80:81], v[10:11], v[32:33] op_sel:[0,0,0] op_sel_hi:[1,0,1] neg_lo:[1,0,0] neg_hi:[1,0,0]
v_pk_fma_f32 v[34:35], v[82:83], v[10:11], v[34:35] op_sel:[0,0,0] op_sel_hi:[1,0,1] neg_lo:[1,0,0] neg_hi:[1,0,0]
v_pk_fma_f32 v[36:37], v[96:97], v[10:11], v[36:37] op_sel:[0,0,0] op_sel_hi:[1,0,1] neg_lo:[1,0,0] neg_hi:[1,0,0]
v_pk_fma_f32 v[38:39], v[98:99], v[10:11], v[38:39] op_sel:[0,0,0] op_sel_hi:[1,0,1] neg_lo:[1,0,0] neg_hi:[1,0,0]
v_pk_mul_f32 v[20:21], v[32:33], v[32:33]
v_pk_mul_f32 v[22:23], v[34:35], v[34:35]
v_pk_mul_f32 v[26:27], v[36:37], v[36:37]
v_pk_mul_f32 v[28:29], v[38:39], v[38:39]
v_pk_fma_f32 v[20:21], v[20:21], v[84:85], v[88:89]
v_pk_fma_f32 v[22:23], v[22:23], v[86:87], v[90:91]
v_pk_fma_f32 v[26:27], v[26:27], v[100:101], v[104:105]
v_pk_fma_f32 v[28:29], v[28:29], v[102:103], v[106:107]
v_pk_mul_f32 v[20:21], v[20:21], v[32:33]
v_pk_mul_f32 v[22:23], v[22:23], v[34:35]
v_pk_mul_f32 v[26:27], v[26:27], v[36:37]
v_pk_mul_f32 v[28:29], v[28:29], v[38:39]
v_exp_f32 v20, v20
v_exp_f32 v21, v21
v_exp_f32 v22, v22
v_exp_f32 v23, v23
v_exp_f32 v26, v26
v_exp_f32 v27, v27
v_exp_f32 v28, v28
v_exp_f32 v29, v29
v_pk_fma_f32 v[20:21], v[20:21], v[92:93], v[92:93]
v_pk_fma_f32 v[22:23], v[22:23], v[94:95], v[94:95]
v_pk_fma_f32 v[26:27], v[26:27], v[108:109], v[108:109]
v_pk_fma_f32 v[28:29], v[28:29], v[110:111], v[110:111]
v_rcp_f32 v20, v20
v_rcp_f32 v21, v21
v_rcp_f32 v22, v22
v_rcp_f32 v23, v23
v_rcp_f32 v26, v26
v_rcp_f32 v27, v27
v_rcp_f32 v28, v28
v_rcp_f32 v29, v29
v_pk_mul_f32 v[32:33], v[32:33], v[20:21]
v_pk_mul_f32 v[34:35], v[34:35], v[22:23]
v_pk_mul_f32 v[36:37], v[36:37], v[26:27]
v_pk_mul_f32 v[38:39], v[38:39], v[28:29]
v_pk_add_f32 v[112:113], v[32:33], 0 op_sel_hi:[1,0]
v_pk_add_f32 v[114:115], v[34:35], 0 op_sel_hi:[1,0]
v_pk_add_f32 v[116:117], v[36:37], 0 op_sel_hi:[1,0]
v_pk_add_f32 v[118:119], v[38:39], 0 op_sel_hi:[1,0]
v_pk_mul_f32 v[120:121], v[32:33], v[32:33]
v_pk_mul_f32 v[122:123], v[34:35], v[34:35]
v_pk_mul_f32 v[124:125], v[36:37], v[36:37]
v_pk_mul_f32 v[126:127], v[38:39], v[38:39]
Lz2skip_48:
s_cmp_gt_u32 s58, 1
s_cbranch_scc0 Lz2skip_49
v_pk_fma_f32 v[40:41], v[80:81], v[10:11], v[40:41] op_sel:[0,1,0] op_sel_hi:[1,1,1] neg_lo:[1,0,0] neg_hi:[1,0,0]
v_pk_fma_f32 v[42:43], v[82:83], v[10:11], v[42:43] op_sel:[0,1,0] op_sel_hi:[1,1,1] neg_lo:[1,0,0] neg_hi:[1,0,0]
v_pk_fma_f32 v[44:45], v[96:97], v[10:11], v[44:45] op_sel:[0,1,0] op_sel_hi:[1,1,1] neg_lo:[1,0,0] neg_hi:[1,0,0]
v_pk_fma_f32 v[46:47], v[98:99], v[10:11], v[46:47] op_sel:[0,1,0] op_sel_hi:[1,1,1] neg_lo:[1,0,0] neg_hi:[1,0,0]
v_pk_mul_f32 v[20:21], v[40:41], v[40:41]
v_pk_mul_f32 v[22:23], v[42:43], v[42:43]
v_pk_mul_f32 v[26:27], v[44:45], v[44:45]
v_pk_mul_f32 v[28:29], v[46:47], v[46:47]
v_pk_fma_f32 v[20:21], v[20:21], v[84:85], v[88:89]
v_pk_fma_f32 v[22:23], v[22:23], v[86:87], v[90:91]
v_pk_fma_f32 v[26:27], v[26:27], v[100:101], v[104:105]
v_pk_fma_f32 v[28:29], v[28:29], v[102:103], v[106:107]
v_pk_mul_f32 v[20:21], v[20:21], v[40:41]
v_pk_mul_f32 v[22:23], v[22:23], v[42:43]
v_pk_mul_f32 v[26:27], v[26:27], v[44:45]
v_pk_mul_f32 v[28:29], v[28:29], v[46:47]
v_exp_f32 v20, v20
v_exp_f32 v21, v21
v_exp_f32 v22, v22
v_exp_f32 v23, v23
v_exp_f32 v26, v26
v_exp_f32 v27, v27
v_exp_f32 v28, v28
v_exp_f32 v29, v29
v_pk_fma_f32 v[20:21], v[20:21], v[92:93], v[92:93]
v_pk_fma_f32 v[22:23], v[22:23], v[94:95], v[94:95]
v_pk_fma_f32 v[26:27], v[26:27], v[108:109], v[108:109]
v_pk_fma_f32 v[28:29], v[28:29], v[110:111], v[110:111]
v_rcp_f32 v20, v20
v_rcp_f32 v21, v21
v_rcp_f32 v22, v22
v_rcp_f32 v23, v23
v_rcp_f32 v26, v26
v_rcp_f32 v27, v27
v_rcp_f32 v28, v28
v_rcp_f32 v29, v29
v_pk_mul_f32 v[40:41], v[40:41], v[20:21]
v_pk_mul_f32 v[42:43], v[42:43], v[22:23]
v_pk_mul_f32 v[44:45], v[44:45], v[26:27]
v_pk_mul_f32 v[46:47], v[46:47], v[28:29]
v_pk_add_f32 v[112:113], v[112:113], v[40:41]
v_pk_add_f32 v[114:115], v[114:115], v[42:43]
v_pk_add_f32 v[116:117], v[116:117], v[44:45]
v_pk_add_f32 v[118:119], v[118:119], v[46:47]
v_pk_fma_f32 v[120:121], v[40:41], v[40:41], v[120:121]
v_pk_fma_f32 v[122:123], v[42:43], v[42:43], v[122:123]
v_pk_fma_f32 v[124:125], v[44:45], v[44:45], v[124:125]
v_pk_fma_f32 v[126:127], v[46:47], v[46:47], v[126:127]
Lz2skip_49:
s_cmp_gt_u32 s58, 2
s_cbranch_scc0 Lz2skip_50
v_pk_fma_f32 v[48:49], v[80:81], v[14:15], v[48:49] op_sel:[0,0,0] op_sel_hi:[1,0,1] neg_lo:[1,0,0] neg_hi:[1,0,0]
v_pk_fma_f32 v[50:51], v[82:83], v[14:15], v[50:51] op_sel:[0,0,0] op_sel_hi:[1,0,1] neg_lo:[1,0,0] neg_hi:[1,0,0]
v_pk_fma_f32 v[52:53], v[96:97], v[14:15], v[52:53] op_sel:[0,0,0] op_sel_hi:[1,0,1] neg_lo:[1,0,0] neg_hi:[1,0,0]
v_pk_fma_f32 v[54:55], v[98:99], v[14:15], v[54:55] op_sel:[0,0,0] op_sel_hi:[1,0,1] neg_lo:[1,0,0] neg_hi:[1,0,0]
v_pk_mul_f32 v[20:21], v[48:49], v[48:49]
v_pk_mul_f32 v[22:23], v[50:51], v[50:51]
v_pk_mul_f32 v[26:27], v[52:53], v[52:53]
v_pk_mul_f32 v[28:29], v[54:55], v[54:55]
v_pk_fma_f32 v[20:21], v[20:21], v[84:85], v[88:89]
v_pk_fma_f32 v[22:23], v[22:23], v[86:87], v[90:91]
v_pk_fma_f32 v[26:27], v[26:27], v[100:101], v[104:105]
v_pk_fma_f32 v[28:29], v[28:29], v[102:103], v[106:107]
v_pk_mul_f32 v[20:21], v[20:21], v[48:49]
v_pk_mul_f32 v[22:23], v[22:23], v[50:51]
v_pk_mul_f32 v[26:27], v[26:27], v[52:53]
v_pk_mul_f32 v[28:29], v[28:29], v[54:55]
v_exp_f32 v20, v20
v_exp_f32 v21, v21
v_exp_f32 v22, v22
v_exp_f32 v23, v23
v_exp_f32 v26, v26
v_exp_f32 v27, v27
v_exp_f32 v28, v28
v_exp_f32 v29, v29
v_pk_fma_f32 v[20:21], v[20:21], v[92:93], v[92:93]
v_pk_fma_f32 v[22:23], v[22:23], v[94:95], v[94:95]
v_pk_fma_f32 v[26:27], v[26:27], v[108:109], v[108:109]
v_pk_fma_f32 v[28:29], v[28:29], v[110:111], v[110:111]
v_rcp_f32 v20, v20
v_rcp_f32 v21, v21
v_rcp_f32 v22, v22
v_rcp_f32 v23, v23
v_rcp_f32 v26, v26
v_rcp_f32 v27, v27
v_rcp_f32 v28, v28
v_rcp_f32 v29, v29
v_pk_mul_f32 v[48:49], v[48:49], v[20:21]
v_pk_mul_f32 v[50:51], v[50:51], v[22:23]
v_pk_mul_f32 v[52:53], v[52:53], v[26:27]
v_pk_mul_f32 v[54:55], v[54:55], v[28:29]
v_pk_add_f32 v[112:113], v[112:113], v[48:49]
v_pk_add_f32 v[114:115], v[114:115], v[50:51]
v_pk_add_f32 v[116:117], v[116:117], v[52:53]
v_pk_add_f32 v[118:119], v[118:119], v[54:55]
v_pk_fma_f32 v[120:121], v[48:49], v[48:49], v[120:121]
v_pk_fma_f32 v[122:123], v[50:51], v[50:51], v[122:123]
v_pk_fma_f32 v[124:125], v[52:53], v[52:53], v[124:125]
v_pk_fma_f32 v[126:127], v[54:55], v[54:55], v[126:127]
Lz2skip_50:
s_cmp_gt_u32 s58, 3
s_cbranch_scc0 Lz2skip_51
v_pk_fma_f32 v[56:57], v[80:81], v[14:15], v[56:57] op_sel:[0,1,0] op_sel_hi:[1,1,1] neg_lo:[1,0,0] neg_hi:[1,0,0]
v_pk_fma_f32 v[58:59], v[82:83], v[14:15], v[58:59] op_sel:[0,1,0] op_sel_hi:[1,1,1] neg_lo:[1,0,0] neg_hi:[1,0,0]
v_pk_fma_f32 v[60:61], v[96:97], v[14:15], v[60:61] op_sel:[0,1,0] op_sel_hi:[1,1,1] neg_lo:[1,0,0] neg_hi:[1,0,0]
v_pk_fma_f32 v[62:63], v[98:99], v[14:15], v[62:63] op_sel:[0,1,0] op_sel_hi:[1,1,1] neg_lo:[1,0,0] neg_hi:[1,0,0]
v_pk_mul_f32 v[20:21], v[56:57], v[56:57]
v_pk_mul_f32 v[22:23], v[58:59], v[58:59]
v_pk_mul_f32 v[26:27], v[60:61], v[60:61]
v_pk_mul_f32 v[28:29], v[62:63], v[62:63]
v_pk_fma_f32 v[20:21], v[20:21], v[84:85], v[88:89]
v_pk_fma_f32 v[22:23], v[22:23], v[86:87], v[90:91]
v_pk_fma_f32 v[26:27], v[26:27], v[100:101], v[104:105]
v_pk_fma_f32 v[28:29], v[28:29], v[102:103], v[106:107]
v_pk_mul_f32 v[20:21], v[20:21], v[56:57]
v_pk_mul_f32 v[22:23], v[22:23], v[58:59]
v_pk_mul_f32 v[26:27], v[26:27], v[60:61]
v_pk_mul_f32 v[28:29], v[28:29], v[62:63]
v_exp_f32 v20, v20
v_exp_f32 v21, v21
v_exp_f32 v22, v22
v_exp_f32 v23, v23
v_exp_f32 v26, v26
v_exp_f32 v27, v27
v_exp_f32 v28, v28
v_exp_f32 v29, v29
v_pk_fma_f32 v[20:21], v[20:21], v[92:93], v[92:93]
v_pk_fma_f32 v[22:23], v[22:23], v[94:95], v[94:95]
v_pk_fma_f32 v[26:27], v[26:27], v[108:109], v[108:109]
v_pk_fma_f32 v[28:29], v[28:29], v[110:111], v[110:111]
v_rcp_f32 v20, v20
v_rcp_f32 v21, v21
v_rcp_f32 v22, v22
v_rcp_f32 v23, v23
v_rcp_f32 v26, v26
v_rcp_f32 v27, v27
v_rcp_f32 v28, v28
v_rcp_f32 v29, v29
v_pk_mul_f32 v[56:57], v[56:57], v[20:21]
v_pk_mul_f32 v[58:59], v[58:59], v[22:23]
v_pk_mul_f32 v[60:61], v[60:61], v[26:27]
v_pk_mul_f32 v[62:63], v[62:63], v[28:29]
v_pk_add_f32 v[112:113], v[112:113], v[56:57]
v_pk_add_f32 v[114:115], v[114:115], v[58:59]
v_pk_add_f32 v[116:117], v[116:117], v[60:61]
v_pk_add_f32 v[118:119], v[118:119], v[62:63]
v_pk_fma_f32 v[120:121], v[56:57], v[56:57], v[120:121]
v_pk_fma_f32 v[122:123], v[58:59], v[58:59], v[122:123]
v_pk_fma_f32 v[124:125], v[60:61], v[60:61], v[124:125]
v_pk_fma_f32 v[126:127], v[62:63], v[62:63], v[126:127]
Lz2skip_51:
s_cmp_gt_u32 s58, 4
s_cbranch_scc0 Lz2skip_52
v_pk_fma_f32 v[64:65], v[80:81], v[16:17], v[64:65] op_sel:[0,0,0] op_sel_hi:[1,0,1] neg_lo:[1,0,0] neg_hi:[1,0,0]
v_pk_fma_f32 v[66:67], v[82:83], v[16:17], v[66:67] op_sel:[0,0,0] op_sel_hi:[1,0,1] neg_lo:[1,0,0] neg_hi:[1,0,0]
v_pk_fma_f32 v[68:69], v[96:97], v[16:17], v[68:69] op_sel:[0,0,0] op_sel_hi:[1,0,1] neg_lo:[1,0,0] neg_hi:[1,0,0]
v_pk_fma_f32 v[70:71], v[98:99], v[16:17], v[70:71] op_sel:[0,0,0] op_sel_hi:[1,0,1] neg_lo:[1,0,0] neg_hi:[1,0,0]
v_pk_mul_f32 v[20:21], v[64:65], v[64:65]
v_pk_mul_f32 v[22:23], v[66:67], v[66:67]
v_pk_mul_f32 v[26:27], v[68:69], v[68:69]
v_pk_mul_f32 v[28:29], v[70:71], v[70:71]
v_pk_fma_f32 v[20:21], v[20:21], v[84:85], v[88:89]
v_pk_fma_f32 v[22:23], v[22:23], v[86:87], v[90:91]
v_pk_fma_f32 v[26:27], v[26:27], v[100:101], v[104:105]
v_pk_fma_f32 v[28:29], v[28:29], v[102:103], v[106:107]
v_pk_mul_f32 v[20:21], v[20:21], v[64:65]
v_pk_mul_f32 v[22:23], v[22:23], v[66:67]
v_pk_mul_f32 v[26:27], v[26:27], v[68:69]
v_pk_mul_f32 v[28:29], v[28:29], v[70:71]
v_exp_f32 v20, v20
v_exp_f32 v21, v21
v_exp_f32 v22, v22
v_exp_f32 v23, v23
v_exp_f32 v26, v26
v_exp_f32 v27, v27
v_exp_f32 v28, v28
v_exp_f32 v29, v29
v_pk_fma_f32 v[20:21], v[20:21], v[92:93], v[92:93]
v_pk_fma_f32 v[22:23], v[22:23], v[94:95], v[94:95]
v_pk_fma_f32 v[26:27], v[26:27], v[108:109], v[108:109]
v_pk_fma_f32 v[28:29], v[28:29], v[110:111], v[110:111]
v_rcp_f32 v20, v20
v_rcp_f32 v21, v21
v_rcp_f32 v22, v22
v_rcp_f32 v23, v23
v_rcp_f32 v26, v26
v_rcp_f32 v27, v27
v_rcp_f32 v28, v28
v_rcp_f32 v29, v29
v_pk_mul_f32 v[64:65], v[64:65], v[20:21]
v_pk_mul_f32 v[66:67], v[66:67], v[22:23]
v_pk_mul_f32 v[68:69], v[68:69], v[26:27]
v_pk_mul_f32 v[70:71], v[70:71], v[28:29]
v_pk_add_f32 v[112:113], v[112:113], v[64:65]
v_pk_add_f32 v[114:115], v[114:115], v[66:67]
v_pk_add_f32 v[116:117], v[116:117], v[68:69]
v_pk_add_f32 v[118:119], v[118:119], v[70:71]
v_pk_fma_f32 v[120:121], v[64:65], v[64:65], v[120:121]
v_pk_fma_f32 v[122:123], v[66:67], v[66:67], v[122:123]
v_pk_fma_f32 v[124:125], v[68:69], v[68:69], v[124:125]
v_pk_fma_f32 v[126:127], v[70:71], v[70:71], v[126:127]
Lz2skip_52:
s_cmp_gt_u32 s58, 5
s_cbranch_scc0 Lz2skip_53
v_pk_fma_f32 v[72:73], v[80:81], v[16:17], v[72:73] op_sel:[0,1,0] op_sel_hi:[1,1,1] neg_lo:[1,0,0] neg_hi:[1,0,0]
v_pk_fma_f32 v[74:75], v[82:83], v[16:17], v[74:75] op_sel:[0,1,0] op_sel_hi:[1,1,1] neg_lo:[1,0,0] neg_hi:[1,0,0]
v_pk_fma_f32 v[76:77], v[96:97], v[16:17], v[76:77] op_sel:[0,1,0] op_sel_hi:[1,1,1] neg_lo:[1,0,0] neg_hi:[1,0,0]
v_pk_fma_f32 v[78:79], v[98:99], v[16:17], v[78:79] op_sel:[0,1,0] op_sel_hi:[1,1,1] neg_lo:[1,0,0] neg_hi:[1,0,0]
v_pk_mul_f32 v[20:21], v[72:73], v[72:73]
v_pk_mul_f32 v[22:23], v[74:75], v[74:75]
v_pk_mul_f32 v[26:27], v[76:77], v[76:77]
v_pk_mul_f32 v[28:29], v[78:79], v[78:79]
v_pk_fma_f32 v[20:21], v[20:21], v[84:85], v[88:89]
v_pk_fma_f32 v[22:23], v[22:23], v[86:87], v[90:91]
v_pk_fma_f32 v[26:27], v[26:27], v[100:101], v[104:105]
v_pk_fma_f32 v[28:29], v[28:29], v[102:103], v[106:107]
v_pk_mul_f32 v[20:21], v[20:21], v[72:73]
v_pk_mul_f32 v[22:23], v[22:23], v[74:75]
v_pk_mul_f32 v[26:27], v[26:27], v[76:77]
v_pk_mul_f32 v[28:29], v[28:29], v[78:79]
v_exp_f32 v20, v20
v_exp_f32 v21, v21
v_exp_f32 v22, v22
v_exp_f32 v23, v23
v_exp_f32 v26, v26
v_exp_f32 v27, v27
v_exp_f32 v28, v28
v_exp_f32 v29, v29
v_pk_fma_f32 v[20:21], v[20:21], v[92:93], v[92:93]
v_pk_fma_f32 v[22:23], v[22:23], v[94:95], v[94:95]
v_pk_fma_f32 v[26:27], v[26:27], v[108:109], v[108:109]
v_pk_fma_f32 v[28:29], v[28:29], v[110:111], v[110:111]
v_rcp_f32 v20, v20
v_rcp_f32 v21, v21
v_rcp_f32 v22, v22
v_rcp_f32 v23, v23
v_rcp_f32 v26, v26
v_rcp_f32 v27, v27
v_rcp_f32 v28, v28
v_rcp_f32 v29, v29
v_pk_mul_f32 v[72:73], v[72:73], v[20:21]
v_pk_mul_f32 v[74:75], v[74:75], v[22:23]
v_pk_mul_f32 v[76:77], v[76:77], v[26:27]
v_pk_mul_f32 v[78:79], v[78:79], v[28:29]
v_pk_add_f32 v[112:113], v[112:113], v[72:73]
v_pk_add_f32 v[114:115], v[114:115], v[74:75]
v_pk_add_f32 v[116:117], v[116:117], v[76:77]
v_pk_add_f32 v[118:119], v[118:119], v[78:79]
v_pk_fma_f32 v[120:121], v[72:73], v[72:73], v[120:121]
v_pk_fma_f32 v[122:123], v[74:75], v[74:75], v[122:123]
v_pk_fma_f32 v[124:125], v[76:77], v[76:77], v[124:125]
v_pk_fma_f32 v[126:127], v[78:79], v[78:79], v[126:127]
Lz2skip_53:
v_add_f32_dpp v112, v112, v112 row_ror:8 row_mask:0xf bank_mask:0x3
v_add_f32_dpp v113, v113, v113 row_ror:8 row_mask:0xf bank_mask:0x3
v_add_f32_dpp v116, v116, v116 row_ror:8 row_mask:0xf bank_mask:0x3
v_add_f32_dpp v117, v117, v117 row_ror:8 row_mask:0xf bank_mask:0x3
v_add_f32_dpp v120, v120, v120 row_ror:8 row_mask:0xf bank_mask:0x3
v_add_f32_dpp v121, v121, v121 row_ror:8 row_mask:0xf bank_mask:0x3
v_add_f32_dpp v124, v124, v124 row_ror:8 row_mask:0xf bank_mask:0x3
v_add_f32_dpp v125, v125, v125 row_ror:8 row_mask:0xf bank_mask:0x3
v_add_f32_dpp v112, v114, v114 row_ror:8 row_mask:0xf bank_mask:0xc
v_add_f32_dpp v113, v115, v115 row_ror:8 row_mask:0xf bank_mask:0xc
v_add_f32_dpp v116, v118, v118 row_ror:8 row_mask:0xf bank_mask:0xc
v_add_f32_dpp v117, v119, v119 row_ror:8 row_mask:0xf bank_mask:0xc
v_add_f32_dpp v120, v122, v122 row_ror:8 row_mask:0xf bank_mask:0xc
v_add_f32_dpp v121, v123, v123 row_ror:8 row_mask:0xf bank_mask:0xc
v_add_f32_dpp v124, v126, v126 row_ror:8 row_mask:0xf bank_mask:0xc
v_add_f32_dpp v125, v127, v127 row_ror:8 row_mask:0xf bank_mask:0xc
s_mov_b32 s60, 0x22222222
s_mov_b32 s61, 0x22222222
v_add_f32_dpp v112, v112, v112 row_half_mirror row_mask:0xf bank_mask:0x5
v_add_f32_dpp v116, v116, v116 row_half_mirror row_mask:0xf bank_mask:0x5
v_add_f32_dpp v120, v120, v120 row_half_mirror row_mask:0xf bank_mask:0x5
v_add_f32_dpp v124, v124, v124 row_half_mirror row_mask:0xf bank_mask:0x5
v_add_f32_dpp v112, v113, v113 row_half_mirror row_mask:0xf bank_mask:0xa
v_add_f32_dpp v116, v117, v117 row_half_mirror row_mask:0xf bank_mask:0xa
v_add_f32_dpp v120, v121, v121 row_half_mirror row_mask:0xf bank_mask:0xa
v_add_f32_dpp v124, v125, v125 row_half_mirror row_mask:0xf bank_mask:0xa
s_mov_b32 s62, 0x44444444
s_mov_b32 s63, 0x44444444
v_add_f32_dpp v112, v112, v112 quad_perm:[1,0,3,2] row_mask:0xf bank_mask:0xf
v_add_f32_dpp v116, v116, v116 quad_perm:[1,0,3,2] row_mask:0xf bank_mask:0xf
v_add_f32_dpp v120, v120, v120 quad_perm:[1,0,3,2] row_mask:0xf bank_mask:0xf
v_add_f32_dpp v124, v124, v124 quad_perm:[1,0,3,2] row_mask:0xf bank_mask:0xf
v_add_f32_dpp v112, v112, v112 quad_perm:[2,3,0,1] row_mask:0xf bank_mask:0xf
v_add_f32_dpp v116, v116, v116 quad_perm:[2,3,0,1] row_mask:0xf bank_mask:0xf
v_add_f32_dpp v120, v120, v120 quad_perm:[2,3,0,1] row_mask:0xf bank_mask:0xf
v_add_f32_dpp v124, v124, v124 quad_perm:[2,3,0,1] row_mask:0xf bank_mask:0xf
v_cndmask_b32 v112, v112, v120, s[60:61]
s_mov_b32 s60, 0x88888888
s_mov_b32 s61, 0x88888888
v_cndmask_b32 v112, v112, v116, s[62:63]
v_cndmask_b32 v112, v112, v124, s[60:61]
v_mov_b32_e64 v113, s52
buffer_store_dwordx2 v[112:113], v9, s[16:19], s56 offen sc1
v_cvt_pk_bf16_f32 v32, v32, v36
v_cvt_pk_bf16_f32 v33, v33, v37
v_cvt_pk_bf16_f32 v34, v34, v38
v_cvt_pk_bf16_f32 v35, v35, v39
ds_write_b128 v30, v[32:35] offset:0
v_cvt_pk_bf16_f32 v40, v40, v44
v_cvt_pk_bf16_f32 v41, v41, v45
v_cvt_pk_bf16_f32 v42, v42, v46
v_cvt_pk_bf16_f32 v43, v43, v47
ds_write_b128 v30, v[40:43] offset:1024
v_cvt_pk_bf16_f32 v48, v48, v52
v_cvt_pk_bf16_f32 v49, v49, v53
v_cvt_pk_bf16_f32 v50, v50, v54
v_cvt_pk_bf16_f32 v51, v51, v55
ds_write_b128 v30, v[48:51] offset:2048
v_cvt_pk_bf16_f32 v56, v56, v60
v_cvt_pk_bf16_f32 v57, v57, v61
v_cvt_pk_bf16_f32 v58, v58, v62
v_cvt_pk_bf16_f32 v59, v59, v63
ds_write_b128 v30, v[56:59] offset:3072
v_cvt_pk_bf16_f32 v64, v64, v68
v_cvt_pk_bf16_f32 v65, v65, v69
v_cvt_pk_bf16_f32 v66, v66, v70
v_cvt_pk_bf16_f32 v67, v67, v71
ds_write_b128 v30, v[64:67] offset:16384
v_cvt_pk_bf16_f32 v72, v72, v76
v_cvt_pk_bf16_f32 v73, v73, v77
v_cvt_pk_bf16_f32 v74, v74, v78
v_cvt_pk_bf16_f32 v75, v75, v79
ds_write_b128 v30, v[72:75] offset:17408
v_mov_b32 v28, 0x3f803f80
v_mov_b32 v29, 0x3f803f80
v_mov_b32 v30, 0x3f803f80
v_mov_b32 v31, 0x3f803f80
s_waitcnt lgkmcnt(0)
v_add_u32 v16, 86016, v12
v_add_u32 v17, 86016, v13
v_add_u32 v20, 86016, v18
v_add_u32 v21, 86016, v19
s_barrier
ds_read_b64_tr_b16 v[80:81], v16 offset:0
ds_read_b64_tr_b16 v[82:83], v16 offset:768
ds_read_b64_tr_b16 v[84:85], v17 offset:32
ds_read_b64_tr_b16 v[86:87], v17 offset:800
ds_read_b64_tr_b16 v[88:89], v16 offset:64
ds_read_b64_tr_b16 v[90:91], v16 offset:832
ds_read_b64_tr_b16 v[92:93], v20 offset:0
ds_read_b64_tr_b16 v[94:95], v20 offset:768
ds_read_b64_tr_b16 v[96:97], v17 offset:96
ds_read_b64_tr_b16 v[98:99], v17 offset:864
ds_read_b64_tr_b16 v[100:101], v16 offset:128
ds_read_b64_tr_b16 v[102:103], v16 offset:896
s_waitcnt lgkmcnt(10)
v_mfma_f32_16x16x32_bf16 v[32:35], v[80:83], v[128:131], 0
ds_read_b64_tr_b16 v[104:105], v17 offset:160
v_mfma_f32_16x16x32_bf16 v[36:39], v[80:83], v[132:135], 0
ds_read_b64_tr_b16 v[106:107], v17 offset:928
s_waitcnt lgkmcnt(10)
v_mfma_f32_16x16x32_bf16 v[40:43], v[84:87], v[128:131], 0
ds_read_b64_tr_b16 v[108:109], v21 offset:0
v_mfma_f32_16x16x32_bf16 v[44:47], v[84:87], v[132:135], 0
ds_read_b64_tr_b16 v[110:111], v21 offset:768
s_waitcnt lgkmcnt(10)
v_mfma_f32_16x16x32_bf16 v[48:51], v[88:91], v[128:131], 0
ds_read_b64_tr_b16 v[80:81], v16 offset:6144
v_mfma_f32_16x16x32_bf16 v[52:55], v[88:91], v[132:135], 0
ds_read_b64_tr_b16 v[82:83], v16 offset:6912
s_waitcnt lgkmcnt(10)
v_mfma_f32_16x16x32_bf16 v[120:123], v[92:95], v[28:31], 0
ds_read_b64_tr_b16 v[84:85], v17 offset:6176
s_waitcnt lgkmcnt(9)
v_mfma_f32_16x16x32_bf16 v[56:59], v[96:99], v[128:131], 0
ds_read_b64_tr_b16 v[86:87], v17 offset:6944
v_mfma_f32_16x16x32_bf16 v[60:63], v[96:99], v[132:135], 0
ds_read_b64_tr_b16 v[88:89], v16 offset:6208
s_waitcnt lgkmcnt(9)
v_mfma_f32_16x16x32_bf16 v[64:67], v[100:103], v[128:131], 0
ds_read_b64_tr_b16 v[90:91], v16 offset:6976
v_mfma_f32_16x16x32_bf16 v[68:71], v[100:103], v[132:135], 0
ds_read_b64_tr_b16 v[92:93], v20 offset:6144
s_waitcnt lgkmcnt(9)
v_mfma_f32_16x16x32_bf16 v[72:75], v[104:107], v[128:131], 0
ds_read_b64_tr_b16 v[94:95], v20 offset:6912
v_mfma_f32_16x16x32_bf16 v[76:79], v[104:107], v[132:135], 0
ds_read_b64_tr_b16 v[96:97], v17 offset:6240
s_waitcnt lgkmcnt(9)
v_mfma_f32_16x16x32_bf16 v[124:127], v[108:111], v[28:31], 0
ds_read_b64_tr_b16 v[98:99], v17 offset:7008
s_waitcnt lgkmcnt(8)
v_mfma_f32_16x16x32_bf16 v[32:35], v[80:83], v[136:139], v[32:35]
ds_read_b64_tr_b16 v[100:101], v16 offset:6272
v_mfma_f32_16x16x32_bf16 v[36:39], v[80:83], v[140:143], v[36:39]
ds_read_b64_tr_b16 v[102:103], v16 offset:7040
s_waitcnt lgkmcnt(8)
v_mfma_f32_16x16x32_bf16 v[40:43], v[84:87], v[136:139], v[40:43]
ds_read_b64_tr_b16 v[104:105], v17 offset:6304
v_mfma_f32_16x16x32_bf16 v[44:47], v[84:87], v[140:143], v[44:47]
ds_read_b64_tr_b16 v[106:107], v17 offset:7072
s_waitcnt lgkmcnt(8)
v_mfma_f32_16x16x32_bf16 v[48:51], v[88:91], v[136:139], v[48:51]
ds_read_b64_tr_b16 v[108:109], v21 offset:6144
v_mfma_f32_16x16x32_bf16 v[52:55], v[88:91], v[140:143], v[52:55]
ds_read_b64_tr_b16 v[110:111], v21 offset:6912
s_waitcnt lgkmcnt(8)
v_mfma_f32_16x16x32_bf16 v[120:123], v[92:95], v[28:31], v[120:123]
s_waitcnt lgkmcnt(6)
v_mfma_f32_16x16x32_bf16 v[56:59], v[96:99], v[136:139], v[56:59]
v_mfma_f32_16x16x32_bf16 v[60:63], v[96:99], v[140:143], v[60:63]
v_add_u32 v16, 98304, v12
v_add_u32 v17, 98304, v13
v_add_u32 v20, 98304, v18
v_add_u32 v21, 98304, v19
ds_read_b64_tr_b16 v[80:81], v16 offset:0
ds_read_b64_tr_b16 v[82:83], v16 offset:768
s_waitcnt lgkmcnt(6)
v_mfma_f32_16x16x32_bf16 v[64:67], v[100:103], v[136:139], v[64:67]
ds_read_b64_tr_b16 v[84:85], v17 offset:32
ds_read_b64_tr_b16 v[86:87], v17 offset:800
v_mfma_f32_16x16x32_bf16 v[68:71], v[100:103], v[140:143], v[68:71]
ds_read_b64_tr_b16 v[88:89], v16 offset:64
s_waitcnt lgkmcnt(7)
v_mfma_f32_16x16x32_bf16 v[72:75], v[104:107], v[136:139], v[72:75]
ds_read_b64_tr_b16 v[90:91], v16 offset:832
v_mfma_f32_16x16x32_bf16 v[76:79], v[104:107], v[140:143], v[76:79]
ds_read_b64_tr_b16 v[92:93], v20 offset:0
s_waitcnt lgkmcnt(7)
v_mfma_f32_16x16x32_bf16 v[124:127], v[108:111], v[28:31], v[124:127]
ds_read_b64_tr_b16 v[94:95], v20 offset:768
s_waitcnt lgkmcnt(6)
v_mfma_f32_16x16x32_bf16 v[32:35], v[80:83], v[144:147], v[32:35]
ds_read_b64_tr_b16 v[96:97], v17 offset:96
ds_read_b64_tr_b16 v[98:99], v17 offset:864
v_mfma_f32_16x16x32_bf16 v[36:39], v[80:83], v[148:151], v[36:39]
ds_read_b64_tr_b16 v[100:101], v16 offset:128
s_waitcnt lgkmcnt(7)
v_mfma_f32_16x16x32_bf16 v[40:43], v[84:87], v[144:147], v[40:43]
ds_read_b64_tr_b16 v[102:103], v16 offset:896
v_mfma_f32_16x16x32_bf16 v[44:47], v[84:87], v[148:151], v[44:47]
ds_read_b64_tr_b16 v[104:105], v17 offset:160
s_waitcnt lgkmcnt(7)
v_mfma_f32_16x16x32_bf16 v[48:51], v[88:91], v[144:147], v[48:51]
ds_read_b64_tr_b16 v[106:107], v17 offset:928
v_mfma_f32_16x16x32_bf16 v[52:55], v[88:91], v[148:151], v[52:55]
ds_read_b64_tr_b16 v[108:109], v21 offset:0
s_waitcnt lgkmcnt(7)
v_mfma_f32_16x16x32_bf16 v[120:123], v[92:95], v[28:31], v[120:123]
ds_read_b64_tr_b16 v[110:111], v21 offset:768
s_waitcnt lgkmcnt(6)
v_mfma_f32_16x16x32_bf16 v[56:59], v[96:99], v[144:147], v[56:59]
ds_read_b64_tr_b16 v[80:81], v16 offset:6144
ds_read_b64_tr_b16 v[82:83], v16 offset:6912
v_mfma_f32_16x16x32_bf16 v[60:63], v[96:99], v[148:151], v[60:63]
ds_read_b64_tr_b16 v[84:85], v17 offset:6176
s_waitcnt lgkmcnt(7)
v_mfma_f32_16x16x32_bf16 v[64:67], v[100:103], v[144:147], v[64:67]
ds_read_b64_tr_b16 v[86:87], v17 offset:6944
v_mfma_f32_16x16x32_bf16 v[68:71], v[100:103], v[148:151], v[68:71]
ds_read_b64_tr_b16 v[88:89], v16 offset:6208
s_waitcnt lgkmcnt(7)
v_mfma_f32_16x16x32_bf16 v[72:75], v[104:107], v[144:147], v[72:75]
ds_read_b64_tr_b16 v[90:91], v16 offset:6976
v_mfma_f32_16x16x32_bf16 v[76:79], v[104:107], v[148:151], v[76:79]
ds_read_b64_tr_b16 v[92:93], v20 offset:6144
s_waitcnt lgkmcnt(7)
v_mfma_f32_16x16x32_bf16 v[124:127], v[108:111], v[28:31], v[124:127]
ds_read_b64_tr_b16 v[94:95], v20 offset:6912
s_waitcnt lgkmcnt(6)
v_mfma_f32_16x16x32_bf16 v[32:35], v[80:83], v[152:155], v[32:35]
ds_read_b64_tr_b16 v[96:97], v17 offset:6240
ds_read_b64_tr_b16 v[98:99], v17 offset:7008
v_mfma_f32_16x16x32_bf16 v[36:39], v[80:83], v[156:159], v[36:39]
ds_read_b64_tr_b16 v[100:101], v16 offset:6272
s_waitcnt lgkmcnt(7)
v_mfma_f32_16x16x32_bf16 v[40:43], v[84:87], v[152:155], v[40:43]
ds_read_b64_tr_b16 v[102:103], v16 offset:7040
v_mfma_f32_16x16x32_bf16 v[44:47], v[84:87], v[156:159], v[44:47]
ds_read_b64_tr_b16 v[104:105], v17 offset:6304
s_waitcnt lgkmcnt(7)
v_mfma_f32_16x16x32_bf16 v[48:51], v[88:91], v[152:155], v[48:51]
ds_read_b64_tr_b16 v[106:107], v17 offset:7072
v_mfma_f32_16x16x32_bf16 v[52:55], v[88:91], v[156:159], v[52:55]
ds_read_b64_tr_b16 v[108:109], v21 offset:6144
s_waitcnt lgkmcnt(7)
v_mfma_f32_16x16x32_bf16 v[120:123], v[92:95], v[28:31], v[120:123]
ds_read_b64_tr_b16 v[110:111], v21 offset:6912
s_waitcnt lgkmcnt(6)
v_mfma_f32_16x16x32_bf16 v[56:59], v[96:99], v[152:155], v[56:59]
v_mfma_f32_16x16x32_bf16 v[60:63], v[96:99], v[156:159], v[60:63]
s_waitcnt lgkmcnt(4)
v_mfma_f32_16x16x32_bf16 v[64:67], v[100:103], v[152:155], v[64:67]
v_add_u32 v16, 110592, v12
v_add_u32 v17, 110592, v13
v_add_u32 v20, 110592, v18
v_add_u32 v21, 110592, v19
ds_read_b64_tr_b16 v[80:81], v16 offset:0
ds_read_b64_tr_b16 v[82:83], v16 offset:768
v_mfma_f32_16x16x32_bf16 v[68:71], v[100:103], v[156:159], v[68:71]
ds_read_b64_tr_b16 v[84:85], v17 offset:32
ds_read_b64_tr_b16 v[86:87], v17 offset:800
s_waitcnt lgkmcnt(6)
v_mfma_f32_16x16x32_bf16 v[72:75], v[104:107], v[152:155], v[72:75]
ds_read_b64_tr_b16 v[88:89], v16 offset:64
ds_read_b64_tr_b16 v[90:91], v16 offset:832
v_mfma_f32_16x16x32_bf16 v[76:79], v[104:107], v[156:159], v[76:79]
ds_read_b64_tr_b16 v[92:93], v20 offset:0
s_waitcnt lgkmcnt(7)
v_mfma_f32_16x16x32_bf16 v[124:127], v[108:111], v[28:31], v[124:127]
ds_read_b64_tr_b16 v[94:95], v20 offset:768
s_waitcnt lgkmcnt(6)
v_mfma_f32_16x16x32_bf16 v[32:35], v[80:83], v[160:163], v[32:35]
ds_read_b64_tr_b16 v[96:97], v17 offset:96
ds_read_b64_tr_b16 v[98:99], v17 offset:864
v_mfma_f32_16x16x32_bf16 v[36:39], v[80:83], v[164:167], v[36:39]
ds_read_b64_tr_b16 v[100:101], v16 offset:128
s_waitcnt lgkmcnt(7)
v_mfma_f32_16x16x32_bf16 v[40:43], v[84:87], v[160:163], v[40:43]
ds_read_b64_tr_b16 v[102:103], v16 offset:896
v_mfma_f32_16x16x32_bf16 v[44:47], v[84:87], v[164:167], v[44:47]
ds_read_b64_tr_b16 v[104:105], v17 offset:160
s_waitcnt lgkmcnt(7)
v_mfma_f32_16x16x32_bf16 v[48:51], v[88:91], v[160:163], v[48:51]
ds_read_b64_tr_b16 v[106:107], v17 offset:928
v_mfma_f32_16x16x32_bf16 v[52:55], v[88:91], v[164:167], v[52:55]
ds_read_b64_tr_b16 v[108:109], v21 offset:0
s_waitcnt lgkmcnt(7)
v_mfma_f32_16x16x32_bf16 v[120:123], v[92:95], v[28:31], v[120:123]
ds_read_b64_tr_b16 v[110:111], v21 offset:768
s_waitcnt lgkmcnt(6)
v_mfma_f32_16x16x32_bf16 v[56:59], v[96:99], v[160:163], v[56:59]
ds_read_b64_tr_b16 v[80:81], v16 offset:6144
ds_read_b64_tr_b16 v[82:83], v16 offset:6912
v_mfma_f32_16x16x32_bf16 v[60:63], v[96:99], v[164:167], v[60:63]
ds_read_b64_tr_b16 v[84:85], v17 offset:6176
s_waitcnt lgkmcnt(7)
v_mfma_f32_16x16x32_bf16 v[64:67], v[100:103], v[160:163], v[64:67]
ds_read_b64_tr_b16 v[86:87], v17 offset:6944
v_mfma_f32_16x16x32_bf16 v[68:71], v[100:103], v[164:167], v[68:71]
ds_read_b64_tr_b16 v[88:89], v16 offset:6208
s_waitcnt lgkmcnt(7)
v_mfma_f32_16x16x32_bf16 v[72:75], v[104:107], v[160:163], v[72:75]
ds_read_b64_tr_b16 v[90:91], v16 offset:6976
v_mfma_f32_16x16x32_bf16 v[76:79], v[104:107], v[164:167], v[76:79]
ds_read_b64_tr_b16 v[92:93], v20 offset:6144
s_waitcnt lgkmcnt(7)
v_mfma_f32_16x16x32_bf16 v[124:127], v[108:111], v[28:31], v[124:127]
ds_read_b64_tr_b16 v[94:95], v20 offset:6912
s_waitcnt lgkmcnt(6)
v_mfma_f32_16x16x32_bf16 v[32:35], v[80:83], v[168:171], v[32:35]
ds_read_b64_tr_b16 v[96:97], v17 offset:6240
ds_read_b64_tr_b16 v[98:99], v17 offset:7008
v_mfma_f32_16x16x32_bf16 v[36:39], v[80:83], v[172:175], v[36:39]
ds_read_b64_tr_b16 v[100:101], v16 offset:6272
s_waitcnt lgkmcnt(7)
v_mfma_f32_16x16x32_bf16 v[40:43], v[84:87], v[168:171], v[40:43]
ds_read_b64_tr_b16 v[102:103], v16 offset:7040
v_mfma_f32_16x16x32_bf16 v[44:47], v[84:87], v[172:175], v[44:47]
ds_read_b64_tr_b16 v[104:105], v17 offset:6304
s_waitcnt lgkmcnt(7)
v_mfma_f32_16x16x32_bf16 v[48:51], v[88:91], v[168:171], v[48:51]
ds_read_b64_tr_b16 v[106:107], v17 offset:7072
v_mfma_f32_16x16x32_bf16 v[52:55], v[88:91], v[172:175], v[52:55]
ds_read_b64_tr_b16 v[108:109], v21 offset:6144
s_waitcnt lgkmcnt(7)
v_mfma_f32_16x16x32_bf16 v[120:123], v[92:95], v[28:31], v[120:123]
ds_read_b64_tr_b16 v[110:111], v21 offset:6912
s_waitcnt lgkmcnt(6)
v_mfma_f32_16x16x32_bf16 v[56:59], v[96:99], v[168:171], v[56:59]
v_mfma_f32_16x16x32_bf16 v[60:63], v[96:99], v[172:175], v[60:63]
s_waitcnt lgkmcnt(4)
v_mfma_f32_16x16x32_bf16 v[64:67], v[100:103], v[168:171], v[64:67]
v_add_u32 v16, 122880, v12
v_add_u32 v17, 122880, v13
v_add_u32 v20, 122880, v18
v_add_u32 v21, 122880, v19
ds_read_b64_tr_b16 v[80:81], v16 offset:0
ds_read_b64_tr_b16 v[82:83], v16 offset:768
v_mfma_f32_16x16x32_bf16 v[68:71], v[100:103], v[172:175], v[68:71]
ds_read_b64_tr_b16 v[84:85], v17 offset:32
ds_read_b64_tr_b16 v[86:87], v17 offset:800
s_waitcnt lgkmcnt(6)
v_mfma_f32_16x16x32_bf16 v[72:75], v[104:107], v[168:171], v[72:75]
ds_read_b64_tr_b16 v[88:89], v16 offset:64
ds_read_b64_tr_b16 v[90:91], v16 offset:832
v_mfma_f32_16x16x32_bf16 v[76:79], v[104:107], v[172:175], v[76:79]
ds_read_b64_tr_b16 v[92:93], v20 offset:0
s_waitcnt lgkmcnt(7)
v_mfma_f32_16x16x32_bf16 v[124:127], v[108:111], v[28:31], v[124:127]
ds_read_b64_tr_b16 v[94:95], v20 offset:768
s_waitcnt lgkmcnt(6)
v_mfma_f32_16x16x32_bf16 v[32:35], v[80:83], v[176:179], v[32:35]
ds_read_b64_tr_b16 v[96:97], v17 offset:96
ds_read_b64_tr_b16 v[98:99], v17 offset:864
v_mfma_f32_16x16x32_bf16 v[36:39], v[80:83], v[180:183], v[36:39]
ds_read_b64_tr_b16 v[100:101], v16 offset:128
s_waitcnt lgkmcnt(7)
v_mfma_f32_16x16x32_bf16 v[40:43], v[84:87], v[176:179], v[40:43]
ds_read_b64_tr_b16 v[102:103], v16 offset:896
v_mfma_f32_16x16x32_bf16 v[44:47], v[84:87], v[180:183], v[44:47]
ds_read_b64_tr_b16 v[104:105], v17 offset:160
s_waitcnt lgkmcnt(7)
v_mfma_f32_16x16x32_bf16 v[48:51], v[88:91], v[176:179], v[48:51]
ds_read_b64_tr_b16 v[106:107], v17 offset:928
v_mfma_f32_16x16x32_bf16 v[52:55], v[88:91], v[180:183], v[52:55]
ds_read_b64_tr_b16 v[108:109], v21 offset:0
s_waitcnt lgkmcnt(7)
v_mfma_f32_16x16x32_bf16 v[120:123], v[92:95], v[28:31], v[120:123]
ds_read_b64_tr_b16 v[110:111], v21 offset:768
s_waitcnt lgkmcnt(6)
v_mfma_f32_16x16x32_bf16 v[56:59], v[96:99], v[176:179], v[56:59]
ds_read_b64_tr_b16 v[80:81], v16 offset:6144
ds_read_b64_tr_b16 v[82:83], v16 offset:6912
v_mfma_f32_16x16x32_bf16 v[60:63], v[96:99], v[180:183], v[60:63]
ds_read_b64_tr_b16 v[84:85], v17 offset:6176
s_waitcnt lgkmcnt(7)
v_mfma_f32_16x16x32_bf16 v[64:67], v[100:103], v[176:179], v[64:67]
ds_read_b64_tr_b16 v[86:87], v17 offset:6944
v_mfma_f32_16x16x32_bf16 v[68:71], v[100:103], v[180:183], v[68:71]
ds_read_b64_tr_b16 v[88:89], v16 offset:6208
s_waitcnt lgkmcnt(7)
v_mfma_f32_16x16x32_bf16 v[72:75], v[104:107], v[176:179], v[72:75]
ds_read_b64_tr_b16 v[90:91], v16 offset:6976
v_mfma_f32_16x16x32_bf16 v[76:79], v[104:107], v[180:183], v[76:79]
ds_read_b64_tr_b16 v[92:93], v20 offset:6144
s_waitcnt lgkmcnt(7)
v_mfma_f32_16x16x32_bf16 v[124:127], v[108:111], v[28:31], v[124:127]
ds_read_b64_tr_b16 v[94:95], v20 offset:6912
s_waitcnt lgkmcnt(6)
v_mfma_f32_16x16x32_bf16 v[32:35], v[80:83], v[184:187], v[32:35]
ds_read_b64_tr_b16 v[96:97], v17 offset:6240
ds_read_b64_tr_b16 v[98:99], v17 offset:7008
v_mfma_f32_16x16x32_bf16 v[36:39], v[80:83], v[188:191], v[36:39]
ds_read_b64_tr_b16 v[100:101], v16 offset:6272
s_waitcnt lgkmcnt(7)
v_mfma_f32_16x16x32_bf16 v[40:43], v[84:87], v[184:187], v[40:43]
ds_read_b64_tr_b16 v[102:103], v16 offset:7040
v_mfma_f32_16x16x32_bf16 v[44:47], v[84:87], v[188:191], v[44:47]
ds_read_b64_tr_b16 v[104:105], v17 offset:6304
s_waitcnt lgkmcnt(7)
v_mfma_f32_16x16x32_bf16 v[48:51], v[88:91], v[184:187], v[48:51]
ds_read_b64_tr_b16 v[106:107], v17 offset:7072
v_mfma_f32_16x16x32_bf16 v[52:55], v[88:91], v[188:191], v[52:55]
ds_read_b64_tr_b16 v[108:109], v21 offset:6144
s_waitcnt lgkmcnt(7)
v_mfma_f32_16x16x32_bf16 v[120:123], v[92:95], v[28:31], v[120:123]
ds_read_b64_tr_b16 v[110:111], v21 offset:6912
s_waitcnt lgkmcnt(6)
v_mfma_f32_16x16x32_bf16 v[56:59], v[96:99], v[184:187], v[56:59]
v_mfma_f32_16x16x32_bf16 v[60:63], v[96:99], v[188:191], v[60:63]
s_waitcnt lgkmcnt(4)
v_mfma_f32_16x16x32_bf16 v[64:67], v[100:103], v[184:187], v[64:67]
v_add_u32 v16, 135168, v12
v_add_u32 v17, 135168, v13
v_add_u32 v20, 135168, v18
v_add_u32 v21, 135168, v19
ds_read_b64_tr_b16 v[80:81], v16 offset:0
ds_read_b64_tr_b16 v[82:83], v16 offset:768
v_mfma_f32_16x16x32_bf16 v[68:71], v[100:103], v[188:191], v[68:71]
ds_read_b64_tr_b16 v[84:85], v17 offset:32
ds_read_b64_tr_b16 v[86:87], v17 offset:800
s_waitcnt lgkmcnt(6)
v_mfma_f32_16x16x32_bf16 v[72:75], v[104:107], v[184:187], v[72:75]
ds_read_b64_tr_b16 v[88:89], v16 offset:64
ds_read_b64_tr_b16 v[90:91], v16 offset:832
v_mfma_f32_16x16x32_bf16 v[76:79], v[104:107], v[188:191], v[76:79]
ds_read_b64_tr_b16 v[92:93], v20 offset:0
s_waitcnt lgkmcnt(7)
v_mfma_f32_16x16x32_bf16 v[124:127], v[108:111], v[28:31], v[124:127]
ds_read_b64_tr_b16 v[94:95], v20 offset:768
s_waitcnt lgkmcnt(6)
v_mfma_f32_16x16x32_bf16 v[32:35], v[80:83], v[192:195], v[32:35]
ds_read_b64_tr_b16 v[96:97], v17 offset:96
ds_read_b64_tr_b16 v[98:99], v17 offset:864
v_mfma_f32_16x16x32_bf16 v[36:39], v[80:83], v[196:199], v[36:39]
ds_read_b64_tr_b16 v[100:101], v16 offset:128
s_waitcnt lgkmcnt(7)
v_mfma_f32_16x16x32_bf16 v[40:43], v[84:87], v[192:195], v[40:43]
ds_read_b64_tr_b16 v[102:103], v16 offset:896
v_mfma_f32_16x16x32_bf16 v[44:47], v[84:87], v[196:199], v[44:47]
ds_read_b64_tr_b16 v[104:105], v17 offset:160
s_waitcnt lgkmcnt(7)
v_mfma_f32_16x16x32_bf16 v[48:51], v[88:91], v[192:195], v[48:51]
ds_read_b64_tr_b16 v[106:107], v17 offset:928
v_mfma_f32_16x16x32_bf16 v[52:55], v[88:91], v[196:199], v[52:55]
ds_read_b64_tr_b16 v[108:109], v21 offset:0
s_waitcnt lgkmcnt(7)
v_mfma_f32_16x16x32_bf16 v[120:123], v[92:95], v[28:31], v[120:123]
ds_read_b64_tr_b16 v[110:111], v21 offset:768
s_waitcnt lgkmcnt(6)
v_mfma_f32_16x16x32_bf16 v[56:59], v[96:99], v[192:195], v[56:59]
ds_read_b64_tr_b16 v[80:81], v16 offset:6144
ds_read_b64_tr_b16 v[82:83], v16 offset:6912
v_mfma_f32_16x16x32_bf16 v[60:63], v[96:99], v[196:199], v[60:63]
ds_read_b64_tr_b16 v[84:85], v17 offset:6176
s_waitcnt lgkmcnt(7)
v_mfma_f32_16x16x32_bf16 v[64:67], v[100:103], v[192:195], v[64:67]
ds_read_b64_tr_b16 v[86:87], v17 offset:6944
v_mfma_f32_16x16x32_bf16 v[68:71], v[100:103], v[196:199], v[68:71]
ds_read_b64_tr_b16 v[88:89], v16 offset:6208
s_waitcnt lgkmcnt(7)
v_mfma_f32_16x16x32_bf16 v[72:75], v[104:107], v[192:195], v[72:75]
ds_read_b64_tr_b16 v[90:91], v16 offset:6976
v_mfma_f32_16x16x32_bf16 v[76:79], v[104:107], v[196:199], v[76:79]
ds_read_b64_tr_b16 v[92:93], v20 offset:6144
s_waitcnt lgkmcnt(7)
v_mfma_f32_16x16x32_bf16 v[124:127], v[108:111], v[28:31], v[124:127]
ds_read_b64_tr_b16 v[94:95], v20 offset:6912
s_waitcnt lgkmcnt(6)
v_mfma_f32_16x16x32_bf16 v[32:35], v[80:83], v[200:203], v[32:35]
ds_read_b64_tr_b16 v[96:97], v17 offset:6240
ds_read_b64_tr_b16 v[98:99], v17 offset:7008
v_mfma_f32_16x16x32_bf16 v[36:39], v[80:83], v[204:207], v[36:39]
ds_read_b64_tr_b16 v[100:101], v16 offset:6272
s_waitcnt lgkmcnt(7)
v_mfma_f32_16x16x32_bf16 v[40:43], v[84:87], v[200:203], v[40:43]
ds_read_b64_tr_b16 v[102:103], v16 offset:7040
v_mfma_f32_16x16x32_bf16 v[44:47], v[84:87], v[204:207], v[44:47]
ds_read_b64_tr_b16 v[104:105], v17 offset:6304
s_waitcnt lgkmcnt(7)
v_mfma_f32_16x16x32_bf16 v[48:51], v[88:91], v[200:203], v[48:51]
ds_read_b64_tr_b16 v[106:107], v17 offset:7072
v_mfma_f32_16x16x32_bf16 v[52:55], v[88:91], v[204:207], v[52:55]
ds_read_b64_tr_b16 v[108:109], v21 offset:6144
s_waitcnt lgkmcnt(7)
v_mfma_f32_16x16x32_bf16 v[120:123], v[92:95], v[28:31], v[120:123]
ds_read_b64_tr_b16 v[110:111], v21 offset:6912
s_waitcnt lgkmcnt(6)
v_mfma_f32_16x16x32_bf16 v[56:59], v[96:99], v[200:203], v[56:59]
v_mfma_f32_16x16x32_bf16 v[60:63], v[96:99], v[204:207], v[60:63]
s_waitcnt lgkmcnt(4)
v_mfma_f32_16x16x32_bf16 v[64:67], v[100:103], v[200:203], v[64:67]
v_add_u32 v16, 147456, v12
v_add_u32 v17, 147456, v13
v_add_u32 v20, 147456, v18
v_add_u32 v21, 147456, v19
ds_read_b64_tr_b16 v[80:81], v16 offset:0
ds_read_b64_tr_b16 v[82:83], v16 offset:768
v_mfma_f32_16x16x32_bf16 v[68:71], v[100:103], v[204:207], v[68:71]
ds_read_b64_tr_b16 v[84:85], v17 offset:32
ds_read_b64_tr_b16 v[86:87], v17 offset:800
s_waitcnt lgkmcnt(6)
v_mfma_f32_16x16x32_bf16 v[72:75], v[104:107], v[200:203], v[72:75]
ds_read_b64_tr_b16 v[88:89], v16 offset:64
ds_read_b64_tr_b16 v[90:91], v16 offset:832
v_mfma_f32_16x16x32_bf16 v[76:79], v[104:107], v[204:207], v[76:79]
ds_read_b64_tr_b16 v[92:93], v20 offset:0
s_waitcnt lgkmcnt(7)
v_mfma_f32_16x16x32_bf16 v[124:127], v[108:111], v[28:31], v[124:127]
ds_read_b64_tr_b16 v[94:95], v20 offset:768
s_waitcnt lgkmcnt(6)
v_mfma_f32_16x16x32_bf16 v[32:35], v[80:83], v[208:211], v[32:35]
ds_read_b64_tr_b16 v[96:97], v17 offset:96
ds_read_b64_tr_b16 v[98:99], v17 offset:864
v_mfma_f32_16x16x32_bf16 v[36:39], v[80:83], v[212:215], v[36:39]
ds_read_b64_tr_b16 v[100:101], v16 offset:128
s_waitcnt lgkmcnt(7)
v_mfma_f32_16x16x32_bf16 v[40:43], v[84:87], v[208:211], v[40:43]
ds_read_b64_tr_b16 v[102:103], v16 offset:896
v_mfma_f32_16x16x32_bf16 v[44:47], v[84:87], v[212:215], v[44:47]
ds_read_b64_tr_b16 v[104:105], v17 offset:160
s_waitcnt lgkmcnt(7)
v_mfma_f32_16x16x32_bf16 v[48:51], v[88:91], v[208:211], v[48:51]
ds_read_b64_tr_b16 v[106:107], v17 offset:928
v_mfma_f32_16x16x32_bf16 v[52:55], v[88:91], v[212:215], v[52:55]
ds_read_b64_tr_b16 v[108:109], v21 offset:0
s_waitcnt lgkmcnt(7)
v_mfma_f32_16x16x32_bf16 v[120:123], v[92:95], v[28:31], v[120:123]
ds_read_b64_tr_b16 v[110:111], v21 offset:768
s_waitcnt lgkmcnt(6)
v_mfma_f32_16x16x32_bf16 v[56:59], v[96:99], v[208:211], v[56:59]
ds_read_b64_tr_b16 v[80:81], v16 offset:6144
ds_read_b64_tr_b16 v[82:83], v16 offset:6912
v_mfma_f32_16x16x32_bf16 v[60:63], v[96:99], v[212:215], v[60:63]
ds_read_b64_tr_b16 v[84:85], v17 offset:6176
s_waitcnt lgkmcnt(7)
v_mfma_f32_16x16x32_bf16 v[64:67], v[100:103], v[208:211], v[64:67]
ds_read_b64_tr_b16 v[86:87], v17 offset:6944
v_mfma_f32_16x16x32_bf16 v[68:71], v[100:103], v[212:215], v[68:71]
ds_read_b64_tr_b16 v[88:89], v16 offset:6208
s_waitcnt lgkmcnt(7)
v_mfma_f32_16x16x32_bf16 v[72:75], v[104:107], v[208:211], v[72:75]
ds_read_b64_tr_b16 v[90:91], v16 offset:6976
v_mfma_f32_16x16x32_bf16 v[76:79], v[104:107], v[212:215], v[76:79]
ds_read_b64_tr_b16 v[92:93], v20 offset:6144
s_waitcnt lgkmcnt(7)
v_mfma_f32_16x16x32_bf16 v[124:127], v[108:111], v[28:31], v[124:127]
ds_read_b64_tr_b16 v[94:95], v20 offset:6912
s_waitcnt lgkmcnt(6)
v_mfma_f32_16x16x32_bf16 v[32:35], v[80:83], v[216:219], v[32:35]
ds_read_b64_tr_b16 v[96:97], v17 offset:6240
ds_read_b64_tr_b16 v[98:99], v17 offset:7008
v_mfma_f32_16x16x32_bf16 v[36:39], v[80:83], v[220:223], v[36:39]
ds_read_b64_tr_b16 v[100:101], v16 offset:6272
s_waitcnt lgkmcnt(7)
v_mfma_f32_16x16x32_bf16 v[40:43], v[84:87], v[216:219], v[40:43]
ds_read_b64_tr_b16 v[102:103], v16 offset:7040
v_mfma_f32_16x16x32_bf16 v[44:47], v[84:87], v[220:223], v[44:47]
ds_read_b64_tr_b16 v[104:105], v17 offset:6304
s_waitcnt lgkmcnt(7)
v_mfma_f32_16x16x32_bf16 v[48:51], v[88:91], v[216:219], v[48:51]
ds_read_b64_tr_b16 v[106:107], v17 offset:7072
v_mfma_f32_16x16x32_bf16 v[52:55], v[88:91], v[220:223], v[52:55]
ds_read_b64_tr_b16 v[108:109], v21 offset:6144
s_waitcnt lgkmcnt(7)
v_mfma_f32_16x16x32_bf16 v[120:123], v[92:95], v[28:31], v[120:123]
ds_read_b64_tr_b16 v[110:111], v21 offset:6912
s_waitcnt lgkmcnt(6)
v_mfma_f32_16x16x32_bf16 v[56:59], v[96:99], v[216:219], v[56:59]
v_mfma_f32_16x16x32_bf16 v[60:63], v[96:99], v[220:223], v[60:63]
s_waitcnt lgkmcnt(4)
v_mfma_f32_16x16x32_bf16 v[64:67], v[100:103], v[216:219], v[64:67]
v_add_u32 v16, 61440, v12
v_add_u32 v17, 61440, v13
v_add_u32 v20, 61440, v18
v_add_u32 v21, 61440, v19
ds_read_b64_tr_b16 v[80:81], v16 offset:0
ds_read_b64_tr_b16 v[82:83], v16 offset:768
v_mfma_f32_16x16x32_bf16 v[68:71], v[100:103], v[220:223], v[68:71]
ds_read_b64_tr_b16 v[84:85], v17 offset:32
ds_read_b64_tr_b16 v[86:87], v17 offset:800
s_waitcnt lgkmcnt(6)
v_mfma_f32_16x16x32_bf16 v[72:75], v[104:107], v[216:219], v[72:75]
ds_read_b64_tr_b16 v[88:89], v16 offset:64
ds_read_b64_tr_b16 v[90:91], v16 offset:832
v_mfma_f32_16x16x32_bf16 v[76:79], v[104:107], v[220:223], v[76:79]
ds_read_b64_tr_b16 v[92:93], v20 offset:0
s_waitcnt lgkmcnt(7)
v_mfma_f32_16x16x32_bf16 v[124:127], v[108:111], v[28:31], v[124:127]
ds_read_b64_tr_b16 v[94:95], v20 offset:768
s_waitcnt lgkmcnt(6)
v_mfma_f32_16x16x32_bf16 v[32:35], v[80:83], v[224:227], v[32:35]
ds_read_b64_tr_b16 v[96:97], v17 offset:96
ds_read_b64_tr_b16 v[98:99], v17 offset:864
v_mfma_f32_16x16x32_bf16 v[36:39], v[80:83], v[228:231], v[36:39]
ds_read_b64_tr_b16 v[100:101], v16 offset:128
s_waitcnt lgkmcnt(7)
v_mfma_f32_16x16x32_bf16 v[40:43], v[84:87], v[224:227], v[40:43]
ds_read_b64_tr_b16 v[102:103], v16 offset:896
v_mfma_f32_16x16x32_bf16 v[44:47], v[84:87], v[228:231], v[44:47]
ds_read_b64_tr_b16 v[104:105], v17 offset:160
s_waitcnt lgkmcnt(7)
v_mfma_f32_16x16x32_bf16 v[48:51], v[88:91], v[224:227], v[48:51]
ds_read_b64_tr_b16 v[106:107], v17 offset:928
v_mfma_f32_16x16x32_bf16 v[52:55], v[88:91], v[228:231], v[52:55]
ds_read_b64_tr_b16 v[108:109], v21 offset:0
s_waitcnt lgkmcnt(7)
v_mfma_f32_16x16x32_bf16 v[120:123], v[92:95], v[28:31], v[120:123]
ds_read_b64_tr_b16 v[110:111], v21 offset:768
s_waitcnt lgkmcnt(6)
v_mfma_f32_16x16x32_bf16 v[56:59], v[96:99], v[224:227], v[56:59]
ds_read_b64_tr_b16 v[80:81], v16 offset:6144
ds_read_b64_tr_b16 v[82:83], v16 offset:6912
v_mfma_f32_16x16x32_bf16 v[60:63], v[96:99], v[228:231], v[60:63]
ds_read_b64_tr_b16 v[84:85], v17 offset:6176
s_waitcnt lgkmcnt(7)
v_mfma_f32_16x16x32_bf16 v[64:67], v[100:103], v[224:227], v[64:67]
ds_read_b64_tr_b16 v[86:87], v17 offset:6944
v_mfma_f32_16x16x32_bf16 v[68:71], v[100:103], v[228:231], v[68:71]
ds_read_b64_tr_b16 v[88:89], v16 offset:6208
s_waitcnt lgkmcnt(7)
v_mfma_f32_16x16x32_bf16 v[72:75], v[104:107], v[224:227], v[72:75]
ds_read_b64_tr_b16 v[90:91], v16 offset:6976
v_mfma_f32_16x16x32_bf16 v[76:79], v[104:107], v[228:231], v[76:79]
ds_read_b64_tr_b16 v[92:93], v20 offset:6144
s_waitcnt lgkmcnt(7)
v_mfma_f32_16x16x32_bf16 v[124:127], v[108:111], v[28:31], v[124:127]
ds_read_b64_tr_b16 v[94:95], v20 offset:6912
s_waitcnt lgkmcnt(6)
v_mfma_f32_16x16x32_bf16 v[32:35], v[80:83], v[232:235], v[32:35]
ds_read_b64_tr_b16 v[96:97], v17 offset:6240
ds_read_b64_tr_b16 v[98:99], v17 offset:7008
v_mfma_f32_16x16x32_bf16 v[36:39], v[80:83], v[236:239], v[36:39]
ds_read_b64_tr_b16 v[100:101], v16 offset:6272
s_waitcnt lgkmcnt(7)
v_mfma_f32_16x16x32_bf16 v[40:43], v[84:87], v[232:235], v[40:43]
ds_read_b64_tr_b16 v[102:103], v16 offset:7040
v_mfma_f32_16x16x32_bf16 v[44:47], v[84:87], v[236:239], v[44:47]
ds_read_b64_tr_b16 v[104:105], v17 offset:6304
s_waitcnt lgkmcnt(7)
v_mfma_f32_16x16x32_bf16 v[48:51], v[88:91], v[232:235], v[48:51]
ds_read_b64_tr_b16 v[106:107], v17 offset:7072
v_mfma_f32_16x16x32_bf16 v[52:55], v[88:91], v[236:239], v[52:55]
ds_read_b64_tr_b16 v[108:109], v21 offset:6144
s_waitcnt lgkmcnt(7)
v_mfma_f32_16x16x32_bf16 v[120:123], v[92:95], v[28:31], v[120:123]
ds_read_b64_tr_b16 v[110:111], v21 offset:6912
s_waitcnt lgkmcnt(6)
v_mfma_f32_16x16x32_bf16 v[56:59], v[96:99], v[232:235], v[56:59]
v_mfma_f32_16x16x32_bf16 v[60:63], v[96:99], v[236:239], v[60:63]
s_waitcnt lgkmcnt(4)
v_mfma_f32_16x16x32_bf16 v[64:67], v[100:103], v[232:235], v[64:67]
v_add_u32 v16, 73728, v12
v_add_u32 v17, 73728, v13
v_add_u32 v20, 73728, v18
v_add_u32 v21, 73728, v19
ds_read_b64_tr_b16 v[80:81], v16 offset:0
ds_read_b64_tr_b16 v[82:83], v16 offset:768
v_mfma_f32_16x16x32_bf16 v[68:71], v[100:103], v[236:239], v[68:71]
ds_read_b64_tr_b16 v[84:85], v17 offset:32
ds_read_b64_tr_b16 v[86:87], v17 offset:800
s_waitcnt lgkmcnt(6)
v_mfma_f32_16x16x32_bf16 v[72:75], v[104:107], v[232:235], v[72:75]
ds_read_b64_tr_b16 v[88:89], v16 offset:64
ds_read_b64_tr_b16 v[90:91], v16 offset:832
v_mfma_f32_16x16x32_bf16 v[76:79], v[104:107], v[236:239], v[76:79]
ds_read_b64_tr_b16 v[92:93], v20 offset:0
s_waitcnt lgkmcnt(7)
v_mfma_f32_16x16x32_bf16 v[124:127], v[108:111], v[28:31], v[124:127]
ds_read_b64_tr_b16 v[94:95], v20 offset:768
s_waitcnt lgkmcnt(6)
v_mfma_f32_16x16x32_bf16 v[32:35], v[80:83], v[240:243], v[32:35]
ds_read_b64_tr_b16 v[96:97], v17 offset:96
ds_read_b64_tr_b16 v[98:99], v17 offset:864
v_mfma_f32_16x16x32_bf16 v[36:39], v[80:83], v[244:247], v[36:39]
ds_read_b64_tr_b16 v[100:101], v16 offset:128
s_waitcnt lgkmcnt(7)
v_mfma_f32_16x16x32_bf16 v[40:43], v[84:87], v[240:243], v[40:43]
ds_read_b64_tr_b16 v[102:103], v16 offset:896
v_mfma_f32_16x16x32_bf16 v[44:47], v[84:87], v[244:247], v[44:47]
ds_read_b64_tr_b16 v[104:105], v17 offset:160
s_waitcnt lgkmcnt(7)
v_mfma_f32_16x16x32_bf16 v[48:51], v[88:91], v[240:243], v[48:51]
ds_read_b64_tr_b16 v[106:107], v17 offset:928
v_mfma_f32_16x16x32_bf16 v[52:55], v[88:91], v[244:247], v[52:55]
ds_read_b64_tr_b16 v[108:109], v21 offset:0
s_waitcnt lgkmcnt(7)
v_mfma_f32_16x16x32_bf16 v[120:123], v[92:95], v[28:31], v[120:123]
ds_read_b64_tr_b16 v[110:111], v21 offset:768
s_waitcnt lgkmcnt(6)
v_mfma_f32_16x16x32_bf16 v[56:59], v[96:99], v[240:243], v[56:59]
ds_read_b64_tr_b16 v[80:81], v16 offset:6144
ds_read_b64_tr_b16 v[82:83], v16 offset:6912
v_mfma_f32_16x16x32_bf16 v[60:63], v[96:99], v[244:247], v[60:63]
ds_read_b64_tr_b16 v[84:85], v20 offset:6144
s_waitcnt lgkmcnt(7)
v_mfma_f32_16x16x32_bf16 v[64:67], v[100:103], v[240:243], v[64:67]
ds_read_b64_tr_b16 v[86:87], v20 offset:6912
v_mfma_f32_16x16x32_bf16 v[68:71], v[100:103], v[244:247], v[68:71]
ds_read_b64_tr_b16 v[88:89], v17 offset:6176
ds_read_b64_tr_b16 v[90:91], v17 offset:6944
s_waitcnt lgkmcnt(8)
v_mfma_f32_16x16x32_bf16 v[72:75], v[104:107], v[240:243], v[72:75]
ds_read_b64_tr_b16 v[92:93], v21 offset:6144
v_mfma_f32_16x16x32_bf16 v[76:79], v[104:107], v[244:247], v[76:79]
ds_read_b64_tr_b16 v[94:95], v21 offset:6912
s_waitcnt lgkmcnt(8)
v_mfma_f32_16x16x32_bf16 v[124:127], v[108:111], v[28:31], v[124:127]
ds_read_b64_tr_b16 v[96:97], v16 offset:6208
ds_read_b64_tr_b16 v[98:99], v16 offset:6976
s_waitcnt lgkmcnt(8)
v_mfma_f32_16x16x32_bf16 v[32:35], v[80:83], v[248:251], v[32:35]
ds_read_b64_tr_b16 v[100:101], v17 offset:6240
v_mfma_f32_16x16x32_bf16 v[36:39], v[80:83], v[252:255], v[36:39]
ds_read_b64_tr_b16 v[102:103], v17 offset:7008
s_waitcnt lgkmcnt(8)
v_mfma_f32_16x16x32_bf16 v[120:123], v[84:87], v[28:31], v[120:123]
ds_read_b64_tr_b16 v[104:105], v16 offset:6272
s_waitcnt lgkmcnt(7)
v_mfma_f32_16x16x32_bf16 v[40:43], v[88:91], v[248:251], v[40:43]
ds_read_b64_tr_b16 v[106:107], v16 offset:7040
v_mfma_f32_16x16x32_bf16 v[44:47], v[88:91], v[252:255], v[44:47]
ds_read_b64_tr_b16 v[108:109], v17 offset:6304
s_waitcnt lgkmcnt(7)
v_mfma_f32_16x16x32_bf16 v[124:127], v[92:95], v[28:31], v[124:127]
ds_read_b64_tr_b16 v[110:111], v17 offset:7072
s_waitcnt lgkmcnt(6)
v_mfma_f32_16x16x32_bf16 v[48:51], v[96:99], v[248:251], v[48:51]
v_mfma_f32_16x16x32_bf16 v[52:55], v[96:99], v[252:255], v[52:55]
s_waitcnt lgkmcnt(4)
v_mfma_f32_16x16x32_bf16 v[56:59], v[100:103], v[248:251], v[56:59]
v_mfma_f32_16x16x32_bf16 v[60:63], v[100:103], v[252:255], v[60:63]
s_waitcnt lgkmcnt(2)
v_mfma_f32_16x16x32_bf16 v[64:67], v[104:107], v[248:251], v[64:67]
v_mfma_f32_16x16x32_bf16 v[68:71], v[104:107], v[252:255], v[68:71]
s_waitcnt lgkmcnt(0)
v_mfma_f32_16x16x32_bf16 v[72:75], v[108:111], v[248:251], v[72:75]
v_mfma_f32_16x16x32_bf16 v[76:79], v[108:111], v[252:255], v[76:79]
s_mov_b32 exec_lo, 0x00010001
s_mov_b32 exec_hi, 0x00010001
ds_write_b128 v24, v[120:123]
ds_write_b128 v25, v[124:127]
s_mov_b64 exec, -1
s_lshl_b32 s61, s4, 2
s_add_u32 s61, s61, 163344
v_mov_b32 v26, s61
v_mov_b32 v27, 1
v_mov_b32 v3, 163344
ds_write_b32 v26, v27
ds_read_b32 v104, v5 offset:0
ds_read_b32 v108, v5 offset:640
ds_read_b32 v112, v5 offset:1280
ds_read_b32 v116, v5 offset:1920
ds_read_b32 v106, v5 offset:64
ds_read_b32 v110, v5 offset:704
ds_read_b32 v114, v5 offset:1344
ds_read_b32 v118, v5 offset:1984
s_waitcnt vmcnt(0)
s_mov_b32 s63, 0
Llw_54:
ds_read_b128 v[20:23], v3
s_add_u32 s63, s63, 1
s_waitcnt lgkmcnt(0)
v_and_b32 v20, v20, v21
v_and_b32 v22, v22, v23
v_and_b32_e64 v20, v20, v22
v_cmp_ne_u32 vcc, 0, v20
s_cbranch_vccnz Llk_55
s_cmp_lt_u32 s63, 0x100000
s_cbranch_scc1 Llw_54
Llk_55:
ds_read_b128 v[80:83], v7 offset:0
ds_read_b128 v[84:87], v7 offset:64
ds_read_b128 v[88:91], v7 offset:128
ds_read_b128 v[92:95], v7 offset:192
ds_read_b128 v[96:99], v7 offset:256
ds_read_b128 v[100:103], v7 offset:320
s_waitcnt lgkmcnt(0)
s_cmp_gt_u32 s59, 0
s_cselect_b32 s64, s54, 268435456
s_cbranch_scc0 Lz1skip_56
v_pk_fma_f32 v[32:33], v[80:81], v[104:105], v[32:33] op_sel_hi:[1,0,1] neg_lo:[1,0,0] neg_hi:[1,0,0]
v_pk_fma_f32 v[34:35], v[82:83], v[104:105], v[34:35] op_sel_hi:[1,0,1] neg_lo:[1,0,0] neg_hi:[1,0,0]
v_pk_fma_f32 v[36:37], v[80:81], v[106:107], v[36:37] op_sel_hi:[1,0,1] neg_lo:[1,0,0] neg_hi:[1,0,0]
v_pk_fma_f32 v[38:39], v[82:83], v[106:107], v[38:39] op_sel_hi:[1,0,1] neg_lo:[1,0,0] neg_hi:[1,0,0]
v_pk_mul_f32 v[20:21], v[32:33], v[32:33]
v_pk_mul_f32 v[22:23], v[34:35], v[34:35]
v_pk_mul_f32 v[26:27], v[36:37], v[36:37]
v_pk_mul_f32 v[28:29], v[38:39], v[38:39]
v_pk_fma_f32 v[20:21], v[20:21], v[108:109], v[112:113] op_sel_hi:[1,0,0]
v_pk_fma_f32 v[22:23], v[22:23], v[108:109], v[112:113] op_sel_hi:[1,0,0]
v_pk_fma_f32 v[26:27], v[26:27], v[110:111], v[114:115] op_sel_hi:[1,0,0]
v_pk_fma_f32 v[28:29], v[28:29], v[110:111], v[114:115] op_sel_hi:[1,0,0]
v_pk_mul_f32 v[20:21], v[20:21], v[32:33]
v_pk_mul_f32 v[22:23], v[22:23], v[34:35]
v_pk_mul_f32 v[26:27], v[26:27], v[36:37]
v_pk_mul_f32 v[28:29], v[28:29], v[38:39]
v_exp_f32 v20, v20
v_exp_f32 v21, v21
v_exp_f32 v22, v22
v_exp_f32 v23, v23
v_exp_f32 v26, v26
v_exp_f32 v27, v27
v_exp_f32 v28, v28
v_exp_f32 v29, v29
v_pk_fma_f32 v[20:21], v[20:21], v[116:117], v[116:117] op_sel_hi:[1,0,0]
v_pk_fma_f32 v[22:23], v[22:23], v[116:117], v[116:117] op_sel_hi:[1,0,0]
v_pk_fma_f32 v[26:27], v[26:27], v[118:119], v[118:119] op_sel_hi:[1,0,0]
v_pk_fma_f32 v[28:29], v[28:29], v[118:119], v[118:119] op_sel_hi:[1,0,0]
v_rcp_f32 v20, v20
v_rcp_f32 v21, v21
v_rcp_f32 v22, v22
v_rcp_f32 v23, v23
v_rcp_f32 v26, v26
v_rcp_f32 v27, v27
v_rcp_f32 v28, v28
v_rcp_f32 v29, v29
v_pk_mul_f32 v[32:33], v[32:33], v[20:21]
v_pk_mul_f32 v[34:35], v[34:35], v[22:23]
v_pk_mul_f32 v[36:37], v[36:37], v[26:27]
v_pk_mul_f32 v[38:39], v[38:39], v[28:29]
v_cvt_pk_bf16_f32 v144, v32, v33
v_cvt_pk_bf16_f32 v145, v34, v35
v_cvt_pk_bf16_f32 v146, v36, v37
v_cvt_pk_bf16_f32 v147, v38, v39
s_nop 0
v_permlane16_swap_b32 v144, v146
v_permlane16_swap_b32 v145, v147
s_nop 0
v_permlane32_swap_b32 v144, v146
v_permlane32_swap_b32 v145, v147
Lz1skip_56:
buffer_store_dwordx4 v[144:147], v8, s[16:19], s64 offen offset:0 sc1
s_cmp_gt_u32 s59, 1
s_cselect_b32 s65, s54, 268435456
s_cbranch_scc0 Lz1skip_57
v_pk_fma_f32 v[40:41], v[84:85], v[104:105], v[40:41] op_sel_hi:[1,0,1] neg_lo:[1,0,0] neg_hi:[1,0,0]
v_pk_fma_f32 v[42:43], v[86:87], v[104:105], v[42:43] op_sel_hi:[1,0,1] neg_lo:[1,0,0] neg_hi:[1,0,0]
v_pk_fma_f32 v[44:45], v[84:85], v[106:107], v[44:45] op_sel_hi:[1,0,1] neg_lo:[1,0,0] neg_hi:[1,0,0]
v_pk_fma_f32 v[46:47], v[86:87], v[106:107], v[46:47] op_sel_hi:[1,0,1] neg_lo:[1,0,0] neg_hi:[1,0,0]
v_pk_mul_f32 v[20:21], v[40:41], v[40:41]
v_pk_mul_f32 v[22:23], v[42:43], v[42:43]
v_pk_mul_f32 v[26:27], v[44:45], v[44:45]
v_pk_mul_f32 v[28:29], v[46:47], v[46:47]
v_pk_fma_f32 v[20:21], v[20:21], v[108:109], v[112:113] op_sel_hi:[1,0,0]
v_pk_fma_f32 v[22:23], v[22:23], v[108:109], v[112:113] op_sel_hi:[1,0,0]
v_pk_fma_f32 v[26:27], v[26:27], v[110:111], v[114:115] op_sel_hi:[1,0,0]
v_pk_fma_f32 v[28:29], v[28:29], v[110:111], v[114:115] op_sel_hi:[1,0,0]
v_pk_mul_f32 v[20:21], v[20:21], v[40:41]
v_pk_mul_f32 v[22:23], v[22:23], v[42:43]
v_pk_mul_f32 v[26:27], v[26:27], v[44:45]
v_pk_mul_f32 v[28:29], v[28:29], v[46:47]
v_exp_f32 v20, v20
v_exp_f32 v21, v21
v_exp_f32 v22, v22
v_exp_f32 v23, v23
v_exp_f32 v26, v26
v_exp_f32 v27, v27
v_exp_f32 v28, v28
v_exp_f32 v29, v29
v_pk_fma_f32 v[20:21], v[20:21], v[116:117], v[116:117] op_sel_hi:[1,0,0]
v_pk_fma_f32 v[22:23], v[22:23], v[116:117], v[116:117] op_sel_hi:[1,0,0]
v_pk_fma_f32 v[26:27], v[26:27], v[118:119], v[118:119] op_sel_hi:[1,0,0]
v_pk_fma_f32 v[28:29], v[28:29], v[118:119], v[118:119] op_sel_hi:[1,0,0]
v_rcp_f32 v20, v20
v_rcp_f32 v21, v21
v_rcp_f32 v22, v22
v_rcp_f32 v23, v23
v_rcp_f32 v26, v26
v_rcp_f32 v27, v27
v_rcp_f32 v28, v28
v_rcp_f32 v29, v29
v_pk_mul_f32 v[40:41], v[40:41], v[20:21]
v_pk_mul_f32 v[42:43], v[42:43], v[22:23]
v_pk_mul_f32 v[44:45], v[44:45], v[26:27]
v_pk_mul_f32 v[46:47], v[46:47], v[28:29]
v_cvt_pk_bf16_f32 v148, v40, v41
v_cvt_pk_bf16_f32 v149, v42, v43
v_cvt_pk_bf16_f32 v150, v44, v45
v_cvt_pk_bf16_f32 v151, v46, v47
s_nop 0
v_permlane16_swap_b32 v148, v150
v_permlane16_swap_b32 v149, v151
s_nop 0
v_permlane32_swap_b32 v148, v150
v_permlane32_swap_b32 v149, v151
Lz1skip_57:
buffer_store_dwordx4 v[148:151], v8, s[16:19], s65 offen offset:1024 sc1
s_cmp_gt_u32 s59, 2
s_cselect_b32 s66, s54, 268435456
s_cbranch_scc0 Lz1skip_58
v_pk_fma_f32 v[48:49], v[88:89], v[104:105], v[48:49] op_sel_hi:[1,0,1] neg_lo:[1,0,0] neg_hi:[1,0,0]
v_pk_fma_f32 v[50:51], v[90:91], v[104:105], v[50:51] op_sel_hi:[1,0,1] neg_lo:[1,0,0] neg_hi:[1,0,0]
v_pk_fma_f32 v[52:53], v[88:89], v[106:107], v[52:53] op_sel_hi:[1,0,1] neg_lo:[1,0,0] neg_hi:[1,0,0]
v_pk_fma_f32 v[54:55], v[90:91], v[106:107], v[54:55] op_sel_hi:[1,0,1] neg_lo:[1,0,0] neg_hi:[1,0,0]
v_pk_mul_f32 v[20:21], v[48:49], v[48:49]
v_pk_mul_f32 v[22:23], v[50:51], v[50:51]
v_pk_mul_f32 v[26:27], v[52:53], v[52:53]
v_pk_mul_f32 v[28:29], v[54:55], v[54:55]
v_pk_fma_f32 v[20:21], v[20:21], v[108:109], v[112:113] op_sel_hi:[1,0,0]
v_pk_fma_f32 v[22:23], v[22:23], v[108:109], v[112:113] op_sel_hi:[1,0,0]
v_pk_fma_f32 v[26:27], v[26:27], v[110:111], v[114:115] op_sel_hi:[1,0,0]
v_pk_fma_f32 v[28:29], v[28:29], v[110:111], v[114:115] op_sel_hi:[1,0,0]
v_pk_mul_f32 v[20:21], v[20:21], v[48:49]
v_pk_mul_f32 v[22:23], v[22:23], v[50:51]
v_pk_mul_f32 v[26:27], v[26:27], v[52:53]
v_pk_mul_f32 v[28:29], v[28:29], v[54:55]
v_exp_f32 v20, v20
v_exp_f32 v21, v21
v_exp_f32 v22, v22
v_exp_f32 v23, v23
v_exp_f32 v26, v26
v_exp_f32 v27, v27
v_exp_f32 v28, v28
v_exp_f32 v29, v29
v_pk_fma_f32 v[20:21], v[20:21], v[116:117], v[116:117] op_sel_hi:[1,0,0]
v_pk_fma_f32 v[22:23], v[22:23], v[116:117], v[116:117] op_sel_hi:[1,0,0]
v_pk_fma_f32 v[26:27], v[26:27], v[118:119], v[118:119] op_sel_hi:[1,0,0]
v_pk_fma_f32 v[28:29], v[28:29], v[118:119], v[118:119] op_sel_hi:[1,0,0]
v_rcp_f32 v20, v20
v_rcp_f32 v21, v21
v_rcp_f32 v22, v22
v_rcp_f32 v23, v23
v_rcp_f32 v26, v26
v_rcp_f32 v27, v27
v_rcp_f32 v28, v28
v_rcp_f32 v29, v29
v_pk_mul_f32 v[48:49], v[48:49], v[20:21]
v_pk_mul_f32 v[50:51], v[50:51], v[22:23]
v_pk_mul_f32 v[52:53], v[52:53], v[26:27]
v_pk_mul_f32 v[54:55], v[54:55], v[28:29]
v_cvt_pk_bf16_f32 v152, v48, v49
v_cvt_pk_bf16_f32 v153, v50, v51
v_cvt_pk_bf16_f32 v154, v52, v53
v_cvt_pk_bf16_f32 v155, v54, v55
s_nop 0
v_permlane16_swap_b32 v152, v154
v_permlane16_swap_b32 v153, v155
s_nop 0
v_permlane32_swap_b32 v152, v154
v_permlane32_swap_b32 v153, v155
Lz1skip_58:
buffer_store_dwordx4 v[152:155], v8, s[16:19], s66 offen offset:2048 sc1
s_cmp_gt_u32 s59, 3
s_cselect_b32 s67, s54, 268435456
s_cbranch_scc0 Lz1skip_59
v_pk_fma_f32 v[56:57], v[92:93], v[104:105], v[56:57] op_sel_hi:[1,0,1] neg_lo:[1,0,0] neg_hi:[1,0,0]
v_pk_fma_f32 v[58:59], v[94:95], v[104:105], v[58:59] op_sel_hi:[1,0,1] neg_lo:[1,0,0] neg_hi:[1,0,0]
v_pk_fma_f32 v[60:61], v[92:93], v[106:107], v[60:61] op_sel_hi:[1,0,1] neg_lo:[1,0,0] neg_hi:[1,0,0]
v_pk_fma_f32 v[62:63], v[94:95], v[106:107], v[62:63] op_sel_hi:[1,0,1] neg_lo:[1,0,0] neg_hi:[1,0,0]
v_pk_mul_f32 v[20:21], v[56:57], v[56:57]
v_pk_mul_f32 v[22:23], v[58:59], v[58:59]
v_pk_mul_f32 v[26:27], v[60:61], v[60:61]
v_pk_mul_f32 v[28:29], v[62:63], v[62:63]
v_pk_fma_f32 v[20:21], v[20:21], v[108:109], v[112:113] op_sel_hi:[1,0,0]
v_pk_fma_f32 v[22:23], v[22:23], v[108:109], v[112:113] op_sel_hi:[1,0,0]
v_pk_fma_f32 v[26:27], v[26:27], v[110:111], v[114:115] op_sel_hi:[1,0,0]
v_pk_fma_f32 v[28:29], v[28:29], v[110:111], v[114:115] op_sel_hi:[1,0,0]
v_pk_mul_f32 v[20:21], v[20:21], v[56:57]
v_pk_mul_f32 v[22:23], v[22:23], v[58:59]
v_pk_mul_f32 v[26:27], v[26:27], v[60:61]
v_pk_mul_f32 v[28:29], v[28:29], v[62:63]
v_exp_f32 v20, v20
v_exp_f32 v21, v21
v_exp_f32 v22, v22
v_exp_f32 v23, v23
v_exp_f32 v26, v26
v_exp_f32 v27, v27
v_exp_f32 v28, v28
v_exp_f32 v29, v29
v_pk_fma_f32 v[20:21], v[20:21], v[116:117], v[116:117] op_sel_hi:[1,0,0]
v_pk_fma_f32 v[22:23], v[22:23], v[116:117], v[116:117] op_sel_hi:[1,0,0]
v_pk_fma_f32 v[26:27], v[26:27], v[118:119], v[118:119] op_sel_hi:[1,0,0]
v_pk_fma_f32 v[28:29], v[28:29], v[118:119], v[118:119] op_sel_hi:[1,0,0]
v_rcp_f32 v20, v20
v_rcp_f32 v21, v21
v_rcp_f32 v22, v22
v_rcp_f32 v23, v23
v_rcp_f32 v26, v26
v_rcp_f32 v27, v27
v_rcp_f32 v28, v28
v_rcp_f32 v29, v29
v_pk_mul_f32 v[56:57], v[56:57], v[20:21]
v_pk_mul_f32 v[58:59], v[58:59], v[22:23]
v_pk_mul_f32 v[60:61], v[60:61], v[26:27]
v_pk_mul_f32 v[62:63], v[62:63], v[28:29]
v_cvt_pk_bf16_f32 v156, v56, v57
v_cvt_pk_bf16_f32 v157, v58, v59
v_cvt_pk_bf16_f32 v158, v60, v61
v_cvt_pk_bf16_f32 v159, v62, v63
s_nop 0
v_permlane16_swap_b32 v156, v158
v_permlane16_swap_b32 v157, v159
s_nop 0
v_permlane32_swap_b32 v156, v158
v_permlane32_swap_b32 v157, v159
Lz1skip_59:
buffer_store_dwordx4 v[156:159], v8, s[16:19], s67 offen offset:3072 sc1
s_cmp_gt_u32 s59, 4
s_cselect_b32 s68, s54, 268435456
s_cbranch_scc0 Lz1skip_60
v_pk_fma_f32 v[64:65], v[96:97], v[104:105], v[64:65] op_sel_hi:[1,0,1] neg_lo:[1,0,0] neg_hi:[1,0,0]
v_pk_fma_f32 v[66:67], v[98:99], v[104:105], v[66:67] op_sel_hi:[1,0,1] neg_lo:[1,0,0] neg_hi:[1,0,0]
v_pk_fma_f32 v[68:69], v[96:97], v[106:107], v[68:69] op_sel_hi:[1,0,1] neg_lo:[1,0,0] neg_hi:[1,0,0]
v_pk_fma_f32 v[70:71], v[98:99], v[106:107], v[70:71] op_sel_hi:[1,0,1] neg_lo:[1,0,0] neg_hi:[1,0,0]
v_pk_mul_f32 v[20:21], v[64:65], v[64:65]
v_pk_mul_f32 v[22:23], v[66:67], v[66:67]
v_pk_mul_f32 v[26:27], v[68:69], v[68:69]
v_pk_mul_f32 v[28:29], v[70:71], v[70:71]
v_pk_fma_f32 v[20:21], v[20:21], v[108:109], v[112:113] op_sel_hi:[1,0,0]
v_pk_fma_f32 v[22:23], v[22:23], v[108:109], v[112:113] op_sel_hi:[1,0,0]
v_pk_fma_f32 v[26:27], v[26:27], v[110:111], v[114:115] op_sel_hi:[1,0,0]
v_pk_fma_f32 v[28:29], v[28:29], v[110:111], v[114:115] op_sel_hi:[1,0,0]
v_pk_mul_f32 v[20:21], v[20:21], v[64:65]
v_pk_mul_f32 v[22:23], v[22:23], v[66:67]
v_pk_mul_f32 v[26:27], v[26:27], v[68:69]
v_pk_mul_f32 v[28:29], v[28:29], v[70:71]
v_exp_f32 v20, v20
v_exp_f32 v21, v21
v_exp_f32 v22, v22
v_exp_f32 v23, v23
v_exp_f32 v26, v26
v_exp_f32 v27, v27
v_exp_f32 v28, v28
v_exp_f32 v29, v29
v_pk_fma_f32 v[20:21], v[20:21], v[116:117], v[116:117] op_sel_hi:[1,0,0]
v_pk_fma_f32 v[22:23], v[22:23], v[116:117], v[116:117] op_sel_hi:[1,0,0]
v_pk_fma_f32 v[26:27], v[26:27], v[118:119], v[118:119] op_sel_hi:[1,0,0]
v_pk_fma_f32 v[28:29], v[28:29], v[118:119], v[118:119] op_sel_hi:[1,0,0]
v_rcp_f32 v20, v20
v_rcp_f32 v21, v21
v_rcp_f32 v22, v22
v_rcp_f32 v23, v23
v_rcp_f32 v26, v26
v_rcp_f32 v27, v27
v_rcp_f32 v28, v28
v_rcp_f32 v29, v29
v_pk_mul_f32 v[64:65], v[64:65], v[20:21]
v_pk_mul_f32 v[66:67], v[66:67], v[22:23]
v_pk_mul_f32 v[68:69], v[68:69], v[26:27]
v_pk_mul_f32 v[70:71], v[70:71], v[28:29]
v_cvt_pk_bf16_f32 v160, v64, v65
v_cvt_pk_bf16_f32 v161, v66, v67
v_cvt_pk_bf16_f32 v162, v68, v69
v_cvt_pk_bf16_f32 v163, v70, v71
s_nop 0
v_permlane16_swap_b32 v160, v162
v_permlane16_swap_b32 v161, v163
s_nop 0
v_permlane32_swap_b32 v160, v162
v_permlane32_swap_b32 v161, v163
Lz1skip_60:
s_add_u32 s68, s68, 4096
buffer_store_dwordx4 v[160:163], v8, s[16:19], s68 offen offset:0 sc1
s_cmp_gt_u32 s59, 5
s_cselect_b32 s69, s54, 268435456
s_cbranch_scc0 Lz1skip_61
v_pk_fma_f32 v[72:73], v[100:101], v[104:105], v[72:73] op_sel_hi:[1,0,1] neg_lo:[1,0,0] neg_hi:[1,0,0]
v_pk_fma_f32 v[74:75], v[102:103], v[104:105], v[74:75] op_sel_hi:[1,0,1] neg_lo:[1,0,0] neg_hi:[1,0,0]
v_pk_fma_f32 v[76:77], v[100:101], v[106:107], v[76:77] op_sel_hi:[1,0,1] neg_lo:[1,0,0] neg_hi:[1,0,0]
v_pk_fma_f32 v[78:79], v[102:103], v[106:107], v[78:79] op_sel_hi:[1,0,1] neg_lo:[1,0,0] neg_hi:[1,0,0]
v_pk_mul_f32 v[20:21], v[72:73], v[72:73]
v_pk_mul_f32 v[22:23], v[74:75], v[74:75]
v_pk_mul_f32 v[26:27], v[76:77], v[76:77]
v_pk_mul_f32 v[28:29], v[78:79], v[78:79]
v_pk_fma_f32 v[20:21], v[20:21], v[108:109], v[112:113] op_sel_hi:[1,0,0]
v_pk_fma_f32 v[22:23], v[22:23], v[108:109], v[112:113] op_sel_hi:[1,0,0]
v_pk_fma_f32 v[26:27], v[26:27], v[110:111], v[114:115] op_sel_hi:[1,0,0]
v_pk_fma_f32 v[28:29], v[28:29], v[110:111], v[114:115] op_sel_hi:[1,0,0]
v_pk_mul_f32 v[20:21], v[20:21], v[72:73]
v_pk_mul_f32 v[22:23], v[22:23], v[74:75]
v_pk_mul_f32 v[26:27], v[26:27], v[76:77]
v_pk_mul_f32 v[28:29], v[28:29], v[78:79]
v_exp_f32 v20, v20
v_exp_f32 v21, v21
v_exp_f32 v22, v22
v_exp_f32 v23, v23
v_exp_f32 v26, v26
v_exp_f32 v27, v27
v_exp_f32 v28, v28
v_exp_f32 v29, v29
v_pk_fma_f32 v[20:21], v[20:21], v[116:117], v[116:117] op_sel_hi:[1,0,0]
v_pk_fma_f32 v[22:23], v[22:23], v[116:117], v[116:117] op_sel_hi:[1,0,0]
v_pk_fma_f32 v[26:27], v[26:27], v[118:119], v[118:119] op_sel_hi:[1,0,0]
v_pk_fma_f32 v[28:29], v[28:29], v[118:119], v[118:119] op_sel_hi:[1,0,0]
v_rcp_f32 v20, v20
v_rcp_f32 v21, v21
v_rcp_f32 v22, v22
v_rcp_f32 v23, v23
v_rcp_f32 v26, v26
v_rcp_f32 v27, v27
v_rcp_f32 v28, v28
v_rcp_f32 v29, v29
v_pk_mul_f32 v[72:73], v[72:73], v[20:21]
v_pk_mul_f32 v[74:75], v[74:75], v[22:23]
v_pk_mul_f32 v[76:77], v[76:77], v[26:27]
v_pk_mul_f32 v[78:79], v[78:79], v[28:29]
v_cvt_pk_bf16_f32 v164, v72, v73
v_cvt_pk_bf16_f32 v165, v74, v75
v_cvt_pk_bf16_f32 v166, v76, v77
v_cvt_pk_bf16_f32 v167, v78, v79
s_nop 0
v_permlane16_swap_b32 v164, v166
v_permlane16_swap_b32 v165, v167
s_nop 0
v_permlane32_swap_b32 v164, v166
v_permlane32_swap_b32 v165, v167
Lz1skip_61:
s_add_u32 s69, s69, 4096
buffer_store_dwordx4 v[164:167], v8, s[16:19], s69 offen offset:1024 sc1
s_mov_b32 s75, 268435456
LF_cb:
v_and_b32 v3, 31, v1
v_lshrrev_b32 v30, 5, v1
v_bfe_u32 v31, v1, 1, 3
v_xor_b32 v31, v30, v31
v_lshlrev_b32 v3, 7, v3
v_lshl_add_u32 v10, v31, 4, v3
s_lshl_b32 s61, s4, 12
v_add_u32 v10, s61, v10
v_xor_b32 v11, 32, v10
v_xor_b32 v12, 64, v10
v_xor_b32 v13, 96, v10
v_add_u32 v14, 0x10000, v10
v_add_u32 v15, 0x10000, v11
v_add_u32 v16, 0x10000, v12
v_add_u32 v17, 0x10000, v13
v_lshlrev_b32_e64 v19, 4, v1
v_add_u32 v18, 114688, v19
v_add_u32 v21, 163840, v19
s_lshl_b32 s57, s6, 2
s_add_u32 s57, s57, s4
s_mul_i32 s55, s50, 6
s_add_u32 s58, s55, 5
s_min_u32 s58, s58, 43
s_sub_u32 s55, s55, 1
s_max_i32 s55, s55, 0
s_sub_u32 s58, s58, s55
s_mul_i32 s53, s57, 48
s_add_u32 s53, s53, s55
s_lshl_b32 s53, s53, 10
s_mul_i32 s61, s48, 3145728
s_add_u32 s54, s53, s61
s_add_u32 s53, s53, 4194304
s_add_u32 s54, s54, 8388608
s_add_u32 s59, s54, 4096
s_mov_b32 s60, 268435456
v_lshlrev_b32 v22, 16, v0
v_mov_b32 v232, v22
v_mov_b32 v233, v22
v_mov_b32 v234, v22
v_mov_b32 v235, v22
v_mov_b32 v236, v22
v_mov_b32 v237, v22
v_mov_b32 v238, v22
v_mov_b32 v239, v22
v_mov_b32 v240, v22
v_mov_b32 v241, v22
v_mov_b32 v242, v22
v_mov_b32 v243, v22
v_mov_b32 v244, v22
v_mov_b32 v245, v22
v_mov_b32 v246, v22
v_mov_b32 v247, v22
s_lshl_b32 s56, s49, 1
s_and_b32 s61, s4, 1
s_add_u32 s56, s56, s61
s_lshl_b32 s56, s56, 1
s_lshr_b32 s61, s4, 1
s_add_u32 s56, s56, s61
s_lshl_b32 s56, s56, 14
s_add_u32 s56, s56, 16777216
s_barrier
s_cmp_eq_u32 s50, 7
s_cbranch_scc1 Lb7_62
s_barrier
ds_read_b128 v[80:83], v18 offset:0
ds_read_b128 v[84:87], v10 offset:0
ds_read_b128 v[88:91], v18 offset:1024
ds_read_b128 v[92:95], v18 offset:2048
ds_read_b128 v[96:99], v18 offset:3072
ds_read_b128 v[100:103], v11 offset:0
ds_read_b128 v[104:107], v18 offset:4096
ds_read_b128 v[108:111], v18 offset:5120
s_waitcnt lgkmcnt(6)
v_mfma_f32_32x32x16_bf16 v[32:47], v[80:83], v[84:87], v[232:247]
ds_read_b128 v[112:115], v18 offset:6144
ds_read_b128 v[116:119], v12 offset:0
s_waitcnt lgkmcnt(7)
v_mfma_f32_32x32x16_bf16 v[48:63], v[88:91], v[84:87], v[232:247]
ds_read_b128 v[120:123], v18 offset:7168
s_waitcnt lgkmcnt(7)
v_mfma_f32_32x32x16_bf16 v[64:79], v[92:95], v[84:87], v[232:247]
ds_read_b128 v[124:127], v18 offset:8192
s_waitcnt lgkmcnt(6)
v_mfma_f32_32x32x16_bf16 v[32:47], v[96:99], v[100:103], v[32:47]
ds_read_b128 v[128:131], v18 offset:9216
ds_read_b128 v[132:135], v13 offset:0
s_waitcnt lgkmcnt(7)
v_mfma_f32_32x32x16_bf16 v[48:63], v[104:107], v[100:103], v[48:63]
ds_read_b128 v[136:139], v18 offset:10240
s_waitcnt lgkmcnt(7)
v_mfma_f32_32x32x16_bf16 v[64:79], v[108:111], v[100:103], v[64:79]
ds_read_b128 v[140:143], v18 offset:11264
s_waitcnt lgkmcnt(6)
v_mfma_f32_32x32x16_bf16 v[32:47], v[112:115], v[116:119], v[32:47]
s_waitcnt lgkmcnt(5)
v_mfma_f32_32x32x16_bf16 v[48:63], v[120:123], v[116:119], v[48:63]
s_waitcnt lgkmcnt(0)
s_barrier
ds_read_b128 v[80:83], v18 offset:12288
ds_read_b128 v[88:91], v10 offset:16384
v_mfma_f32_32x32x16_bf16 v[64:79], v[124:127], v[116:119], v[64:79]
ds_read_b128 v[84:87], v18 offset:13312
ds_read_b128 v[92:95], v18 offset:14336
v_mfma_f32_32x32x16_bf16 v[32:47], v[128:131], v[132:135], v[32:47]
ds_read_b128 v[96:99], v18 offset:15360
ds_read_b128 v[104:107], v11 offset:16384
v_mfma_f32_32x32x16_bf16 v[48:63], v[136:139], v[132:135], v[48:63]
ds_read_b128 v[100:103], v18 offset:16384
v_mfma_f32_32x32x16_bf16 v[64:79], v[140:143], v[132:135], v[64:79]
ds_read_b128 v[108:111], v18 offset:17408
s_waitcnt lgkmcnt(6)
v_mfma_f32_32x32x16_bf16 v[32:47], v[80:83], v[88:91], v[32:47]
ds_read_b128 v[112:115], v18 offset:18432
ds_read_b128 v[120:123], v12 offset:16384
s_waitcnt lgkmcnt(7)
v_mfma_f32_32x32x16_bf16 v[48:63], v[84:87], v[88:91], v[48:63]
ds_read_b128 v[116:119], v18 offset:19456
s_waitcnt lgkmcnt(7)
v_mfma_f32_32x32x16_bf16 v[64:79], v[92:95], v[88:91], v[64:79]
ds_read_b128 v[124:127], v18 offset:20480
s_waitcnt lgkmcnt(6)
v_mfma_f32_32x32x16_bf16 v[32:47], v[96:99], v[104:107], v[32:47]
ds_read_b128 v[128:131], v18 offset:21504
ds_read_b128 v[136:139], v13 offset:16384
s_waitcnt lgkmcnt(7)
v_mfma_f32_32x32x16_bf16 v[48:63], v[100:103], v[104:107], v[48:63]
ds_read_b128 v[132:135], v18 offset:22528
s_waitcnt lgkmcnt(7)
v_mfma_f32_32x32x16_bf16 v[64:79], v[108:111], v[104:107], v[64:79]
ds_read_b128 v[140:143], v18 offset:23552
s_waitcnt lgkmcnt(6)
v_mfma_f32_32x32x16_bf16 v[32:47], v[112:115], v[120:123], v[32:47]
s_waitcnt lgkmcnt(5)
v_mfma_f32_32x32x16_bf16 v[48:63], v[116:119], v[120:123], v[48:63]
v_mov_b32 v30, s52
v_mov_b32 v31, 0
s_waitcnt vmcnt(0)
s_mov_b64 exec, 1
buffer_store_dword v30, v31, s[16:19], s75 offen sc1
s_mov_b64 exec, -1
s_waitcnt lgkmcnt(0)
s_barrier
ds_read_b128 v[80:83], v18 offset:24576
ds_read_b128 v[84:87], v10 offset:32768
v_mfma_f32_32x32x16_bf16 v[64:79], v[124:127], v[120:123], v[64:79]
ds_read_b128 v[88:91], v18 offset:25600
ds_read_b128 v[92:95], v18 offset:26624
v_mfma_f32_32x32x16_bf16 v[32:47], v[128:131], v[136:139], v[32:47]
ds_read_b128 v[96:99], v18 offset:27648
ds_read_b128 v[100:103], v11 offset:32768
v_mfma_f32_32x32x16_bf16 v[48:63], v[132:135], v[136:139], v[48:63]
ds_read_b128 v[104:107], v18 offset:28672
v_mfma_f32_32x32x16_bf16 v[64:79], v[140:143], v[136:139], v[64:79]
ds_read_b128 v[108:111], v18 offset:29696
s_waitcnt lgkmcnt(6)
v_mfma_f32_32x32x16_bf16 v[32:47], v[80:83], v[84:87], v[32:47]
ds_read_b128 v[112:115], v18 offset:30720
ds_read_b128 v[116:119], v12 offset:32768
s_waitcnt lgkmcnt(7)
v_mfma_f32_32x32x16_bf16 v[48:63], v[88:91], v[84:87], v[48:63]
ds_read_b128 v[120:123], v18 offset:31744
s_waitcnt lgkmcnt(7)
v_mfma_f32_32x32x16_bf16 v[64:79], v[92:95], v[84:87], v[64:79]
ds_read_b128 v[124:127], v18 offset:32768
s_waitcnt lgkmcnt(6)
v_mfma_f32_32x32x16_bf16 v[32:47], v[96:99], v[100:103], v[32:47]
ds_read_b128 v[128:131], v18 offset:33792
ds_read_b128 v[132:135], v13 offset:32768
s_waitcnt lgkmcnt(7)
v_mfma_f32_32x32x16_bf16 v[48:63], v[104:107], v[100:103], v[48:63]
ds_read_b128 v[136:139], v18 offset:34816
s_waitcnt lgkmcnt(7)
v_mfma_f32_32x32x16_bf16 v[64:79], v[108:111], v[100:103], v[64:79]
ds_read_b128 v[140:143], v18 offset:35840
s_waitcnt lgkmcnt(6)
v_mfma_f32_32x32x16_bf16 v[32:47], v[112:115], v[116:119], v[32:47]
s_waitcnt lgkmcnt(5)
v_mfma_f32_32x32x16_bf16 v[48:63], v[120:123], v[116:119], v[48:63]
s_waitcnt lgkmcnt(0)
s_barrier
ds_read_b128 v[80:83], v18 offset:36864
ds_read_b128 v[88:91], v10 offset:49152
v_mfma_f32_32x32x16_bf16 v[64:79], v[124:127], v[116:119], v[64:79]
ds_read_b128 v[84:87], v18 offset:37888
ds_read_b128 v[92:95], v18 offset:38912
v_mfma_f32_32x32x16_bf16 v[32:47], v[128:131], v[132:135], v[32:47]
ds_read_b128 v[96:99], v18 offset:39936
ds_read_b128 v[104:107], v11 offset:49152
v_mfma_f32_32x32x16_bf16 v[48:63], v[136:139], v[132:135], v[48:63]
ds_read_b128 v[100:103], v18 offset:40960
v_mfma_f32_32x32x16_bf16 v[64:79], v[140:143], v[132:135], v[64:79]
ds_read_b128 v[108:111], v18 offset:41984
s_waitcnt lgkmcnt(6)
v_mfma_f32_32x32x16_bf16 v[32:47], v[80:83], v[88:91], v[32:47]
ds_read_b128 v[112:115], v18 offset:43008
ds_read_b128 v[120:123], v12 offset:49152
s_waitcnt lgkmcnt(7)
v_mfma_f32_32x32x16_bf16 v[48:63], v[84:87], v[88:91], v[48:63]
ds_read_b128 v[116:119], v18 offset:44032
s_waitcnt lgkmcnt(7)
v_mfma_f32_32x32x16_bf16 v[64:79], v[92:95], v[88:91], v[64:79]
ds_read_b128 v[124:127], v18 offset:45056
s_waitcnt lgkmcnt(6)
v_mfma_f32_32x32x16_bf16 v[32:47], v[96:99], v[104:107], v[32:47]
ds_read_b128 v[128:131], v18 offset:46080
ds_read_b128 v[136:139], v13 offset:49152
s_waitcnt lgkmcnt(7)
v_mfma_f32_32x32x16_bf16 v[48:63], v[100:103], v[104:107], v[48:63]
ds_read_b128 v[132:135], v18 offset:47104
s_waitcnt lgkmcnt(7)
v_mfma_f32_32x32x16_bf16 v[64:79], v[108:111], v[104:107], v[64:79]
ds_read_b128 v[140:143], v18 offset:48128
s_waitcnt lgkmcnt(6)
v_mfma_f32_32x32x16_bf16 v[32:47], v[112:115], v[120:123], v[32:47]
s_waitcnt lgkmcnt(5)
v_mfma_f32_32x32x16_bf16 v[48:63], v[116:119], v[120:123], v[48:63]
s_waitcnt lgkmcnt(0)
s_barrier
ds_read_b128 v[80:83], v18 offset:0
ds_read_b128 v[84:87], v14 offset:0
v_mfma_f32_32x32x16_bf16 v[64:79], v[124:127], v[120:123], v[64:79]
ds_read_b128 v[88:91], v18 offset:1024
ds_read_b128 v[92:95], v18 offset:2048
v_mfma_f32_32x32x16_bf16 v[32:47], v[128:131], v[136:139], v[32:47]
ds_read_b128 v[96:99], v18 offset:3072
ds_read_b128 v[100:103], v15 offset:0
v_mfma_f32_32x32x16_bf16 v[48:63], v[132:135], v[136:139], v[48:63]
ds_read_b128 v[104:107], v18 offset:4096
v_mfma_f32_32x32x16_bf16 v[64:79], v[140:143], v[136:139], v[64:79]
ds_read_b128 v[108:111], v18 offset:5120
s_waitcnt lgkmcnt(6)
v_mfma_f32_32x32x16_bf16 v[32:47], v[80:83], v[84:87], v[32:47]
ds_read_b128 v[112:115], v18 offset:6144
ds_read_b128 v[116:119], v16 offset:0
s_waitcnt lgkmcnt(7)
v_mfma_f32_32x32x16_bf16 v[48:63], v[88:91], v[84:87], v[48:63]
ds_read_b128 v[120:123], v18 offset:7168
s_waitcnt lgkmcnt(7)
v_mfma_f32_32x32x16_bf16 v[64:79], v[92:95], v[84:87], v[64:79]
ds_read_b128 v[124:127], v18 offset:8192
s_waitcnt lgkmcnt(6)
v_mfma_f32_32x32x16_bf16 v[32:47], v[96:99], v[100:103], v[32:47]
ds_read_b128 v[128:131], v18 offset:9216
ds_read_b128 v[132:135], v17 offset:0
s_waitcnt lgkmcnt(7)
v_mfma_f32_32x32x16_bf16 v[48:63], v[104:107], v[100:103], v[48:63]
ds_read_b128 v[136:139], v18 offset:10240
s_waitcnt lgkmcnt(7)
v_mfma_f32_32x32x16_bf16 v[64:79], v[108:111], v[100:103], v[64:79]
ds_read_b128 v[140:143], v18 offset:11264
s_waitcnt lgkmcnt(6)
v_mfma_f32_32x32x16_bf16 v[32:47], v[112:115], v[116:119], v[32:47]
s_waitcnt lgkmcnt(5)
v_mfma_f32_32x32x16_bf16 v[48:63], v[120:123], v[116:119], v[48:63]
s_waitcnt lgkmcnt(0)
s_barrier
ds_read_b128 v[80:83], v18 offset:12288
ds_read_b128 v[88:91], v14 offset:16384
v_mfma_f32_32x32x16_bf16 v[64:79], v[124:127], v[116:119], v[64:79]
ds_read_b128 v[84:87], v18 offset:13312
ds_read_b128 v[92:95], v18 offset:14336
v_mfma_f32_32x32x16_bf16 v[32:47], v[128:131], v[132:135], v[32:47]
ds_read_b128 v[96:99], v18 offset:15360
ds_read_b128 v[104:107], v15 offset:16384
v_mfma_f32_32x32x16_bf16 v[48:63], v[136:139], v[132:135], v[48:63]
ds_read_b128 v[100:103], v18 offset:16384
v_mfma_f32_32x32x16_bf16 v[64:79], v[140:143], v[132:135], v[64:79]
ds_read_b128 v[108:111], v18 offset:17408
s_waitcnt lgkmcnt(6)
v_mfma_f32_32x32x16_bf16 v[32:47], v[80:83], v[88:91], v[32:47]
ds_read_b128 v[112:115], v18 offset:18432
ds_read_b128 v[120:123], v16 offset:16384
s_waitcnt lgkmcnt(7)
v_mfma_f32_32x32x16_bf16 v[48:63], v[84:87], v[88:91], v[48:63]
ds_read_b128 v[116:119], v18 offset:19456
s_waitcnt lgkmcnt(7)
v_mfma_f32_32x32x16_bf16 v[64:79], v[92:95], v[88:91], v[64:79]
ds_read_b128 v[124:127], v18 offset:20480
s_waitcnt lgkmcnt(6)
v_mfma_f32_32x32x16_bf16 v[32:47], v[96:99], v[104:107], v[32:47]
ds_read_b128 v[128:131], v18 offset:21504
ds_read_b128 v[136:139], v17 offset:16384
s_waitcnt lgkmcnt(7)
v_mfma_f32_32x32x16_bf16 v[48:63], v[100:103], v[104:107], v[48:63]
ds_read_b128 v[132:135], v18 offset:22528
s_waitcnt lgkmcnt(7)
v_mfma_f32_32x32x16_bf16 v[64:79], v[108:111], v[104:107], v[64:79]
ds_read_b128 v[140:143], v18 offset:23552
s_waitcnt lgkmcnt(6)
v_mfma_f32_32x32x16_bf16 v[32:47], v[112:115], v[120:123], v[32:47]
s_waitcnt lgkmcnt(5)
v_mfma_f32_32x32x16_bf16 v[48:63], v[116:119], v[120:123], v[48:63]
s_waitcnt lgkmcnt(0)
s_barrier
ds_read_b128 v[80:83], v18 offset:24576
ds_read_b128 v[84:87], v14 offset:32768
v_mfma_f32_32x32x16_bf16 v[64:79], v[124:127], v[120:123], v[64:79]
ds_read_b128 v[88:91], v18 offset:25600
ds_read_b128 v[92:95], v18 offset:26624
v_mfma_f32_32x32x16_bf16 v[32:47], v[128:131], v[136:139], v[32:47]
ds_read_b128 v[96:99], v18 offset:27648
ds_read_b128 v[100:103], v15 offset:32768
v_mfma_f32_32x32x16_bf16 v[48:63], v[132:135], v[136:139], v[48:63]
ds_read_b128 v[104:107], v18 offset:28672
v_mfma_f32_32x32x16_bf16 v[64:79], v[140:143], v[136:139], v[64:79]
ds_read_b128 v[108:111], v18 offset:29696
s_waitcnt lgkmcnt(6)
v_mfma_f32_32x32x16_bf16 v[32:47], v[80:83], v[84:87], v[32:47]
ds_read_b128 v[112:115], v18 offset:30720
ds_read_b128 v[116:119], v16 offset:32768
s_waitcnt lgkmcnt(7)
v_mfma_f32_32x32x16_bf16 v[48:63], v[88:91], v[84:87], v[48:63]
ds_read_b128 v[120:123], v18 offset:31744
s_waitcnt lgkmcnt(7)
v_mfma_f32_32x32x16_bf16 v[64:79], v[92:95], v[84:87], v[64:79]
ds_read_b128 v[124:127], v18 offset:32768
s_waitcnt lgkmcnt(6)
v_mfma_f32_32x32x16_bf16 v[32:47], v[96:99], v[100:103], v[32:47]
ds_read_b128 v[128:131], v18 offset:33792
ds_read_b128 v[132:135], v17 offset:32768
s_waitcnt lgkmcnt(7)
v_mfma_f32_32x32x16_bf16 v[48:63], v[104:107], v[100:103], v[48:63]
ds_read_b128 v[136:139], v18 offset:34816
s_waitcnt lgkmcnt(7)
v_mfma_f32_32x32x16_bf16 v[64:79], v[108:111], v[100:103], v[64:79]
ds_read_b128 v[140:143], v18 offset:35840
s_waitcnt lgkmcnt(6)
v_mfma_f32_32x32x16_bf16 v[32:47], v[112:115], v[116:119], v[32:47]
s_waitcnt lgkmcnt(5)
v_mfma_f32_32x32x16_bf16 v[48:63], v[120:123], v[116:119], v[48:63]
s_waitcnt lgkmcnt(0)
s_barrier
ds_read_b128 v[80:83], v18 offset:36864
ds_read_b128 v[88:91], v10 offset:0
v_mfma_f32_32x32x16_bf16 v[64:79], v[124:127], v[116:119], v[64:79]
ds_read_b128 v[84:87], v18 offset:37888
ds_read_b128 v[92:95], v18 offset:38912
v_mfma_f32_32x32x16_bf16 v[32:47], v[128:131], v[132:135], v[32:47]
ds_read_b128 v[96:99], v18 offset:39936
ds_read_b128 v[104:107], v11 offset:0
v_mfma_f32_32x32x16_bf16 v[48:63], v[136:139], v[132:135], v[48:63]
ds_read_b128 v[100:103], v18 offset:40960
v_mfma_f32_32x32x16_bf16 v[64:79], v[140:143], v[132:135], v[64:79]
ds_read_b128 v[108:111], v18 offset:41984
s_waitcnt lgkmcnt(6)
v_mfma_f32_32x32x16_bf16 v[32:47], v[80:83], v[88:91], v[32:47]
ds_read_b128 v[112:115], v18 offset:43008
ds_read_b128 v[120:123], v12 offset:0
s_waitcnt lgkmcnt(7)
v_mfma_f32_32x32x16_bf16 v[48:63], v[84:87], v[88:91], v[48:63]
ds_read_b128 v[116:119], v18 offset:44032
s_waitcnt lgkmcnt(7)
v_mfma_f32_32x32x16_bf16 v[64:79], v[92:95], v[88:91], v[64:79]
ds_read_b128 v[124:127], v18 offset:45056
s_waitcnt lgkmcnt(6)
v_mfma_f32_32x32x16_bf16 v[32:47], v[96:99], v[104:107], v[32:47]
ds_read_b128 v[128:131], v18 offset:46080
ds_read_b128 v[136:139], v13 offset:0
s_waitcnt lgkmcnt(7)
v_mfma_f32_32x32x16_bf16 v[48:63], v[100:103], v[104:107], v[48:63]
ds_read_b128 v[132:135], v18 offset:47104
s_waitcnt lgkmcnt(7)
v_mfma_f32_32x32x16_bf16 v[64:79], v[108:111], v[104:107], v[64:79]
ds_read_b128 v[140:143], v18 offset:48128
s_waitcnt lgkmcnt(6)
v_mfma_f32_32x32x16_bf16 v[32:47], v[112:115], v[120:123], v[32:47]
s_waitcnt lgkmcnt(5)
v_mfma_f32_32x32x16_bf16 v[48:63], v[116:119], v[120:123], v[48:63]
s_waitcnt lgkmcnt(0)
s_barrier
ds_read_b128 v[80:83], v18 offset:0
ds_read_b128 v[84:87], v10 offset:16384
v_mfma_f32_32x32x16_bf16 v[64:79], v[124:127], v[120:123], v[64:79]
ds_read_b128 v[88:91], v18 offset:1024
ds_read_b128 v[92:95], v18 offset:2048
v_mfma_f32_32x32x16_bf16 v[32:47], v[128:131], v[136:139], v[32:47]
ds_read_b128 v[96:99], v18 offset:3072
ds_read_b128 v[100:103], v11 offset:16384
v_mfma_f32_32x32x16_bf16 v[48:63], v[132:135], v[136:139], v[48:63]
ds_read_b128 v[104:107], v18 offset:4096
v_mfma_f32_32x32x16_bf16 v[64:79], v[140:143], v[136:139], v[64:79]
ds_read_b128 v[108:111], v18 offset:5120
s_waitcnt lgkmcnt(6)
v_mfma_f32_32x32x16_bf16 v[32:47], v[80:83], v[84:87], v[32:47]
ds_read_b128 v[112:115], v18 offset:6144
ds_read_b128 v[116:119], v12 offset:16384
s_waitcnt lgkmcnt(7)
v_mfma_f32_32x32x16_bf16 v[48:63], v[88:91], v[84:87], v[48:63]
ds_read_b128 v[120:123], v18 offset:7168
s_waitcnt lgkmcnt(7)
v_mfma_f32_32x32x16_bf16 v[64:79], v[92:95], v[84:87], v[64:79]
ds_read_b128 v[124:127], v18 offset:8192
s_waitcnt lgkmcnt(6)
v_mfma_f32_32x32x16_bf16 v[32:47], v[96:99], v[100:103], v[32:47]
ds_read_b128 v[128:131], v18 offset:9216
ds_read_b128 v[132:135], v13 offset:16384
s_waitcnt lgkmcnt(7)
v_mfma_f32_32x32x16_bf16 v[48:63], v[104:107], v[100:103], v[48:63]
ds_read_b128 v[136:139], v18 offset:10240
s_waitcnt lgkmcnt(7)
v_mfma_f32_32x32x16_bf16 v[64:79], v[108:111], v[100:103], v[64:79]
ds_read_b128 v[140:143], v18 offset:11264
s_waitcnt lgkmcnt(6)
v_mfma_f32_32x32x16_bf16 v[32:47], v[112:115], v[116:119], v[32:47]
s_waitcnt lgkmcnt(5)
v_mfma_f32_32x32x16_bf16 v[48:63], v[120:123], v[116:119], v[48:63]
s_waitcnt lgkmcnt(0)
s_barrier
ds_read_b128 v[80:83], v18 offset:12288
ds_read_b128 v[88:91], v10 offset:32768
v_mfma_f32_32x32x16_bf16 v[64:79], v[124:127], v[116:119], v[64:79]
ds_read_b128 v[84:87], v18 offset:13312
ds_read_b128 v[92:95], v18 offset:14336
v_mfma_f32_32x32x16_bf16 v[32:47], v[128:131], v[132:135], v[32:47]
ds_read_b128 v[96:99], v18 offset:15360
ds_read_b128 v[104:107], v11 offset:32768
v_mfma_f32_32x32x16_bf16 v[48:63], v[136:139], v[132:135], v[48:63]
ds_read_b128 v[100:103], v18 offset:16384
v_mfma_f32_32x32x16_bf16 v[64:79], v[140:143], v[132:135], v[64:79]
ds_read_b128 v[108:111], v18 offset:17408
s_waitcnt lgkmcnt(6)
v_mfma_f32_32x32x16_bf16 v[32:47], v[80:83], v[88:91], v[32:47]
ds_read_b128 v[112:115], v18 offset:18432
ds_read_b128 v[120:123], v12 offset:32768
s_waitcnt lgkmcnt(7)
v_mfma_f32_32x32x16_bf16 v[48:63], v[84:87], v[88:91], v[48:63]
ds_read_b128 v[116:119], v18 offset:19456
s_waitcnt lgkmcnt(7)
v_mfma_f32_32x32x16_bf16 v[64:79], v[92:95], v[88:91], v[64:79]
ds_read_b128 v[124:127], v18 offset:20480
s_waitcnt lgkmcnt(6)
v_mfma_f32_32x32x16_bf16 v[32:47], v[96:99], v[104:107], v[32:47]
ds_read_b128 v[128:131], v18 offset:21504
ds_read_b128 v[136:139], v13 offset:32768
s_waitcnt lgkmcnt(7)
v_mfma_f32_32x32x16_bf16 v[48:63], v[100:103], v[104:107], v[48:63]
ds_read_b128 v[132:135], v18 offset:22528
s_waitcnt lgkmcnt(7)
v_mfma_f32_32x32x16_bf16 v[64:79], v[108:111], v[104:107], v[64:79]
ds_read_b128 v[140:143], v18 offset:23552
s_waitcnt lgkmcnt(6)
v_mfma_f32_32x32x16_bf16 v[32:47], v[112:115], v[120:123], v[32:47]
s_waitcnt lgkmcnt(5)
v_mfma_f32_32x32x16_bf16 v[48:63], v[116:119], v[120:123], v[48:63]
s_waitcnt lgkmcnt(0)
s_barrier
ds_read_b128 v[80:83], v18 offset:24576
ds_read_b128 v[84:87], v10 offset:49152
v_mfma_f32_32x32x16_bf16 v[64:79], v[124:127], v[120:123], v[64:79]
ds_read_b128 v[88:91], v18 offset:25600
ds_read_b128 v[92:95], v18 offset:26624
v_mfma_f32_32x32x16_bf16 v[32:47], v[128:131], v[136:139], v[32:47]
ds_read_b128 v[96:99], v18 offset:27648
ds_read_b128 v[100:103], v11 offset:49152
v_mfma_f32_32x32x16_bf16 v[48:63], v[132:135], v[136:139], v[48:63]
ds_read_b128 v[104:107], v18 offset:28672
v_mfma_f32_32x32x16_bf16 v[64:79], v[140:143], v[136:139], v[64:79]
ds_read_b128 v[108:111], v18 offset:29696
s_waitcnt lgkmcnt(6)
v_mfma_f32_32x32x16_bf16 v[32:47], v[80:83], v[84:87], v[32:47]
ds_read_b128 v[112:115], v18 offset:30720
ds_read_b128 v[116:119], v12 offset:49152
s_waitcnt lgkmcnt(7)
v_mfma_f32_32x32x16_bf16 v[48:63], v[88:91], v[84:87], v[48:63]
ds_read_b128 v[120:123], v18 offset:31744
s_waitcnt lgkmcnt(7)
v_mfma_f32_32x32x16_bf16 v[64:79], v[92:95], v[84:87], v[64:79]
ds_read_b128 v[124:127], v18 offset:32768
s_waitcnt lgkmcnt(6)
v_mfma_f32_32x32x16_bf16 v[32:47], v[96:99], v[100:103], v[32:47]
ds_read_b128 v[128:131], v18 offset:33792
ds_read_b128 v[132:135], v13 offset:49152
s_waitcnt lgkmcnt(7)
v_mfma_f32_32x32x16_bf16 v[48:63], v[104:107], v[100:103], v[48:63]
ds_read_b128 v[136:139], v18 offset:34816
s_waitcnt lgkmcnt(7)
v_mfma_f32_32x32x16_bf16 v[64:79], v[108:111], v[100:103], v[64:79]
ds_read_b128 v[140:143], v18 offset:35840
s_waitcnt lgkmcnt(6)
v_mfma_f32_32x32x16_bf16 v[32:47], v[112:115], v[116:119], v[32:47]
s_waitcnt lgkmcnt(5)
v_mfma_f32_32x32x16_bf16 v[48:63], v[120:123], v[116:119], v[48:63]
s_waitcnt lgkmcnt(0)
s_barrier
ds_read_b128 v[80:83], v18 offset:36864
ds_read_b128 v[88:91], v14 offset:0
v_mfma_f32_32x32x16_bf16 v[64:79], v[124:127], v[116:119], v[64:79]
ds_read_b128 v[84:87], v18 offset:37888
ds_read_b128 v[92:95], v18 offset:38912
v_mfma_f32_32x32x16_bf16 v[32:47], v[128:131], v[132:135], v[32:47]
ds_read_b128 v[96:99], v18 offset:39936
ds_read_b128 v[104:107], v15 offset:0
v_mfma_f32_32x32x16_bf16 v[48:63], v[136:139], v[132:135], v[48:63]
ds_read_b128 v[100:103], v18 offset:40960
v_mfma_f32_32x32x16_bf16 v[64:79], v[140:143], v[132:135], v[64:79]
ds_read_b128 v[108:111], v18 offset:41984
s_waitcnt lgkmcnt(6)
v_mfma_f32_32x32x16_bf16 v[32:47], v[80:83], v[88:91], v[32:47]
ds_read_b128 v[112:115], v18 offset:43008
ds_read_b128 v[120:123], v16 offset:0
s_waitcnt lgkmcnt(7)
v_mfma_f32_32x32x16_bf16 v[48:63], v[84:87], v[88:91], v[48:63]
ds_read_b128 v[116:119], v18 offset:44032
s_waitcnt lgkmcnt(7)
v_mfma_f32_32x32x16_bf16 v[64:79], v[92:95], v[88:91], v[64:79]
ds_read_b128 v[124:127], v18 offset:45056
s_waitcnt lgkmcnt(6)
v_mfma_f32_32x32x16_bf16 v[32:47], v[96:99], v[104:107], v[32:47]
ds_read_b128 v[128:131], v18 offset:46080
ds_read_b128 v[136:139], v17 offset:0
s_waitcnt lgkmcnt(7)
v_mfma_f32_32x32x16_bf16 v[48:63], v[100:103], v[104:107], v[48:63]
ds_read_b128 v[132:135], v18 offset:47104
s_waitcnt lgkmcnt(7)
v_mfma_f32_32x32x16_bf16 v[64:79], v[108:111], v[104:107], v[64:79]
ds_read_b128 v[140:143], v18 offset:48128
s_waitcnt lgkmcnt(6)
v_mfma_f32_32x32x16_bf16 v[32:47], v[112:115], v[120:123], v[32:47]
s_waitcnt lgkmcnt(5)
v_mfma_f32_32x32x16_bf16 v[48:63], v[116:119], v[120:123], v[48:63]
s_waitcnt lgkmcnt(0)
s_barrier
ds_read_b128 v[80:83], v18 offset:0
ds_read_b128 v[84:87], v14 offset:16384
v_mfma_f32_32x32x16_bf16 v[64:79], v[124:127], v[120:123], v[64:79]
ds_read_b128 v[88:91], v18 offset:1024
ds_read_b128 v[92:95], v18 offset:2048
v_mfma_f32_32x32x16_bf16 v[32:47], v[128:131], v[136:139], v[32:47]
ds_read_b128 v[96:99], v18 offset:3072
ds_read_b128 v[100:103], v15 offset:16384
v_mfma_f32_32x32x16_bf16 v[48:63], v[132:135], v[136:139], v[48:63]
ds_read_b128 v[104:107], v18 offset:4096
v_mfma_f32_32x32x16_bf16 v[64:79], v[140:143], v[136:139], v[64:79]
ds_read_b128 v[108:111], v18 offset:5120
s_waitcnt lgkmcnt(6)
v_mfma_f32_32x32x16_bf16 v[32:47], v[80:83], v[84:87], v[32:47]
ds_read_b128 v[112:115], v18 offset:6144
ds_read_b128 v[116:119], v16 offset:16384
s_waitcnt lgkmcnt(7)
v_mfma_f32_32x32x16_bf16 v[48:63], v[88:91], v[84:87], v[48:63]
ds_read_b128 v[120:123], v18 offset:7168
s_waitcnt lgkmcnt(7)
v_mfma_f32_32x32x16_bf16 v[64:79], v[92:95], v[84:87], v[64:79]
ds_read_b128 v[124:127], v18 offset:8192
s_waitcnt lgkmcnt(6)
v_mfma_f32_32x32x16_bf16 v[32:47], v[96:99], v[100:103], v[32:47]
ds_read_b128 v[128:131], v18 offset:9216
ds_read_b128 v[132:135], v17 offset:16384
s_waitcnt lgkmcnt(7)
v_mfma_f32_32x32x16_bf16 v[48:63], v[104:107], v[100:103], v[48:63]
ds_read_b128 v[136:139], v18 offset:10240
s_waitcnt lgkmcnt(7)
v_mfma_f32_32x32x16_bf16 v[64:79], v[108:111], v[100:103], v[64:79]
ds_read_b128 v[140:143], v18 offset:11264
s_waitcnt lgkmcnt(6)
v_mfma_f32_32x32x16_bf16 v[32:47], v[112:115], v[116:119], v[32:47]
s_waitcnt lgkmcnt(5)
v_mfma_f32_32x32x16_bf16 v[48:63], v[120:123], v[116:119], v[48:63]
s_waitcnt lgkmcnt(0)
s_barrier
ds_read_b128 v[80:83], v18 offset:12288
ds_read_b128 v[88:91], v14 offset:32768
v_mfma_f32_32x32x16_bf16 v[64:79], v[124:127], v[116:119], v[64:79]
ds_read_b128 v[84:87], v18 offset:13312
ds_read_b128 v[92:95], v18 offset:14336
v_mfma_f32_32x32x16_bf16 v[32:47], v[128:131], v[132:135], v[32:47]
ds_read_b128 v[96:99], v18 offset:15360
ds_read_b128 v[104:107], v15 offset:32768
v_mfma_f32_32x32x16_bf16 v[48:63], v[136:139], v[132:135], v[48:63]
ds_read_b128 v[100:103], v18 offset:16384
s_cmp_lg_u32 s45, 0
s_cbranch_scc1 Lnz_64
buffer_load_dwordx4 v[144:147], v19, s[16:19], s53 offen offset:0 sc1
Lnz_64:
v_mfma_f32_32x32x16_bf16 v[64:79], v[140:143], v[132:135], v[64:79]
ds_read_b128 v[108:111], v18 offset:17408
s_cmp_lg_u32 s45, 0
s_cbranch_scc1 Lnz_65
buffer_load_dwordx4 v[148:151], v19, s[16:19], s53 offen offset:1024 sc1
Lnz_65:
s_waitcnt lgkmcnt(6)
v_mfma_f32_32x32x16_bf16 v[32:47], v[80:83], v[88:91], v[32:47]
ds_read_b128 v[112:115], v18 offset:18432
ds_read_b128 v[120:123], v16 offset:32768
s_waitcnt lgkmcnt(7)
v_mfma_f32_32x32x16_bf16 v[48:63], v[84:87], v[88:91], v[48:63]
ds_read_b128 v[116:119], v18 offset:19456
s_cmp_gt_u32 s58, 2
s_cselect_b32 s53, s53, s60
s_cmp_lg_u32 s45, 0
s_cbranch_scc1 Lnz_66
buffer_load_dwordx4 v[152:155], v19, s[16:19], s53 offen offset:2048 sc1
Lnz_66:
s_waitcnt lgkmcnt(7)
v_mfma_f32_32x32x16_bf16 v[64:79], v[92:95], v[88:91], v[64:79]
ds_read_b128 v[124:127], v18 offset:20480
s_cmp_gt_u32 s58, 3
s_cselect_b32 s53, s53, s60
s_cmp_lg_u32 s45, 0
s_cbranch_scc1 Lnz_67
buffer_load_dwordx4 v[156:159], v19, s[16:19], s53 offen offset:3072 sc1
Lnz_67:
s_waitcnt lgkmcnt(6)
v_mfma_f32_32x32x16_bf16 v[32:47], v[96:99], v[104:107], v[32:47]
ds_read_b128 v[128:131], v18 offset:21504
ds_read_b128 v[136:139], v17 offset:32768
s_waitcnt lgkmcnt(7)
v_mfma_f32_32x32x16_bf16 v[48:63], v[100:103], v[104:107], v[48:63]
ds_read_b128 v[132:135], v18 offset:22528
s_add_u32 s53, s53, 4096
s_cmp_gt_u32 s58, 4
s_cselect_b32 s53, s53, s60
s_cmp_lg_u32 s45, 0
s_cbranch_scc1 Lnz_68
buffer_load_dwordx4 v[160:163], v19, s[16:19], s53 offen offset:0 sc1
Lnz_68:
s_waitcnt lgkmcnt(7)
v_mfma_f32_32x32x16_bf16 v[64:79], v[108:111], v[104:107], v[64:79]
ds_read_b128 v[140:143], v18 offset:23552
s_cmp_gt_u32 s58, 5
s_cselect_b32 s53, s53, s60
s_cmp_lg_u32 s45, 0
s_cbranch_scc1 Lnz_69
buffer_load_dwordx4 v[164:167], v19, s[16:19], s53 offen offset:1024 sc1
Lnz_69:
s_waitcnt lgkmcnt(6)
v_mfma_f32_32x32x16_bf16 v[32:47], v[112:115], v[120:123], v[32:47]
s_waitcnt lgkmcnt(5)
v_mfma_f32_32x32x16_bf16 v[48:63], v[116:119], v[120:123], v[48:63]
s_waitcnt lgkmcnt(0)
s_barrier
ds_read_b128 v[80:83], v18 offset:24576
ds_read_b128 v[84:87], v10 offset:0
v_mfma_f32_32x32x16_bf16 v[64:79], v[124:127], v[120:123], v[64:79]
ds_read_b128 v[88:91], v18 offset:25600
ds_read_b128 v[92:95], v18 offset:26624
v_mfma_f32_32x32x16_bf16 v[32:47], v[128:131], v[136:139], v[32:47]
ds_read_b128 v[96:99], v18 offset:27648
ds_read_b128 v[100:103], v11 offset:0
v_mfma_f32_32x32x16_bf16 v[48:63], v[132:135], v[136:139], v[48:63]
ds_read_b128 v[104:107], v18 offset:28672
v_mfma_f32_32x32x16_bf16 v[64:79], v[140:143], v[136:139], v[64:79]
ds_read_b128 v[108:111], v18 offset:29696
s_waitcnt lgkmcnt(6)
v_mfma_f32_32x32x16_bf16 v[32:47], v[80:83], v[84:87], v[32:47]
ds_read_b128 v[112:115], v18 offset:30720
ds_read_b128 v[116:119], v12 offset:0
s_waitcnt lgkmcnt(7)
v_mfma_f32_32x32x16_bf16 v[48:63], v[88:91], v[84:87], v[48:63]
ds_read_b128 v[120:123], v18 offset:31744
s_waitcnt lgkmcnt(7)
v_mfma_f32_32x32x16_bf16 v[64:79], v[92:95], v[84:87], v[64:79]
ds_read_b128 v[124:127], v18 offset:32768
s_waitcnt lgkmcnt(6)
v_mfma_f32_32x32x16_bf16 v[32:47], v[96:99], v[100:103], v[32:47]
ds_read_b128 v[128:131], v18 offset:33792
ds_read_b128 v[132:135], v13 offset:0
s_waitcnt lgkmcnt(7)
v_mfma_f32_32x32x16_bf16 v[48:63], v[104:107], v[100:103], v[48:63]
ds_read_b128 v[136:139], v18 offset:34816
s_waitcnt lgkmcnt(7)
v_mfma_f32_32x32x16_bf16 v[64:79], v[108:111], v[100:103], v[64:79]
ds_read_b128 v[140:143], v18 offset:35840
s_waitcnt lgkmcnt(6)
v_mfma_f32_32x32x16_bf16 v[32:47], v[112:115], v[116:119], v[32:47]
s_waitcnt lgkmcnt(5)
v_mfma_f32_32x32x16_bf16 v[48:63], v[120:123], v[116:119], v[48:63]
ds_read_b128 v[80:83], v18 offset:36864
ds_read_b128 v[88:91], v10 offset:16384
s_waitcnt lgkmcnt(6)
v_mfma_f32_32x32x16_bf16 v[64:79], v[124:127], v[116:119], v[64:79]
ds_read_b128 v[84:87], v18 offset:37888
ds_read_b128 v[92:95], v18 offset:38912
s_waitcnt lgkmcnt(6)
v_mfma_f32_32x32x16_bf16 v[32:47], v[128:131], v[132:135], v[32:47]
ds_read_b128 v[96:99], v18 offset:39936
ds_read_b128 v[104:107], v11 offset:16384
s_waitcnt lgkmcnt(7)
v_mfma_f32_32x32x16_bf16 v[48:63], v[136:139], v[132:135], v[48:63]
ds_read_b128 v[100:103], v18 offset:40960
s_waitcnt lgkmcnt(7)
v_mfma_f32_32x32x16_bf16 v[64:79], v[140:143], v[132:135], v[64:79]
ds_read_b128 v[108:111], v18 offset:41984
s_waitcnt lgkmcnt(6)
v_mfma_f32_32x32x16_bf16 v[32:47], v[80:83], v[88:91], v[32:47]
ds_read_b128 v[112:115], v18 offset:43008
ds_read_b128 v[120:123], v12 offset:16384
s_waitcnt lgkmcnt(7)
v_mfma_f32_32x32x16_bf16 v[48:63], v[84:87], v[88:91], v[48:63]
ds_read_b128 v[116:119], v18 offset:44032
s_waitcnt lgkmcnt(7)
v_mfma_f32_32x32x16_bf16 v[64:79], v[92:95], v[88:91], v[64:79]
ds_read_b128 v[124:127], v18 offset:45056
s_waitcnt lgkmcnt(6)
v_mfma_f32_32x32x16_bf16 v[32:47], v[96:99], v[104:107], v[32:47]
ds_read_b128 v[128:131], v18 offset:46080
ds_read_b128 v[136:139], v13 offset:16384
s_waitcnt lgkmcnt(7)
v_mfma_f32_32x32x16_bf16 v[48:63], v[100:103], v[104:107], v[48:63]
ds_read_b128 v[132:135], v18 offset:47104
s_waitcnt lgkmcnt(7)
v_mfma_f32_32x32x16_bf16 v[64:79], v[108:111], v[104:107], v[64:79]
ds_read_b128 v[140:143], v18 offset:48128
s_waitcnt lgkmcnt(6)
v_mfma_f32_32x32x16_bf16 v[32:47], v[112:115], v[120:123], v[32:47]
s_waitcnt lgkmcnt(5)
v_mfma_f32_32x32x16_bf16 v[48:63], v[116:119], v[120:123], v[48:63]
s_waitcnt lgkmcnt(4)
v_mfma_f32_32x32x16_bf16 v[64:79], v[124:127], v[120:123], v[64:79]
s_waitcnt lgkmcnt(2)
v_mfma_f32_32x32x16_bf16 v[32:47], v[128:131], v[136:139], v[32:47]
s_waitcnt lgkmcnt(1)
v_mfma_f32_32x32x16_bf16 v[48:63], v[132:135], v[136:139], v[48:63]
s_waitcnt lgkmcnt(0)
v_mfma_f32_32x32x16_bf16 v[64:79], v[140:143], v[136:139], v[64:79]
Lbj_63:
s_lshl_b32 s61, s4, 2
s_add_u32 s61, s61, 135168
v_mov_b32 v22, s61
v_mov_b32 v23, s52
ds_write_b32 v22, v23
s_waitcnt vmcnt(0)
v_mov_b32 v23, 0xffff0000
v_lshlrev_b32 v80, 16, v144
v_and_b32 v81, v23, v144
v_lshlrev_b32 v82, 16, v145
v_and_b32 v83, v23, v145
v_lshlrev_b32 v84, 16, v146
v_and_b32 v85, v23, v146
v_lshlrev_b32 v86, 16, v147
v_and_b32_e64 v87, v23, v147
s_cmp_gt_u32 s58, 0
s_cselect_b32 s61, s54, s60
v_pk_mul_f32 v[32:33], v[32:33], v[80:81]
v_pk_mul_f32 v[34:35], v[34:35], v[82:83]
v_pk_mul_f32 v[36:37], v[36:37], v[84:85]
v_pk_mul_f32 v[38:39], v[38:39], v[86:87]
v_cvt_pk_bf16_f32 v32, v32, v33
v_cvt_pk_bf16_f32 v33, v34, v35
v_cvt_pk_bf16_f32 v34, v36, v37
v_cvt_pk_bf16_f32 v35, v38, v39
buffer_store_dwordx4 v[32:35], v19, s[16:19], s61 offen offset:0 sc1
v_lshlrev_b32 v88, 16, v148
v_and_b32 v89, v23, v148
v_lshlrev_b32 v90, 16, v149
v_and_b32 v91, v23, v149
v_lshlrev_b32 v92, 16, v150
v_and_b32 v93, v23, v150
v_lshlrev_b32 v94, 16, v151
v_and_b32 v95, v23, v151
s_cmp_gt_u32 s58, 1
s_cselect_b32 s61, s54, s60
v_pk_mul_f32 v[40:41], v[40:41], v[88:89]
v_pk_mul_f32 v[42:43], v[42:43], v[90:91]
v_pk_mul_f32 v[44:45], v[44:45], v[92:93]
v_pk_mul_f32 v[46:47], v[46:47], v[94:95]
v_cvt_pk_bf16_f32 v40, v40, v41
v_cvt_pk_bf16_f32 v41, v42, v43
v_cvt_pk_bf16_f32 v42, v44, v45
v_cvt_pk_bf16_f32 v43, v46, v47
buffer_store_dwordx4 v[40:43], v19, s[16:19], s61 offen offset:1024 sc1
v_lshlrev_b32 v80, 16, v152
v_and_b32 v81, v23, v152
v_lshlrev_b32 v82, 16, v153
v_and_b32 v83, v23, v153
v_lshlrev_b32 v84, 16, v154
v_and_b32 v85, v23, v154
v_lshlrev_b32 v86, 16, v155
v_and_b32 v87, v23, v155
s_cmp_gt_u32 s58, 2
s_cselect_b32 s61, s54, s60
v_pk_mul_f32 v[48:49], v[48:49], v[80:81]
v_pk_mul_f32 v[50:51], v[50:51], v[82:83]
v_pk_mul_f32 v[52:53], v[52:53], v[84:85]
v_pk_mul_f32 v[54:55], v[54:55], v[86:87]
v_cvt_pk_bf16_f32 v48, v48, v49
v_cvt_pk_bf16_f32 v49, v50, v51
v_cvt_pk_bf16_f32 v50, v52, v53
v_cvt_pk_bf16_f32 v51, v54, v55
buffer_store_dwordx4 v[48:51], v19, s[16:19], s61 offen offset:2048 sc1
v_lshlrev_b32 v88, 16, v156
v_and_b32 v89, v23, v156
v_lshlrev_b32 v90, 16, v157
v_and_b32 v91, v23, v157
v_lshlrev_b32 v92, 16, v158
v_and_b32 v93, v23, v158
v_lshlrev_b32 v94, 16, v159
v_and_b32 v95, v23, v159
s_cmp_gt_u32 s58, 3
s_cselect_b32 s61, s54, s60
v_pk_mul_f32 v[56:57], v[56:57], v[88:89]
v_pk_mul_f32 v[58:59], v[58:59], v[90:91]
v_pk_mul_f32 v[60:61], v[60:61], v[92:93]
v_pk_mul_f32 v[62:63], v[62:63], v[94:95]
v_cvt_pk_bf16_f32 v56, v56, v57
v_cvt_pk_bf16_f32 v57, v58, v59
v_cvt_pk_bf16_f32 v58, v60, v61
v_cvt_pk_bf16_f32 v59, v62, v63
buffer_store_dwordx4 v[56:59], v19, s[16:19], s61 offen offset:3072 sc1
v_lshlrev_b32 v80, 16, v160
v_and_b32 v81, v23, v160
v_lshlrev_b32 v82, 16, v161
v_and_b32 v83, v23, v161
v_lshlrev_b32 v84, 16, v162
v_and_b32 v85, v23, v162
v_lshlrev_b32 v86, 16, v163
v_and_b32 v87, v23, v163
s_cmp_gt_u32 s58, 4
s_cselect_b32 s61, s59, s60
v_pk_mul_f32 v[64:65], v[64:65], v[80:81]
v_pk_mul_f32 v[66:67], v[66:67], v[82:83]
v_pk_mul_f32 v[68:69], v[68:69], v[84:85]
v_pk_mul_f32 v[70:71], v[70:71], v[86:87]
v_cvt_pk_bf16_f32 v64, v64, v65
v_cvt_pk_bf16_f32 v65, v66, v67
v_cvt_pk_bf16_f32 v66, v68, v69
v_cvt_pk_bf16_f32 v67, v70, v71
buffer_store_dwordx4 v[64:67], v19, s[16:19], s61 offen offset:0 sc1
v_lshlrev_b32 v88, 16, v164
v_and_b32 v89, v23, v164
v_lshlrev_b32 v90, 16, v165
v_and_b32 v91, v23, v165
v_lshlrev_b32 v92, 16, v166
v_and_b32 v93, v23, v166
v_lshlrev_b32 v94, 16, v167
v_and_b32 v95, v23, v167
s_cmp_gt_u32 s58, 5
s_cselect_b32 s61, s59, s60
v_pk_mul_f32 v[72:73], v[72:73], v[88:89]
v_pk_mul_f32 v[74:75], v[74:75], v[90:91]
v_pk_mul_f32 v[76:77], v[76:77], v[92:93]
v_pk_mul_f32 v[78:79], v[78:79], v[94:95]
v_cvt_pk_bf16_f32 v72, v72, v73
v_cvt_pk_bf16_f32 v73, v74, v75
v_cvt_pk_bf16_f32 v74, v76, v77
v_cvt_pk_bf16_f32 v75, v78, v79
buffer_store_dwordx4 v[72:75], v19, s[16:19], s61 offen offset:1024 sc1
s_and_b32 s53, s4, 1
s_lshr_b32 s54, s4, 1
v_lshrrev_b32_e64 v3, 5, v1
v_bfe_u32 v30, v1, 2, 2
v_lshl_add_u32 v3, v3, 2, v30
v_lshlrev_b32 v3, 7, v3
v_and_b32 v30, 2, v30
v_bfe_u32 v31, v1, 4, 1
v_or_b32_e64 v30, v30, v31
v_lshl_add_u32 v3, v30, 5, v3
v_and_b32_e64 v30, 3, v1
v_lshl_add_u32 v26, v30, 3, v3
v_xor_b32 v27, 64, v26
s_cmp_eq_u32 s54, 0
s_mov_b32 s61, 16384
s_cselect_b32 s61, 98304, s61
s_mov_b32 s62, 114688
s_cselect_b32 s62, 0, s62
v_add_u32 v4, s61, v26
v_add_u32 v5, s61, v27
v_add_u32 v6, s62, v26
v_add_u32 v7, s62, v27
s_barrier
buffer_load_dwordx4 v[168:171], v19, s[16:19], s56 offen offset:0 sc1
buffer_load_dwordx4 v[172:175], v19, s[16:19], s56 offen offset:1024 sc1
buffer_load_dwordx4 v[176:179], v19, s[16:19], s56 offen offset:2048 sc1
buffer_load_dwordx4 v[180:183], v19, s[16:19], s56 offen offset:3072 sc1
s_add_u32 s56, s56, 4096
buffer_load_dwordx4 v[184:187], v19, s[16:19], s56 offen offset:0 sc1
buffer_load_dwordx4 v[188:191], v19, s[16:19], s56 offen offset:1024 sc1
buffer_load_dwordx4 v[192:195], v19, s[16:19], s56 offen offset:2048 sc1
buffer_load_dwordx4 v[196:199], v19, s[16:19], s56 offen offset:3072 sc1
s_lshl_b32 s61, s57, 1
s_add_u32 s61, s61, s48
s_lshl_b32 s61, s61, 3
s_add_u32 s61, s61, s50
s_lshl_b32 s61, s61, 7
s_add_u32 s61, s61, 22118400
v_mov_b32 v30, s52
v_mov_b32_e64 v31, 0
s_waitcnt vmcnt(8)
s_mov_b64 exec, 1
buffer_store_dword v30, v31, s[16:19], s61 offen sc1
s_mov_b64 exec, -1
s_barrier
s_add_u32 s56, s56, 4096
buffer_load_dwordx4 v[200:203], v19, s[16:19], s56 offen offset:0 sc1
buffer_load_dwordx4 v[204:207], v19, s[16:19], s56 offen offset:1024 sc1
buffer_load_dwordx4 v[208:211], v19, s[16:19], s56 offen offset:2048 sc1
buffer_load_dwordx4 v[212:215], v19, s[16:19], s56 offen offset:3072 sc1
s_add_u32 s56, s56, 4096
buffer_load_dwordx4 v[216:219], v19, s[16:19], s56 offen offset:0 sc1
buffer_load_dwordx4 v[220:223], v19, s[16:19], s56 offen offset:1024 sc1
buffer_load_dwordx4 v[224:227], v19, s[16:19], s56 offen offset:2048 sc1
buffer_load_dwordx4 v[228:231], v19, s[16:19], s56 offen offset:3072 sc1
ds_read_b64_tr_b16 v[80:81], v4 offset:0
ds_read_b64_tr_b16 v[82:83], v4 offset:1024
ds_read_b64_tr_b16 v[84:85], v5 offset:0
ds_read_b64_tr_b16 v[86:87], v5 offset:1024
ds_read_b64_tr_b16 v[88:89], v4 offset:2048
ds_read_b64_tr_b16 v[90:91], v4 offset:3072
ds_read_b64_tr_b16 v[92:93], v5 offset:2048
ds_read_b64_tr_b16 v[94:95], v5 offset:3072
ds_read_b64_tr_b16 v[96:97], v4 offset:4096
ds_read_b64_tr_b16 v[98:99], v4 offset:5120
s_waitcnt lgkmcnt(8)
s_waitcnt vmcnt(16)
v_mfma_f32_32x32x16_bf16 v[32:47], v[80:83], v[168:171], 0
ds_read_b64_tr_b16 v[100:101], v5 offset:4096
ds_read_b64_tr_b16 v[102:103], v5 offset:5120
s_waitcnt lgkmcnt(8)
v_mfma_f32_32x32x16_bf16 v[48:63], v[84:87], v[168:171], 0
ds_read_b64_tr_b16 v[104:105], v4 offset:6144
ds_read_b64_tr_b16 v[106:107], v4 offset:7168
s_waitcnt lgkmcnt(8)
s_waitcnt vmcnt(15)
v_mfma_f32_32x32x16_bf16 v[32:47], v[88:91], v[172:175], v[32:47]
ds_read_b64_tr_b16 v[108:109], v5 offset:6144
ds_read_b64_tr_b16 v[110:111], v5 offset:7168
s_waitcnt lgkmcnt(8)
v_mfma_f32_32x32x16_bf16 v[48:63], v[92:95], v[172:175], v[48:63]
ds_read_b64_tr_b16 v[80:81], v4 offset:8192
ds_read_b64_tr_b16 v[82:83], v4 offset:9216
s_waitcnt lgkmcnt(8)
s_waitcnt vmcnt(14)
v_mfma_f32_32x32x16_bf16 v[32:47], v[96:99], v[176:179], v[32:47]
ds_read_b64_tr_b16 v[84:85], v5 offset:8192
ds_read_b64_tr_b16 v[86:87], v5 offset:9216
s_waitcnt lgkmcnt(8)
v_mfma_f32_32x32x16_bf16 v[48:63], v[100:103], v[176:179], v[48:63]
ds_read_b64_tr_b16 v[88:89], v4 offset:10240
ds_read_b64_tr_b16 v[90:91], v4 offset:11264
s_waitcnt lgkmcnt(8)
s_waitcnt vmcnt(13)
v_mfma_f32_32x32x16_bf16 v[32:47], v[104:107], v[180:183], v[32:47]
ds_read_b64_tr_b16 v[92:93], v5 offset:10240
ds_read_b64_tr_b16 v[94:95], v5 offset:11264
s_waitcnt lgkmcnt(8)
v_mfma_f32_32x32x16_bf16 v[48:63], v[108:111], v[180:183], v[48:63]
ds_read_b64_tr_b16 v[96:97], v4 offset:12288
ds_read_b64_tr_b16 v[98:99], v4 offset:13312
s_waitcnt lgkmcnt(8)
s_waitcnt vmcnt(12)
v_mfma_f32_32x32x16_bf16 v[32:47], v[80:83], v[184:187], v[32:47]
ds_read_b64_tr_b16 v[100:101], v5 offset:12288
ds_read_b64_tr_b16 v[102:103], v5 offset:13312
s_waitcnt lgkmcnt(8)
v_mfma_f32_32x32x16_bf16 v[48:63], v[84:87], v[184:187], v[48:63]
ds_read_b64_tr_b16 v[104:105], v4 offset:14336
ds_read_b64_tr_b16 v[106:107], v4 offset:15360
s_waitcnt lgkmcnt(8)
s_waitcnt vmcnt(11)
v_mfma_f32_32x32x16_bf16 v[32:47], v[88:91], v[188:191], v[32:47]
ds_read_b64_tr_b16 v[108:109], v5 offset:14336
ds_read_b64_tr_b16 v[110:111], v5 offset:15360
s_waitcnt lgkmcnt(8)
v_mfma_f32_32x32x16_bf16 v[48:63], v[92:95], v[188:191], v[48:63]
ds_read_b64_tr_b16 v[80:81], v6 offset:0
ds_read_b64_tr_b16 v[82:83], v6 offset:1024
s_waitcnt lgkmcnt(8)
s_waitcnt vmcnt(10)
v_mfma_f32_32x32x16_bf16 v[32:47], v[96:99], v[192:195], v[32:47]
ds_read_b64_tr_b16 v[84:85], v7 offset:0
ds_read_b64_tr_b16 v[86:87], v7 offset:1024
s_waitcnt lgkmcnt(8)
v_mfma_f32_32x32x16_bf16 v[48:63], v[100:103], v[192:195], v[48:63]
ds_read_b64_tr_b16 v[88:89], v6 offset:2048
ds_read_b64_tr_b16 v[90:91], v6 offset:3072
s_waitcnt lgkmcnt(8)
s_waitcnt vmcnt(9)
v_mfma_f32_32x32x16_bf16 v[32:47], v[104:107], v[196:199], v[32:47]
ds_read_b64_tr_b16 v[92:93], v7 offset:2048
ds_read_b64_tr_b16 v[94:95], v7 offset:3072
s_waitcnt lgkmcnt(8)
v_mfma_f32_32x32x16_bf16 v[48:63], v[108:111], v[196:199], v[48:63]
ds_read_b64_tr_b16 v[96:97], v6 offset:4096
ds_read_b64_tr_b16 v[98:99], v6 offset:5120
s_waitcnt lgkmcnt(8)
s_waitcnt vmcnt(7)
v_mfma_f32_32x32x16_bf16 v[32:47], v[80:83], v[200:203], v[32:47]
ds_read_b64_tr_b16 v[100:101], v7 offset:4096
ds_read_b64_tr_b16 v[102:103], v7 offset:5120
s_waitcnt lgkmcnt(8)
v_mfma_f32_32x32x16_bf16 v[48:63], v[84:87], v[200:203], v[48:63]
ds_read_b64_tr_b16 v[104:105], v6 offset:6144
ds_read_b64_tr_b16 v[106:107], v6 offset:7168
s_waitcnt lgkmcnt(8)
s_waitcnt vmcnt(6)
v_mfma_f32_32x32x16_bf16 v[32:47], v[88:91], v[204:207], v[32:47]
ds_read_b64_tr_b16 v[108:109], v7 offset:6144
ds_read_b64_tr_b16 v[110:111], v7 offset:7168
s_waitcnt lgkmcnt(8)
v_mfma_f32_32x32x16_bf16 v[48:63], v[92:95], v[204:207], v[48:63]
ds_read_b64_tr_b16 v[80:81], v6 offset:8192
ds_read_b64_tr_b16 v[82:83], v6 offset:9216
s_waitcnt lgkmcnt(8)
s_waitcnt vmcnt(5)
v_mfma_f32_32x32x16_bf16 v[32:47], v[96:99], v[208:211], v[32:47]
ds_read_b64_tr_b16 v[84:85], v7 offset:8192
ds_read_b64_tr_b16 v[86:87], v7 offset:9216
s_waitcnt lgkmcnt(8)
v_mfma_f32_32x32x16_bf16 v[48:63], v[100:103], v[208:211], v[48:63]
ds_read_b64_tr_b16 v[88:89], v6 offset:10240
ds_read_b64_tr_b16 v[90:91], v6 offset:11264
s_waitcnt lgkmcnt(8)
s_waitcnt vmcnt(4)
v_mfma_f32_32x32x16_bf16 v[32:47], v[104:107], v[212:215], v[32:47]
ds_read_b64_tr_b16 v[92:93], v7 offset:10240
ds_read_b64_tr_b16 v[94:95], v7 offset:11264
s_waitcnt lgkmcnt(8)
v_mfma_f32_32x32x16_bf16 v[48:63], v[108:111], v[212:215], v[48:63]
ds_read_b64_tr_b16 v[96:97], v6 offset:12288
ds_read_b64_tr_b16 v[98:99], v6 offset:13312
s_waitcnt lgkmcnt(8)
s_waitcnt vmcnt(3)
v_mfma_f32_32x32x16_bf16 v[32:47], v[80:83], v[216:219], v[32:47]
ds_read_b64_tr_b16 v[100:101], v7 offset:12288
ds_read_b64_tr_b16 v[102:103], v7 offset:13312
s_waitcnt lgkmcnt(8)
v_mfma_f32_32x32x16_bf16 v[48:63], v[84:87], v[216:219], v[48:63]
ds_read_b64_tr_b16 v[104:105], v6 offset:14336
ds_read_b64_tr_b16 v[106:107], v6 offset:15360
s_waitcnt lgkmcnt(8)
s_waitcnt vmcnt(2)
v_mfma_f32_32x32x16_bf16 v[32:47], v[88:91], v[220:223], v[32:47]
ds_read_b64_tr_b16 v[108:109], v7 offset:14336
ds_read_b64_tr_b16 v[110:111], v7 offset:15360
s_waitcnt lgkmcnt(8)
v_mfma_f32_32x32x16_bf16 v[48:63], v[92:95], v[220:223], v[48:63]
s_waitcnt lgkmcnt(6)
s_waitcnt vmcnt(1)
v_mfma_f32_32x32x16_bf16 v[32:47], v[96:99], v[224:227], v[32:47]
s_waitcnt lgkmcnt(4)
v_mfma_f32_32x32x16_bf16 v[48:63], v[100:103], v[224:227], v[48:63]
s_waitcnt lgkmcnt(2)
s_waitcnt vmcnt(0)
v_mfma_f32_32x32x16_bf16 v[32:47], v[104:107], v[228:231], v[32:47]
s_waitcnt lgkmcnt(0)
v_mfma_f32_32x32x16_bf16 v[48:63], v[108:111], v[228:231], v[48:63]
v_add_u32 v252, 0x10000, v26
v_add_u32 v253, 0x10000, v27
v_add_u32 v254, 0x20000, v26
v_add_u32 v255, 0x20000, v27
s_lshl_b32 s55, s49, 1
s_add_u32 s55, s55, s53
s_lshl_b32 s56, s54, 6
s_add_u32 s56, s56, s55
s_mul_i32 s56, s56, 49152
s_add_u32 s56, s56, 8388608
v_lshlrev_b32 v28, 4, v1
v_lshrrev_b32 v3, 3, v1
s_lshl_b32 s61, s3, 3
v_add_u32 v3, s61, v3
v_and_b32_e64 v30, 7, v1
v_mul_u32_u24 v6, 272, v3
v_lshl_add_u32 v6, v30, 5, v6
v_add_u32 v5, 98304, v6
v_and_b32 v31, 15, v3
v_lshlrev_b32 v31, 1, v31
v_bfe_u32 v7, v3, 4, 1
v_add_u32 v31, v31, v7
v_and_b32 v7, 32, v3
v_add_u32 v31, v31, v7
v_lshlrev_b32 v31, 10, v31
v_lshl_add_u32 v7, v30, 4, v31
s_lshl_b32 s47, s49, 9
s_add_u32 s47, s47, s50
s_lshl_b32 s47, s47, 7
buffer_load_dwordx4 v[8:11], v7, s[8:11], s47 offen
v_and_b32 v3, 31, v1
v_mul_u32_u24 v3, 272, v3
v_lshrrev_b32_e64 v30, 5, v1
v_lshl_add_u32 v3, v30, 4, v3
s_mul_i32 s61, s54, 98304
s_mul_i32 s62, s53, 8704
s_add_u32 s61, s61, s62
v_add_u32_e64 v4, s61, v3
s_lshl_b32 s62, s55, 1
s_add_u32 s62, s62, s54
s_lshl_b32 s62, s62, 10
s_add_u32 s62, s62, 22118400
v_and_b32 v31, 7, v1
v_lshlrev_b32 v31, 7, v31
v_mov_b32_e64 v30, 0
v_cmp_ne_u32 vcc, s52, v30
s_cmp_eq_u64 vcc, 0
s_cbranch_scc1 Lok_77
s_mov_b32 s63, 0
Lspin_76:
buffer_load_dword v30, v31, s[16:19], s62 offen sc1
s_waitcnt vmcnt(0)
s_add_u32 s63, s63, 1
s_cmp_gt_u32 s63, 32768
s_cbranch_scc1 Lok_77
v_cmp_ne_u32 vcc, s52, v30
s_cmp_eq_u64 vcc, 0
s_cbranch_scc0 Lspin_76
Lok_77:
v_add_u32 v29, 4096, v28
s_and_b32 s77, s50, 7
s_lshl_b32 s77, s77, 12
s_lshl_b32 s62, s77, 1
s_add_u32 s61, s56, 0
buffer_load_dwordx4 v[80:83], v28, s[16:19], s61 offen offset:0 sc1
buffer_load_dwordx4 v[84:87], v28, s[16:19], s61 offen offset:1024 sc1
buffer_load_dwordx4 v[88:91], v28, s[16:19], s61 offen offset:2048 sc1
buffer_load_dwordx4 v[92:95], v28, s[16:19], s61 offen offset:3072 sc1
buffer_load_dwordx4 v[96:99], v29, s[16:19], s61 offen offset:0 sc1
buffer_load_dwordx4 v[100:103], v29, s[16:19], s61 offen offset:1024 sc1
buffer_load_dwordx4 v[104:107], v29, s[16:19], s61 offen offset:2048 sc1
buffer_load_dwordx4 v[108:111], v29, s[16:19], s61 offen offset:3072 sc1
s_add_u32 s61, s56, 8192
buffer_load_dwordx4 v[112:115], v28, s[16:19], s61 offen offset:0 sc1
buffer_load_dwordx4 v[116:119], v28, s[16:19], s61 offen offset:1024 sc1
buffer_load_dwordx4 v[120:123], v28, s[16:19], s61 offen offset:2048 sc1
buffer_load_dwordx4 v[124:127], v28, s[16:19], s61 offen offset:3072 sc1
s_barrier
ds_read_b64_tr_b16 v[64:65], v26 offset:32768
ds_read_b64_tr_b16 v[66:67], v26 offset:33792
ds_read_b64_tr_b16 v[68:69], v27 offset:32768
ds_read_b64_tr_b16 v[70:71], v27 offset:33792
ds_read_b64_tr_b16 v[72:73], v26 offset:34816
ds_read_b64_tr_b16 v[74:75], v26 offset:35840
ds_read_b64_tr_b16 v[76:77], v27 offset:34816
ds_read_b64_tr_b16 v[78:79], v27 offset:35840
ds_read_b64_tr_b16 v[12:13], v26 offset:36864
ds_read_b64_tr_b16 v[14:15], v26 offset:37888
s_waitcnt lgkmcnt(8)
s_waitcnt vmcnt(11)
v_mfma_f32_32x32x16_bf16 v[32:47], v[64:67], v[80:83], v[32:47]
ds_read_b64_tr_b16 v[16:17], v27 offset:36864
ds_read_b64_tr_b16 v[18:19], v27 offset:37888
s_waitcnt lgkmcnt(8)
buffer_load_dwordx4 v[128:131], v29, s[16:19], s61 offen offset:0 sc1
v_mfma_f32_32x32x16_bf16 v[48:63], v[68:71], v[80:83], v[48:63]
ds_read_b64_tr_b16 v[20:21], v26 offset:38912
ds_read_b64_tr_b16 v[22:23], v26 offset:39936
s_waitcnt lgkmcnt(8)
s_waitcnt vmcnt(11)
v_mfma_f32_32x32x16_bf16 v[32:47], v[72:75], v[84:87], v[32:47]
ds_read_b64_tr_b16 v[64:65], v27 offset:38912
ds_read_b64_tr_b16 v[66:67], v27 offset:39936
s_waitcnt lgkmcnt(8)
buffer_load_dwordx4 v[132:135], v29, s[16:19], s61 offen offset:1024 sc1
v_mfma_f32_32x32x16_bf16 v[48:63], v[76:79], v[84:87], v[48:63]
ds_read_b64_tr_b16 v[68:69], v26 offset:40960
ds_read_b64_tr_b16 v[70:71], v26 offset:41984
s_waitcnt lgkmcnt(8)
s_waitcnt vmcnt(11)
v_mfma_f32_32x32x16_bf16 v[32:47], v[12:15], v[88:91], v[32:47]
ds_read_b64_tr_b16 v[72:73], v27 offset:40960
ds_read_b64_tr_b16 v[74:75], v27 offset:41984
s_waitcnt lgkmcnt(8)
buffer_load_dwordx4 v[136:139], v29, s[16:19], s61 offen offset:2048 sc1
v_mfma_f32_32x32x16_bf16 v[48:63], v[16:19], v[88:91], v[48:63]
ds_read_b64_tr_b16 v[76:77], v26 offset:43008
ds_read_b64_tr_b16 v[78:79], v26 offset:44032
s_waitcnt lgkmcnt(8)
s_waitcnt vmcnt(11)
v_mfma_f32_32x32x16_bf16 v[32:47], v[20:23], v[92:95], v[32:47]
ds_read_b64_tr_b16 v[12:13], v27 offset:43008
ds_read_b64_tr_b16 v[14:15], v27 offset:44032
s_waitcnt lgkmcnt(8)
buffer_load_dwordx4 v[140:143], v29, s[16:19], s61 offen offset:3072 sc1
v_mfma_f32_32x32x16_bf16 v[48:63], v[64:67], v[92:95], v[48:63]
ds_read_b64_tr_b16 v[16:17], v26 offset:45056
ds_read_b64_tr_b16 v[18:19], v26 offset:46080
s_waitcnt lgkmcnt(8)
s_waitcnt vmcnt(11)
v_mfma_f32_32x32x16_bf16 v[32:47], v[68:71], v[96:99], v[32:47]
ds_read_b64_tr_b16 v[20:21], v27 offset:45056
ds_read_b64_tr_b16 v[22:23], v27 offset:46080
s_waitcnt lgkmcnt(8)
s_add_u32 s61, s56, 16384
buffer_load_dwordx4 v[144:147], v28, s[16:19], s61 offen offset:0 sc1
v_mfma_f32_32x32x16_bf16 v[48:63], v[72:75], v[96:99], v[48:63]
ds_read_b64_tr_b16 v[64:65], v26 offset:47104
ds_read_b64_tr_b16 v[66:67], v26 offset:48128
s_waitcnt lgkmcnt(8)
s_waitcnt vmcnt(11)
v_mfma_f32_32x32x16_bf16 v[32:47], v[76:79], v[100:103], v[32:47]
ds_read_b64_tr_b16 v[68:69], v27 offset:47104
ds_read_b64_tr_b16 v[70:71], v27 offset:48128
s_waitcnt lgkmcnt(8)
buffer_load_dwordx4 v[148:151], v28, s[16:19], s61 offen offset:1024 sc1
v_mfma_f32_32x32x16_bf16 v[48:63], v[12:15], v[100:103], v[48:63]
ds_read_b64_tr_b16 v[72:73], v26 offset:49152
ds_read_b64_tr_b16 v[74:75], v26 offset:50176
s_waitcnt lgkmcnt(8)
s_waitcnt vmcnt(11)
v_mfma_f32_32x32x16_bf16 v[32:47], v[16:19], v[104:107], v[32:47]
ds_read_b64_tr_b16 v[76:77], v27 offset:49152
ds_read_b64_tr_b16 v[78:79], v27 offset:50176
s_waitcnt lgkmcnt(8)
buffer_load_dwordx4 v[152:155], v28, s[16:19], s61 offen offset:2048 sc1
v_mfma_f32_32x32x16_bf16 v[48:63], v[20:23], v[104:107], v[48:63]
ds_read_b64_tr_b16 v[12:13], v26 offset:51200
ds_read_b64_tr_b16 v[14:15], v26 offset:52224
s_waitcnt lgkmcnt(8)
s_waitcnt vmcnt(11)
v_mfma_f32_32x32x16_bf16 v[32:47], v[64:67], v[108:111], v[32:47]
ds_read_b64_tr_b16 v[16:17], v27 offset:51200
ds_read_b64_tr_b16 v[18:19], v27 offset:52224
s_waitcnt lgkmcnt(8)
buffer_load_dwordx4 v[156:159], v28, s[16:19], s61 offen offset:3072 sc1
v_mfma_f32_32x32x16_bf16 v[48:63], v[68:71], v[108:111], v[48:63]
ds_read_b64_tr_b16 v[20:21], v26 offset:53248
ds_read_b64_tr_b16 v[22:23], v26 offset:54272
s_waitcnt lgkmcnt(8)
s_waitcnt vmcnt(11)
v_mfma_f32_32x32x16_bf16 v[32:47], v[72:75], v[112:115], v[32:47]
ds_read_b64_tr_b16 v[64:65], v27 offset:53248
ds_read_b64_tr_b16 v[66:67], v27 offset:54272
s_waitcnt lgkmcnt(8)
buffer_load_dwordx4 v[160:163], v29, s[16:19], s61 offen offset:0 sc1
v_mfma_f32_32x32x16_bf16 v[48:63], v[76:79], v[112:115], v[48:63]
ds_read_b64_tr_b16 v[68:69], v26 offset:55296
ds_read_b64_tr_b16 v[70:71], v26 offset:56320
s_waitcnt lgkmcnt(8)
s_waitcnt vmcnt(11)
v_mfma_f32_32x32x16_bf16 v[32:47], v[12:15], v[116:119], v[32:47]
ds_read_b64_tr_b16 v[72:73], v27 offset:55296
ds_read_b64_tr_b16 v[74:75], v27 offset:56320
s_waitcnt lgkmcnt(8)
buffer_load_dwordx4 v[164:167], v29, s[16:19], s61 offen offset:1024 sc1
v_mfma_f32_32x32x16_bf16 v[48:63], v[16:19], v[116:119], v[48:63]
ds_read_b64_tr_b16 v[76:77], v26 offset:57344
ds_read_b64_tr_b16 v[78:79], v26 offset:58368
s_waitcnt lgkmcnt(8)
s_waitcnt vmcnt(11)
v_mfma_f32_32x32x16_bf16 v[32:47], v[20:23], v[120:123], v[32:47]
ds_read_b64_tr_b16 v[12:13], v27 offset:57344
ds_read_b64_tr_b16 v[14:15], v27 offset:58368
s_waitcnt lgkmcnt(8)
buffer_load_dwordx4 v[168:171], v29, s[16:19], s61 offen offset:2048 sc1
v_mfma_f32_32x32x16_bf16 v[48:63], v[64:67], v[120:123], v[48:63]
ds_read_b64_tr_b16 v[16:17], v26 offset:59392
ds_read_b64_tr_b16 v[18:19], v26 offset:60416
s_waitcnt lgkmcnt(8)
s_waitcnt vmcnt(11)
v_mfma_f32_32x32x16_bf16 v[32:47], v[68:71], v[124:127], v[32:47]
ds_read_b64_tr_b16 v[20:21], v27 offset:59392
ds_read_b64_tr_b16 v[22:23], v27 offset:60416
s_waitcnt lgkmcnt(8)
buffer_load_dwordx4 v[172:175], v29, s[16:19], s61 offen offset:3072 sc1
v_mfma_f32_32x32x16_bf16 v[48:63], v[72:75], v[124:127], v[48:63]
ds_read_b64_tr_b16 v[64:65], v26 offset:61440
ds_read_b64_tr_b16 v[66:67], v26 offset:62464
s_waitcnt lgkmcnt(8)
s_waitcnt vmcnt(11)
v_mfma_f32_32x32x16_bf16 v[32:47], v[76:79], v[128:131], v[32:47]
ds_read_b64_tr_b16 v[68:69], v27 offset:61440
ds_read_b64_tr_b16 v[70:71], v27 offset:62464
s_waitcnt lgkmcnt(8)
s_add_u32 s61, s56, 24576
buffer_load_dwordx4 v[176:179], v28, s[16:19], s61 offen offset:0 sc1
v_mfma_f32_32x32x16_bf16 v[48:63], v[12:15], v[128:131], v[48:63]
ds_read_b64_tr_b16 v[72:73], v26 offset:63488
ds_read_b64_tr_b16 v[74:75], v26 offset:64512
s_waitcnt lgkmcnt(8)
s_waitcnt vmcnt(11)
v_mfma_f32_32x32x16_bf16 v[32:47], v[16:19], v[132:135], v[32:47]
ds_read_b64_tr_b16 v[76:77], v27 offset:63488
ds_read_b64_tr_b16 v[78:79], v27 offset:64512
s_waitcnt lgkmcnt(8)
buffer_load_dwordx4 v[180:183], v28, s[16:19], s61 offen offset:1024 sc1
v_mfma_f32_32x32x16_bf16 v[48:63], v[20:23], v[132:135], v[48:63]
ds_read_b64_tr_b16 v[12:13], v252 offset:0
ds_read_b64_tr_b16 v[14:15], v252 offset:1024
s_waitcnt lgkmcnt(8)
s_waitcnt vmcnt(11)
v_mfma_f32_32x32x16_bf16 v[32:47], v[64:67], v[136:139], v[32:47]
ds_read_b64_tr_b16 v[16:17], v253 offset:0
ds_read_b64_tr_b16 v[18:19], v253 offset:1024
s_waitcnt lgkmcnt(8)
buffer_load_dwordx4 v[184:187], v28, s[16:19], s61 offen offset:2048 sc1
v_mfma_f32_32x32x16_bf16 v[48:63], v[68:71], v[136:139], v[48:63]
ds_read_b64_tr_b16 v[20:21], v252 offset:2048
ds_read_b64_tr_b16 v[22:23], v252 offset:3072
s_waitcnt lgkmcnt(8)
s_waitcnt vmcnt(11)
v_mfma_f32_32x32x16_bf16 v[32:47], v[72:75], v[140:143], v[32:47]
ds_read_b64_tr_b16 v[64:65], v253 offset:2048
ds_read_b64_tr_b16 v[66:67], v253 offset:3072
s_waitcnt lgkmcnt(8)
buffer_load_dwordx4 v[188:191], v28, s[16:19], s61 offen offset:3072 sc1
v_mfma_f32_32x32x16_bf16 v[48:63], v[76:79], v[140:143], v[48:63]
ds_read_b64_tr_b16 v[68:69], v252 offset:4096
ds_read_b64_tr_b16 v[70:71], v252 offset:5120
s_waitcnt lgkmcnt(8)
s_waitcnt vmcnt(11)
v_mfma_f32_32x32x16_bf16 v[32:47], v[12:15], v[144:147], v[32:47]
ds_read_b64_tr_b16 v[72:73], v253 offset:4096
ds_read_b64_tr_b16 v[74:75], v253 offset:5120
s_waitcnt lgkmcnt(8)
buffer_load_dwordx4 v[192:195], v29, s[16:19], s61 offen offset:0 sc1
v_mfma_f32_32x32x16_bf16 v[48:63], v[16:19], v[144:147], v[48:63]
ds_read_b64_tr_b16 v[76:77], v252 offset:6144
ds_read_b64_tr_b16 v[78:79], v252 offset:7168
s_waitcnt lgkmcnt(8)
s_waitcnt vmcnt(11)
v_mfma_f32_32x32x16_bf16 v[32:47], v[20:23], v[148:151], v[32:47]
ds_read_b64_tr_b16 v[12:13], v253 offset:6144
ds_read_b64_tr_b16 v[14:15], v253 offset:7168
s_waitcnt lgkmcnt(8)
buffer_load_dwordx4 v[196:199], v29, s[16:19], s61 offen offset:1024 sc1
v_mfma_f32_32x32x16_bf16 v[48:63], v[64:67], v[148:151], v[48:63]
ds_read_b64_tr_b16 v[16:17], v252 offset:8192
ds_read_b64_tr_b16 v[18:19], v252 offset:9216
s_waitcnt lgkmcnt(8)
s_waitcnt vmcnt(11)
v_mfma_f32_32x32x16_bf16 v[32:47], v[68:71], v[152:155], v[32:47]
ds_read_b64_tr_b16 v[20:21], v253 offset:8192
ds_read_b64_tr_b16 v[22:23], v253 offset:9216
s_waitcnt lgkmcnt(8)
buffer_load_dwordx4 v[200:203], v29, s[16:19], s61 offen offset:2048 sc1
v_mfma_f32_32x32x16_bf16 v[48:63], v[72:75], v[152:155], v[48:63]
ds_read_b64_tr_b16 v[64:65], v252 offset:10240
ds_read_b64_tr_b16 v[66:67], v252 offset:11264
s_waitcnt lgkmcnt(8)
s_waitcnt vmcnt(11)
v_mfma_f32_32x32x16_bf16 v[32:47], v[76:79], v[156:159], v[32:47]
ds_read_b64_tr_b16 v[68:69], v253 offset:10240
ds_read_b64_tr_b16 v[70:71], v253 offset:11264
s_waitcnt lgkmcnt(8)
buffer_load_dwordx4 v[204:207], v29, s[16:19], s61 offen offset:3072 sc1
v_mfma_f32_32x32x16_bf16 v[48:63], v[12:15], v[156:159], v[48:63]
ds_read_b64_tr_b16 v[72:73], v252 offset:12288
ds_read_b64_tr_b16 v[74:75], v252 offset:13312
s_waitcnt lgkmcnt(8)
s_waitcnt vmcnt(11)
v_mfma_f32_32x32x16_bf16 v[32:47], v[16:19], v[160:163], v[32:47]
ds_read_b64_tr_b16 v[76:77], v253 offset:12288
ds_read_b64_tr_b16 v[78:79], v253 offset:13312
s_waitcnt lgkmcnt(8)
s_add_u32 s61, s56, 32768
buffer_load_dwordx4 v[208:211], v28, s[16:19], s61 offen offset:0 sc1
v_mfma_f32_32x32x16_bf16 v[48:63], v[20:23], v[160:163], v[48:63]
ds_read_b64_tr_b16 v[12:13], v252 offset:14336
ds_read_b64_tr_b16 v[14:15], v252 offset:15360
s_waitcnt lgkmcnt(8)
s_waitcnt vmcnt(11)
v_mfma_f32_32x32x16_bf16 v[32:47], v[64:67], v[164:167], v[32:47]
ds_read_b64_tr_b16 v[16:17], v253 offset:14336
ds_read_b64_tr_b16 v[18:19], v253 offset:15360
s_waitcnt lgkmcnt(8)
buffer_load_dwordx4 v[212:215], v28, s[16:19], s61 offen offset:1024 sc1
v_mfma_f32_32x32x16_bf16 v[48:63], v[68:71], v[164:167], v[48:63]
ds_read_b64_tr_b16 v[20:21], v252 offset:16384
ds_read_b64_tr_b16 v[22:23], v252 offset:17408
s_waitcnt lgkmcnt(8)
s_waitcnt vmcnt(11)
v_mfma_f32_32x32x16_bf16 v[32:47], v[72:75], v[168:171], v[32:47]
ds_read_b64_tr_b16 v[64:65], v253 offset:16384
ds_read_b64_tr_b16 v[66:67], v253 offset:17408
s_waitcnt lgkmcnt(8)
buffer_load_dwordx4 v[216:219], v28, s[16:19], s61 offen offset:2048 sc1
v_mfma_f32_32x32x16_bf16 v[48:63], v[76:79], v[168:171], v[48:63]
ds_read_b64_tr_b16 v[68:69], v252 offset:18432
ds_read_b64_tr_b16 v[70:71], v252 offset:19456
s_waitcnt lgkmcnt(8)
s_waitcnt vmcnt(11)
v_mfma_f32_32x32x16_bf16 v[32:47], v[12:15], v[172:175], v[32:47]
ds_read_b64_tr_b16 v[72:73], v253 offset:18432
ds_read_b64_tr_b16 v[74:75], v253 offset:19456
s_waitcnt lgkmcnt(8)
buffer_load_dwordx4 v[220:223], v28, s[16:19], s61 offen offset:3072 sc1
v_mfma_f32_32x32x16_bf16 v[48:63], v[16:19], v[172:175], v[48:63]
ds_read_b64_tr_b16 v[76:77], v252 offset:20480
ds_read_b64_tr_b16 v[78:79], v252 offset:21504
s_waitcnt lgkmcnt(8)
s_waitcnt vmcnt(11)
v_mfma_f32_32x32x16_bf16 v[32:47], v[20:23], v[176:179], v[32:47]
ds_read_b64_tr_b16 v[12:13], v253 offset:20480
ds_read_b64_tr_b16 v[14:15], v253 offset:21504
s_waitcnt lgkmcnt(8)
buffer_load_dwordx4 v[224:227], v29, s[16:19], s61 offen offset:0 sc1
v_mfma_f32_32x32x16_bf16 v[48:63], v[64:67], v[176:179], v[48:63]
ds_read_b64_tr_b16 v[16:17], v252 offset:22528
ds_read_b64_tr_b16 v[18:19], v252 offset:23552
s_waitcnt lgkmcnt(8)
s_waitcnt vmcnt(11)
v_mfma_f32_32x32x16_bf16 v[32:47], v[68:71], v[180:183], v[32:47]
ds_read_b64_tr_b16 v[20:21], v253 offset:22528
ds_read_b64_tr_b16 v[22:23], v253 offset:23552
s_waitcnt lgkmcnt(8)
buffer_load_dwordx4 v[228:231], v29, s[16:19], s61 offen offset:1024 sc1
v_mfma_f32_32x32x16_bf16 v[48:63], v[72:75], v[180:183], v[48:63]
ds_read_b64_tr_b16 v[64:65], v252 offset:24576
ds_read_b64_tr_b16 v[66:67], v252 offset:25600
s_waitcnt lgkmcnt(8)
s_waitcnt vmcnt(11)
v_mfma_f32_32x32x16_bf16 v[32:47], v[76:79], v[184:187], v[32:47]
ds_read_b64_tr_b16 v[68:69], v253 offset:24576
ds_read_b64_tr_b16 v[70:71], v253 offset:25600
s_waitcnt lgkmcnt(8)
buffer_load_dwordx4 v[232:235], v29, s[16:19], s61 offen offset:2048 sc1
v_mfma_f32_32x32x16_bf16 v[48:63], v[12:15], v[184:187], v[48:63]
ds_read_b64_tr_b16 v[72:73], v252 offset:26624
ds_read_b64_tr_b16 v[74:75], v252 offset:27648
s_waitcnt lgkmcnt(8)
s_waitcnt vmcnt(11)
v_mfma_f32_32x32x16_bf16 v[32:47], v[16:19], v[188:191], v[32:47]
ds_read_b64_tr_b16 v[76:77], v253 offset:26624
ds_read_b64_tr_b16 v[78:79], v253 offset:27648
s_waitcnt lgkmcnt(8)
buffer_load_dwordx4 v[236:239], v29, s[16:19], s61 offen offset:3072 sc1
v_mfma_f32_32x32x16_bf16 v[48:63], v[20:23], v[188:191], v[48:63]
ds_read_b64_tr_b16 v[12:13], v252 offset:28672
ds_read_b64_tr_b16 v[14:15], v252 offset:29696
s_waitcnt lgkmcnt(8)
s_waitcnt vmcnt(11)
v_mfma_f32_32x32x16_bf16 v[32:47], v[64:67], v[192:195], v[32:47]
ds_read_b64_tr_b16 v[16:17], v253 offset:28672
ds_read_b64_tr_b16 v[18:19], v253 offset:29696
s_waitcnt lgkmcnt(8)
s_add_u32 s61, s56, 40960
buffer_load_dwordx4 v[240:243], v28, s[16:19], s61 offen offset:0 sc1
v_mfma_f32_32x32x16_bf16 v[48:63], v[68:71], v[192:195], v[48:63]
ds_read_b64_tr_b16 v[20:21], v252 offset:30720
ds_read_b64_tr_b16 v[22:23], v252 offset:31744
s_waitcnt lgkmcnt(8)
s_waitcnt vmcnt(11)
v_mfma_f32_32x32x16_bf16 v[32:47], v[72:75], v[196:199], v[32:47]
ds_read_b64_tr_b16 v[64:65], v253 offset:30720
ds_read_b64_tr_b16 v[66:67], v253 offset:31744
s_waitcnt lgkmcnt(8)
buffer_load_dwordx4 v[244:247], v28, s[16:19], s61 offen offset:1024 sc1
v_mfma_f32_32x32x16_bf16 v[48:63], v[76:79], v[196:199], v[48:63]
ds_read_b64_tr_b16 v[68:69], v254 offset:0
ds_read_b64_tr_b16 v[70:71], v254 offset:1024
s_waitcnt lgkmcnt(8)
s_waitcnt vmcnt(11)
v_mfma_f32_32x32x16_bf16 v[32:47], v[12:15], v[200:203], v[32:47]
ds_read_b64_tr_b16 v[72:73], v255 offset:0
ds_read_b64_tr_b16 v[74:75], v255 offset:1024
s_waitcnt lgkmcnt(8)
buffer_load_dwordx4 v[248:251], v28, s[16:19], s61 offen offset:2048 sc1
v_mfma_f32_32x32x16_bf16 v[48:63], v[16:19], v[200:203], v[48:63]
ds_read_b64_tr_b16 v[76:77], v254 offset:2048
ds_read_b64_tr_b16 v[78:79], v254 offset:3072
s_waitcnt lgkmcnt(8)
s_waitcnt vmcnt(11)
v_mfma_f32_32x32x16_bf16 v[32:47], v[20:23], v[204:207], v[32:47]
ds_read_b64_tr_b16 v[12:13], v255 offset:2048
ds_read_b64_tr_b16 v[14:15], v255 offset:3072
s_waitcnt lgkmcnt(8)
v_mfma_f32_32x32x16_bf16 v[48:63], v[64:67], v[204:207], v[48:63]
ds_read_b64_tr_b16 v[16:17], v254 offset:4096
ds_read_b64_tr_b16 v[18:19], v254 offset:5120
s_waitcnt lgkmcnt(8)
s_waitcnt vmcnt(10)
v_mfma_f32_32x32x16_bf16 v[32:47], v[68:71], v[208:211], v[32:47]
ds_read_b64_tr_b16 v[20:21], v255 offset:4096
ds_read_b64_tr_b16 v[22:23], v255 offset:5120
s_waitcnt lgkmcnt(8)
v_mfma_f32_32x32x16_bf16 v[48:63], v[72:75], v[208:211], v[48:63]
ds_read_b64_tr_b16 v[64:65], v254 offset:6144
ds_read_b64_tr_b16 v[66:67], v254 offset:7168
s_waitcnt lgkmcnt(8)
s_waitcnt vmcnt(9)
v_mfma_f32_32x32x16_bf16 v[32:47], v[76:79], v[212:215], v[32:47]
ds_read_b64_tr_b16 v[68:69], v255 offset:6144
ds_read_b64_tr_b16 v[70:71], v255 offset:7168
s_waitcnt lgkmcnt(8)
v_mfma_f32_32x32x16_bf16 v[48:63], v[12:15], v[212:215], v[48:63]
ds_read_b64_tr_b16 v[72:73], v254 offset:8192
ds_read_b64_tr_b16 v[74:75], v254 offset:9216
s_waitcnt lgkmcnt(8)
s_waitcnt vmcnt(8)
v_mfma_f32_32x32x16_bf16 v[32:47], v[16:19], v[216:219], v[32:47]
ds_read_b64_tr_b16 v[76:77], v255 offset:8192
ds_read_b64_tr_b16 v[78:79], v255 offset:9216
s_waitcnt lgkmcnt(8)
v_mfma_f32_32x32x16_bf16 v[48:63], v[20:23], v[216:219], v[48:63]
ds_read_b64_tr_b16 v[12:13], v254 offset:10240
ds_read_b64_tr_b16 v[14:15], v254 offset:11264
s_waitcnt lgkmcnt(8)
s_waitcnt vmcnt(7)
v_mfma_f32_32x32x16_bf16 v[32:47], v[64:67], v[220:223], v[32:47]
ds_read_b64_tr_b16 v[16:17], v255 offset:10240
ds_read_b64_tr_b16 v[18:19], v255 offset:11264
s_waitcnt lgkmcnt(8)
v_mfma_f32_32x32x16_bf16 v[48:63], v[68:71], v[220:223], v[48:63]
ds_read_b64_tr_b16 v[20:21], v254 offset:12288
ds_read_b64_tr_b16 v[22:23], v254 offset:13312
s_waitcnt lgkmcnt(8)
s_waitcnt vmcnt(6)
v_mfma_f32_32x32x16_bf16 v[32:47], v[72:75], v[224:227], v[32:47]
ds_read_b64_tr_b16 v[64:65], v255 offset:12288
ds_read_b64_tr_b16 v[66:67], v255 offset:13312
s_waitcnt lgkmcnt(8)
v_mfma_f32_32x32x16_bf16 v[48:63], v[76:79], v[224:227], v[48:63]
ds_read_b64_tr_b16 v[68:69], v254 offset:14336
ds_read_b64_tr_b16 v[70:71], v254 offset:15360
s_waitcnt lgkmcnt(8)
s_waitcnt vmcnt(5)
v_mfma_f32_32x32x16_bf16 v[32:47], v[12:15], v[228:231], v[32:47]
ds_read_b64_tr_b16 v[72:73], v255 offset:14336
ds_read_b64_tr_b16 v[74:75], v255 offset:15360
s_waitcnt lgkmcnt(8)
v_mfma_f32_32x32x16_bf16 v[48:63], v[16:19], v[228:231], v[48:63]
ds_read_b64_tr_b16 v[76:77], v254 offset:16384
ds_read_b64_tr_b16 v[78:79], v254 offset:17408
s_waitcnt lgkmcnt(8)
s_waitcnt vmcnt(4)
v_mfma_f32_32x32x16_bf16 v[32:47], v[20:23], v[232:235], v[32:47]
ds_read_b64_tr_b16 v[12:13], v255 offset:16384
ds_read_b64_tr_b16 v[14:15], v255 offset:17408
s_waitcnt lgkmcnt(8)
v_mfma_f32_32x32x16_bf16 v[48:63], v[64:67], v[232:235], v[48:63]
ds_read_b64_tr_b16 v[16:17], v254 offset:18432
ds_read_b64_tr_b16 v[18:19], v254 offset:19456
s_waitcnt lgkmcnt(8)
s_waitcnt vmcnt(3)
v_mfma_f32_32x32x16_bf16 v[32:47], v[68:71], v[236:239], v[32:47]
ds_read_b64_tr_b16 v[20:21], v255 offset:18432
ds_read_b64_tr_b16 v[22:23], v255 offset:19456
s_waitcnt lgkmcnt(8)
v_mfma_f32_32x32x16_bf16 v[48:63], v[72:75], v[236:239], v[48:63]
ds_read_b64_tr_b16 v[64:65], v254 offset:20480
ds_read_b64_tr_b16 v[66:67], v254 offset:21504
s_waitcnt lgkmcnt(8)
s_waitcnt vmcnt(2)
v_mfma_f32_32x32x16_bf16 v[32:47], v[76:79], v[240:243], v[32:47]
ds_read_b64_tr_b16 v[68:69], v255 offset:20480
ds_read_b64_tr_b16 v[70:71], v255 offset:21504
s_waitcnt lgkmcnt(8)
v_mfma_f32_32x32x16_bf16 v[48:63], v[12:15], v[240:243], v[48:63]
s_waitcnt lgkmcnt(6)
s_waitcnt vmcnt(1)
v_mfma_f32_32x32x16_bf16 v[32:47], v[16:19], v[244:247], v[32:47]
s_waitcnt lgkmcnt(4)
v_mfma_f32_32x32x16_bf16 v[48:63], v[20:23], v[244:247], v[48:63]
s_waitcnt lgkmcnt(2)
s_waitcnt vmcnt(0)
v_mfma_f32_32x32x16_bf16 v[32:47], v[64:67], v[248:251], v[32:47]
s_waitcnt lgkmcnt(0)
v_mfma_f32_32x32x16_bf16 v[48:63], v[68:71], v[248:251], v[48:63]
Lhj_78:
s_nop 10
ds_write_b128 v4, v[32:35] offset:0
ds_write_b128 v4, v[36:39] offset:32
ds_write_b128 v4, v[40:43] offset:64
ds_write_b128 v4, v[44:47] offset:96
ds_write_b128 v4, v[48:51] offset:128
ds_write_b128 v4, v[52:55] offset:160
ds_write_b128 v4, v[56:59] offset:192
ds_write_b128 v4, v[60:63] offset:224
v_lshlrev_b32 v64, 16, v8
v_and_b32 v65, 0xffff0000, v8
v_lshlrev_b32_e64 v66, 16, v9
v_and_b32 v67, 0xffff0000, v9
v_lshlrev_b32_e64 v68, 16, v10
v_and_b32 v69, 0xffff0000, v10
v_lshlrev_b32_e64 v70, 16, v11
v_and_b32 v71, 0xffff0000, v11
s_waitcnt lgkmcnt(0)
s_barrier
ds_read_b128 v[16:19], v6
ds_read_b128 v[20:23], v6 offset:16
ds_read_b128 v[24:27], v5
ds_read_b128 v[28:31], v5 offset:16
s_waitcnt lgkmcnt(2)
v_pk_add_f32 v[64:65], v[64:65], v[16:17]
v_pk_add_f32 v[66:67], v[66:67], v[18:19]
v_pk_add_f32 v[68:69], v[68:69], v[20:21]
v_pk_add_f32 v[70:71], v[70:71], v[22:23]
s_waitcnt lgkmcnt(0)
v_pk_add_f32 v[64:65], v[64:65], v[24:25]
v_pk_add_f32 v[66:67], v[66:67], v[26:27]
v_pk_add_f32 v[68:69], v[68:69], v[28:29]
v_pk_add_f32 v[70:71], v[70:71], v[30:31]
v_cvt_pk_bf16_f32 v32, v64, v65
v_cvt_pk_bf16_f32 v33, v66, v67
v_cvt_pk_bf16_f32 v34, v68, v69
v_cvt_pk_bf16_f32 v35, v70, v71
buffer_store_dwordx4 v[32:35], v7, s[32:35], s47 offen
s_endpgm
LF_hq1:
s_mov_b32 s16, s92
s_and_b32 s17, s93, 0xffff
s_mov_b32 s18, 0x10000000
s_mov_b32 s19, 0x20000
s_mov_b32 s40, s90
s_and_b32 s41, s91, 0xffff
s_mov_b32 s42, 0x100
s_mov_b32 s43, 0x20000
s_mov_b32 s20, s74
s_and_b32 s21, s75, 0xffff
s_mov_b32 s22, 0x800000
s_mov_b32 s23, 0x20000
s_mov_b32 s24, s68
s_and_b32 s25, s69, 0xffff
s_mov_b32 s26, 0x80000
s_mov_b32 s27, 0x20000
s_mov_b32 s28, s78
s_and_b32 s29, s79, 0xffff
s_mov_b32 s30, 0xac000
s_mov_b32 s31, 0x20000
s_mov_b32 s32, s88
s_and_b32 s33, s89, 0xffff
s_mov_b32 s34, 0x200000
s_mov_b32 s35, 0x20000
s_mov_b32 s36, s76
s_and_b32 s37, s77, 0xffff
s_mov_b32 s38, 0x1000
s_mov_b32 s39, 0x20000
v_lshrrev_b32 v3, 3, v1
v_lshlrev_b32 v3, 13, v3
v_lshrrev_b32 v30, 4, v1
v_and_b32 v31, 7, v1
v_xor_b32_e64 v30, v30, v31
v_lshl_add_u32 v8, v30, 4, v3
v_xor_b32_e64 v30, 4, v30
v_lshl_add_u32 v9, v30, 4, v3
v_add_u32 v9, 64512, v9
s_lshl_b32 s59, s6, 2
s_add_u32 s59, s59, s4
s_lshl_b32 s59, s59, 17
s_lshl_b32 s61, s48, 11
s_add_u32 s59, s59, s61
s_mov_b32 s96, s72
s_and_b32 s97, s73, 0xffff
s_mov_b32 s98, 0x158000
s_mov_b32 s99, 0x20000
v_lshrrev_b32 v31, 4, v1
v_lshlrev_b32 v31, 12, v31
v_and_b32_e64 v30, 15, v1
v_lshl_add_u32 v12, v30, 7, v31
s_lshl_b32 s64, s6, 2
s_add_u32 s62, s50, 0
s_and_b32 s62, s62, 3
s_add_u32 s64, s64, s62
s_lshl_b32 s64, s64, 2
s_add_u32 s64, s64, s4
s_lshl_b32 s64, s64, 15
s_lshl_b32 s62, s48, 11
s_add_u32 s64, s64, s62
s_add_u32 s67, s64, 16384
s_lshr_b32 s61, s2, 3
s_lshl_b32 s61, s61, 2
s_add_u32 s61, s61, s4
v_lshlrev_b32 v13, 7, v1
s_lshl_b32 s65, s61, 13
s_mul_i32 s66, s61, 11008
s_add_u32 s68, s66, 8192
v_lshlrev_b32_e64 v14, 10, v1
s_and_b32 s61, s61, 15
s_lshl_b32 s71, s61, 15
s_add_u32 s61, s50, 4
s_lshl_b32 s61, s61, 7
s_add_u32 s71, s71, s61
s_add_u32 s61, s2, 0
s_and_b32 s61, s61, 127
s_lshl_b32 s61, s61, 2
s_add_u32 s61, s61, s4
s_lshl_b32 s73, s61, 10
s_mul_i32 s74, s61, 1408
s_mul_i32 s66, s61, 2752
s_and_b32 s66, s66, 0xffffff80
s_mul_i32 s77, s61, 640
s_add_u32 s77, s77, 22020096
s_lshl_b32 s78, s61, 9
s_add_u32 s78, s78, 20971520
s_mul_i32 s79, s61, 6144
s_add_u32 s79, s79, 0
s_mul_i32 s94, s61, 12288
s_add_u32 s94, s94, 8388608
s_add_u32 s95, s94, 8192
s_waitcnt vmcnt(11)
s_barrier
s_load_dword s52, s[90:91], 128
s_add_u32 s61, s44, 2
s_and_b32 s61, s61, 7
s_lshl_b32 s58, s61, 7
s_add_u32 s62, s58, s53
s_add_u32 m0, s60, 0
s_add_u32 s63, s62, 1024
buffer_load_dwordx4 v4, s[8:11], s62 offen lds
buffer_load_dwordx4 v5, s[8:11], s62 offen offset:1024 lds
s_add_u32 m0, s60, 2048
s_nop 0
buffer_load_dwordx4 v4, s[8:11], s63 offen lds
buffer_load_dwordx4 v5, s[8:11], s63 offen offset:1024 lds
s_mul_i32 s63, s61, 196608
s_add_u32 s63, s63, s54
s_add_u32 m0, s56, 18432
s_add_u32 s62, s58, s55
buffer_load_dwordx4 v6, s[12:15], s63 offen offset:0 lds
buffer_load_dwordx4 v6, s[12:15], s63 offen offset:1024 lds
buffer_load_dwordx4 v6, s[12:15], s63 offen offset:2048 lds
s_add_u32 m0, s56, 21504
s_nop 0
buffer_load_dwordx4 v7, s[12:15], s63 offen offset:0 lds
buffer_load_dwordx4 v7, s[12:15], s63 offen offset:1024 lds
buffer_load_dwordx4 v7, s[12:15], s63 offen offset:2048 lds
s_add_u32 m0, s57, 16384
s_mov_b32 exec_hi, 0
buffer_load_dwordx4 v20, s[8:11], s62 offen lds
s_mov_b32 exec_hi, -1
s_waitcnt lgkmcnt(0)
s_cmp_lg_u32 s52, 0
s_cbranch_scc1 Lok_2
s_mov_b32 s63, 0
Lspin_1:
s_sleep 2
v_mov_b32 v31, 0
buffer_load_dword v30, v31, s[40:43], 0 offen sc1
s_waitcnt vmcnt(0)
s_add_u32 s63, s63, 1
s_cmp_gt_u32 s63, 32768
s_cbranch_scc1 Lok_2
v_readfirstlane_b32 s52, v30
s_cmp_lg_u32 s52, 0
s_cbranch_scc0 Lspin_1
Lok_2:
s_mov_b32 m0, 163072
s_mov_b32 exec_lo, 0xff
s_mov_b32 exec_hi, 0x0
buffer_load_dword v13, s[24:27], s73 offen lds
s_mov_b32 exec_lo, 0x7ff
s_mov_b32 exec_hi, 0x0
buffer_load_dword v13, s[28:31], s74 offen lds
s_mov_b64 exec, -1
s_mov_b32 m0, 163072
s_mov_b32 exec_lo, 0xfff
s_mov_b32 exec_hi, 0x0
buffer_load_dword v13, s[96:99], s66 offen lds
s_mov_b64 exec, -1
s_mov_b32 m0, 163072
s_mov_b32 exec_lo, 0x1f
s_mov_b32 exec_hi, 0x0
buffer_load_dword v13, s[16:19], s77 offen lds
s_mov_b32 exec_lo, 0xf
s_mov_b32 exec_hi, 0x0
buffer_load_dword v13, s[16:19], s78 offen lds
s_mov_b64 exec, -1
s_waitcnt vmcnt(16)
s_barrier
s_add_u32 s61, s44, 3
s_and_b32 s61, s61, 7
s_lshl_b32 s58, s61, 7
s_add_u32 s62, s58, s53
s_add_u32 m0, s60, 86016
s_add_u32 s63, s62, 1024
buffer_load_dwordx4 v4, s[8:11], s62 offen lds
buffer_load_dwordx4 v5, s[8:11], s62 offen offset:1024 lds
s_add_u32 m0, s60, 88064
s_nop 0
buffer_load_dwordx4 v4, s[8:11], s63 offen lds
buffer_load_dwordx4 v5, s[8:11], s63 offen offset:1024 lds
s_mul_i32 s63, s61, 196608
s_add_u32 s63, s63, s54
s_add_u32 m0, s56, 104448
s_add_u32 s62, s58, s55
buffer_load_dwordx4 v6, s[12:15], s63 offen offset:0 lds
buffer_load_dwordx4 v6, s[12:15], s63 offen offset:1024 lds
buffer_load_dwordx4 v6, s[12:15], s63 offen offset:2048 lds
s_add_u32 m0, s56, 107520
s_nop 0
buffer_load_dwordx4 v7, s[12:15], s63 offen offset:0 lds
buffer_load_dwordx4 v7, s[12:15], s63 offen offset:1024 lds
buffer_load_dwordx4 v7, s[12:15], s63 offen offset:2048 lds
s_add_u32 m0, s57, 102400
s_mov_b32 exec_hi, 0
buffer_load_dwordx4 v20, s[8:11], s62 offen lds
s_mov_b32 exec_hi, -1
s_waitcnt vmcnt(16)
s_barrier
s_add_u32 s61, s44, 4
s_and_b32 s61, s61, 7
s_lshl_b32 s58, s61, 7
s_add_u32 s62, s58, s53
s_add_u32 m0, s60, 43008
s_add_u32 s63, s62, 1024
buffer_load_dwordx4 v4, s[8:11], s62 offen lds
buffer_load_dwordx4 v5, s[8:11], s62 offen offset:1024 lds
s_add_u32 m0, s60, 45056
s_nop 0
buffer_load_dwordx4 v4, s[8:11], s63 offen lds
buffer_load_dwordx4 v5, s[8:11], s63 offen offset:1024 lds
s_mul_i32 s63, s61, 196608
s_add_u32 s63, s63, s54
s_add_u32 m0, s56, 61440
s_add_u32 s62, s58, s55
buffer_load_dwordx4 v6, s[12:15], s63 offen offset:0 lds
buffer_load_dwordx4 v6, s[12:15], s63 offen offset:1024 lds
buffer_load_dwordx4 v6, s[12:15], s63 offen offset:2048 lds
s_add_u32 m0, s56, 64512
s_nop 0
buffer_load_dwordx4 v7, s[12:15], s63 offen offset:0 lds
buffer_load_dwordx4 v7, s[12:15], s63 offen offset:1024 lds
buffer_load_dwordx4 v7, s[12:15], s63 offen offset:2048 lds
s_add_u32 m0, s57, 59392
s_mov_b32 exec_hi, 0
buffer_load_dwordx4 v20, s[8:11], s62 offen lds
s_mov_b32 exec_hi, -1
s_waitcnt vmcnt(11)
s_barrier
s_add_u32 s61, s44, 5
s_and_b32 s61, s61, 7
s_lshl_b32 s58, s61, 7
s_add_u32 s62, s58, s53
s_add_u32 m0, s60, 0
s_add_u32 s63, s62, 1024
buffer_load_dwordx4 v4, s[8:11], s62 offen lds
buffer_load_dwordx4 v5, s[8:11], s62 offen offset:1024 lds
s_add_u32 m0, s60, 2048
s_nop 0
buffer_load_dwordx4 v4, s[8:11], s63 offen lds
buffer_load_dwordx4 v5, s[8:11], s63 offen offset:1024 lds
s_mul_i32 s63, s61, 196608
s_add_u32 s63, s63, s54
s_add_u32 m0, s56, 18432
s_add_u32 s62, s58, s55
buffer_load_dwordx4 v6, s[12:15], s63 offen offset:0 lds
buffer_load_dwordx4 v6, s[12:15], s63 offen offset:1024 lds
buffer_load_dwordx4 v6, s[12:15], s63 offen offset:2048 lds
s_add_u32 m0, s56, 21504
s_nop 0
buffer_load_dwordx4 v7, s[12:15], s63 offen offset:0 lds
buffer_load_dwordx4 v7, s[12:15], s63 offen offset:1024 lds
buffer_load_dwordx4 v7, s[12:15], s63 offen offset:2048 lds
s_add_u32 m0, s57, 16384
s_mov_b32 exec_hi, 0
buffer_load_dwordx4 v20, s[8:11], s62 offen lds
s_mov_b32 exec_hi, -1
s_lshl_b32 s69, s6, 2
s_add_u32 s69, s69, s4
s_lshl_b32 s69, s69, 9
s_add_u32 s69, s69, 21495808
s_lshl_b32 s70, s6, 11
s_sub_u32 s70, s70, 256
s_max_i32 s70, s70, 0
s_add_u32 s70, s70, 21495808
v_lshlrev_b32_e64 v36, 3, v1
v_and_b32 v37, 0xff, v36
buffer_load_dwordx2 v[32:33], v36, s[16:19], s69 offen sc1
buffer_load_dwordx2 v[34:35], v37, s[16:19], s70 offen sc1
s_mov_b32 m0, 163072
s_mov_b32 exec_lo, 0xffffffff
s_mov_b32 exec_hi, 0x3ff
buffer_load_dword v12, s[20:23], s64 offen nt lds
s_mov_b64 exec, -1
s_waitcnt vmcnt(14)
s_barrier
s_add_u32 s61, s44, 6
s_and_b32 s61, s61, 7
s_lshl_b32 s58, s61, 7
s_add_u32 s62, s58, s53
s_add_u32 m0, s60, 86016
s_add_u32 s63, s62, 1024
buffer_load_dwordx4 v4, s[8:11], s62 offen lds
buffer_load_dwordx4 v5, s[8:11], s62 offen offset:1024 lds
s_add_u32 m0, s60, 88064
s_nop 0
buffer_load_dwordx4 v4, s[8:11], s63 offen lds
buffer_load_dwordx4 v5, s[8:11], s63 offen offset:1024 lds
s_mul_i32 s63, s61, 196608
s_add_u32 s63, s63, s54
s_add_u32 m0, s56, 104448
s_add_u32 s62, s58, s55
buffer_load_dwordx4 v6, s[12:15], s63 offen offset:0 lds
buffer_load_dwordx4 v6, s[12:15], s63 offen offset:1024 lds
buffer_load_dwordx4 v6, s[12:15], s63 offen offset:2048 lds
s_add_u32 m0, s56, 107520
s_nop 0
buffer_load_dwordx4 v7, s[12:15], s63 offen offset:0 lds
buffer_load_dwordx4 v7, s[12:15], s63 offen offset:1024 lds
buffer_load_dwordx4 v7, s[12:15], s63 offen offset:2048 lds
s_add_u32 m0, s57, 102400
s_mov_b32 exec_hi, 0
buffer_load_dwordx4 v20, s[8:11], s62 offen lds
s_mov_b32 exec_hi, -1
s_mov_b32 m0, 163072
s_mov_b32 exec_lo, 0x0
s_mov_b32 exec_hi, 0xfffffc00
buffer_load_dword v12, s[20:23], s64 offen nt lds
s_mov_b32 exec_lo, 0x1fffff
s_mov_b32 exec_hi, 0x0
buffer_load_dword v12, s[20:23], s67 offen nt lds
s_mov_b64 exec, -1
s_waitcnt vmcnt(16)
s_barrier
s_add_u32 s61, s44, 7
s_and_b32 s61, s61, 7
s_lshl_b32 s58, s61, 7
s_add_u32 s62, s58, s53
s_add_u32 m0, s60, 43008
s_add_u32 s63, s62, 1024
buffer_load_dwordx4 v4, s[8:11], s62 offen lds
buffer_load_dwordx4 v5, s[8:11], s62 offen offset:1024 lds
s_add_u32 m0, s60, 45056
s_nop 0
buffer_load_dwordx4 v4, s[8:11], s63 offen lds
buffer_load_dwordx4 v5, s[8:11], s63 offen offset:1024 lds
s_mul_i32 s63, s61, 196608
s_add_u32 s63, s63, s54
s_add_u32 m0, s56, 61440
s_add_u32 s62, s58, s55
buffer_load_dwordx4 v6, s[12:15], s63 offen offset:0 lds
buffer_load_dwordx4 v6, s[12:15], s63 offen offset:1024 lds
buffer_load_dwordx4 v6, s[12:15], s63 offen offset:2048 lds
s_add_u32 m0, s56, 64512
s_nop 0
buffer_load_dwordx4 v7, s[12:15], s63 offen offset:0 lds
buffer_load_dwordx4 v7, s[12:15], s63 offen offset:1024 lds
buffer_load_dwordx4 v7, s[12:15], s63 offen offset:2048 lds
s_add_u32 m0, s57, 59392
s_mov_b32 exec_hi, 0
buffer_load_dwordx4 v20, s[8:11], s62 offen lds
s_mov_b32 exec_hi, -1
s_mov_b32 m0, 163072
s_mov_b32 exec_lo, 0xffe00000
s_mov_b32 exec_hi, 0xffffffff
buffer_load_dword v12, s[20:23], s67 offen nt lds
s_mov_b64 exec, -1
s_waitcnt vmcnt(14)
s_barrier
v_cmp_ne_u32 vcc, s52, v33
v_cmp_ne_u32 s[72:73], s52, v35
s_nop 0
s_or_b64 vcc, vcc, s[72:73]
s_cmp_eq_u64 vcc, 0
s_cbranch_scc1 Lok_4
s_mov_b32 s63, 0
Lspin_3:
buffer_load_dwordx2 v[32:33], v36, s[16:19], s69 offen sc1
buffer_load_dwordx2 v[34:35], v37, s[16:19], s70 offen sc1
s_waitcnt vmcnt(0)
s_add_u32 s63, s63, 1
s_cmp_gt_u32 s63, 32768
s_cbranch_scc1 Lok_4
v_cmp_ne_u32 vcc, s52, v33
v_cmp_ne_u32 s[72:73], s52, v35
s_nop 0
s_or_b64 vcc, vcc, s[72:73]
s_cmp_eq_u64 vcc, 0
s_cbranch_scc0 Lspin_3
Lok_4:
v_bfe_u32 v38, v1, 1, 1
v_lshrrev_b32 v39, 2, v1
v_lshl_add_u32 v38, v38, 4, v39
s_lshl_b32 s61, s4, 7
s_add_u32 s61, s61, 159744
v_lshl_add_u32 v38, v38, 2, s61
v_mov_b32_dpp v33, v32 quad_perm:[1,0,3,2] row_mask:0xf bank_mask:0xf
v_mov_b32_dpp v35, v34 quad_perm:[1,0,3,2] row_mask:0xf bank_mask:0xf
v_lshlrev_b32 v39, 1, v1
v_and_b32_e64 v39, 0x3c, v39
v_add_u32 v39, 160256, v39
v_rsq_f32 v33, v33
v_rsq_f32 v35, v35
s_mov_b32 exec_lo, 0x55555555
s_mov_b32 exec_hi, 0x55555555
ds_write_b32 v38, v32
ds_write_b32 v38, v33 offset:640
ds_write_b32 v39, v34
ds_write_b32 v39, v35 offset:640
s_mov_b64 exec, -1
s_waitcnt lgkmcnt(0)
s_mov_b32 m0, 163072
s_mov_b32 exec_lo, 0xffffffff
s_mov_b32 exec_hi, 0xffffffff
buffer_load_dword v12, s[20:23], s64 offen lds
s_mov_b32 exec_lo, 0xffffffff
s_mov_b32 exec_hi, 0xffffffff
buffer_load_dword v12, s[20:23], s67 offen lds
s_mov_b64 exec, -1
s_waitcnt vmcnt(3)
s_barrier
s_add_u32 s61, s51, 0
s_and_b32 s61, s61, 15
s_lshl_b32 s61, s61, 7
s_add_u32 s61, s61, s59
s_add_u32 m0, s60, 0
s_add_u32 s62, s61, 4096
buffer_load_dwordx4 v8, s[20:23], s61 offen lds
buffer_load_dwordx4 v9, s[20:23], s61 offen offset:1024 lds
s_add_u32 m0, s60, 2048
s_nop 0
buffer_load_dwordx4 v8, s[20:23], s62 offen lds
buffer_load_dwordx4 v9, s[20:23], s62 offen offset:1024 lds
s_add_u32 s61, s51, 1
s_and_b32 s61, s61, 15
s_lshl_b32 s61, s61, 7
s_add_u32 s61, s61, s59
s_add_u32 m0, s60, 16384
s_add_u32 s62, s61, 4096
buffer_load_dwordx4 v8, s[20:23], s61 offen lds
buffer_load_dwordx4 v9, s[20:23], s61 offen offset:1024 lds
s_add_u32 m0, s60, 18432
s_nop 0
buffer_load_dwordx4 v8, s[20:23], s62 offen lds
buffer_load_dwordx4 v9, s[20:23], s62 offen offset:1024 lds
s_add_u32 s61, s51, 6
s_and_b32 s61, s61, 15
s_lshl_b32 s61, s61, 7
s_add_u32 s61, s61, s59
s_add_u32 m0, s60, 98304
s_add_u32 s62, s61, 4096
buffer_load_dwordx4 v8, s[20:23], s61 offen lds
buffer_load_dwordx4 v9, s[20:23], s61 offen offset:1024 lds
s_add_u32 m0, s60, 100352
s_nop 0
buffer_load_dwordx4 v8, s[20:23], s62 offen lds
buffer_load_dwordx4 v9, s[20:23], s62 offen offset:1024 lds
v_mov_b32 v30, 163328
s_mov_b32 s63, 0
Llw_5:
ds_read_b128 v[32:35], v30
s_add_u32 s63, s63, 1
s_waitcnt lgkmcnt(0)
v_and_b32 v32, v32, v33
v_and_b32 v34, v34, v35
v_and_b32_e64 v32, v32, v34
v_cmp_ne_u32 vcc, 0, v32
s_cbranch_vccnz Llk_6
s_cmp_lt_u32 s63, 0x100000
s_cbranch_scc1 Llw_5
Llk_6:
s_add_u32 s61, s51, 2
s_and_b32 s61, s61, 15
s_lshl_b32 s61, s61, 7
s_add_u32 s61, s61, s59
s_add_u32 m0, s60, 32768
s_add_u32 s62, s61, 4096
buffer_load_dwordx4 v8, s[20:23], s61 offen lds
buffer_load_dwordx4 v9, s[20:23], s61 offen offset:1024 lds
s_add_u32 m0, s60, 34816
s_nop 0
buffer_load_dwordx4 v8, s[20:23], s62 offen lds
buffer_load_dwordx4 v9, s[20:23], s62 offen offset:1024 lds
s_add_u32 s61, s51, 3
s_and_b32 s61, s61, 15
s_lshl_b32 s61, s61, 7
s_add_u32 s61, s61, s59
s_add_u32 m0, s60, 49152
s_add_u32 s62, s61, 4096
buffer_load_dwordx4 v8, s[20:23], s61 offen lds
buffer_load_dwordx4 v9, s[20:23], s61 offen offset:1024 lds
s_add_u32 m0, s60, 51200
s_nop 0
buffer_load_dwordx4 v8, s[20:23], s62 offen lds
buffer_load_dwordx4 v9, s[20:23], s62 offen offset:1024 lds
s_add_u32 s61, s51, 4
s_and_b32 s61, s61, 15
s_lshl_b32 s61, s61, 7
s_add_u32 s61, s61, s59
s_add_u32 m0, s60, 65536
s_add_u32 s62, s61, 4096
buffer_load_dwordx4 v8, s[20:23], s61 offen lds
buffer_load_dwordx4 v9, s[20:23], s61 offen offset:1024 lds
s_add_u32 m0, s60, 67584
s_nop 0
buffer_load_dwordx4 v8, s[20:23], s62 offen lds
buffer_load_dwordx4 v9, s[20:23], s62 offen offset:1024 lds
s_add_u32 s61, s51, 5
s_and_b32 s61, s61, 15
s_lshl_b32 s61, s61, 7
s_add_u32 s61, s61, s59
s_add_u32 m0, s60, 81920
s_add_u32 s62, s61, 4096
buffer_load_dwordx4 v8, s[20:23], s61 offen lds
buffer_load_dwordx4 v9, s[20:23], s61 offen offset:1024 lds
s_add_u32 m0, s60, 83968
s_nop 0
buffer_load_dwordx4 v8, s[20:23], s62 offen lds
buffer_load_dwordx4 v9, s[20:23], s62 offen offset:1024 lds
v_bfe_u32 v3, v1, 4, 1
v_lshlrev_b32 v3, 2, v3
v_and_b32 v30, 7, v1
v_xor_b32 v30, v30, v3
v_lshrrev_b32 v3, 3, v1
v_lshlrev_b32 v3, 10, v3
v_lshl_add_u32 v26, v30, 4, v3
s_lshl_b32 s47, s50, 7
s_lshl_b32 s61, s4, 13
s_add_u32 s47, s47, s61
s_add_u32 s46, s47, 0
buffer_load_dwordx4 v[104:107], v26, s[24:27], s46 offen
s_add_u32 s46, s47, 32768
buffer_load_dwordx4 v[108:111], v26, s[24:27], s46 offen
s_add_u32 s46, s47, 65536
buffer_load_dwordx4 v[112:115], v26, s[24:27], s46 offen
s_add_u32 s46, s47, 98304
buffer_load_dwordx4 v[116:119], v26, s[24:27], s46 offen
s_add_u32 s46, s47, 131072
buffer_load_dwordx4 v[120:123], v26, s[24:27], s46 offen
s_add_u32 s46, s47, 163840
buffer_load_dwordx4 v[124:127], v26, s[24:27], s46 offen
s_add_u32 s46, s47, 196608
buffer_load_dwordx4 v[128:131], v26, s[24:27], s46 offen
s_add_u32 s46, s47, 229376
buffer_load_dwordx4 v[132:135], v26, s[24:27], s46 offen
s_add_u32 s46, s47, 262144
buffer_load_dwordx4 v[136:139], v26, s[24:27], s46 offen
s_add_u32 s46, s47, 294912
buffer_load_dwordx4 v[140:143], v26, s[24:27], s46 offen
s_add_u32 s46, s47, 327680
buffer_load_dwordx4 v[144:147], v26, s[24:27], s46 offen
s_add_u32 s46, s47, 360448
buffer_load_dwordx4 v[148:151], v26, s[24:27], s46 offen
s_add_u32 s46, s47, 393216
buffer_load_dwordx4 v[152:155], v26, s[24:27], s46 offen
s_add_u32 s46, s47, 425984
buffer_load_dwordx4 v[156:159], v26, s[24:27], s46 offen
s_add_u32 s46, s47, 458752
buffer_load_dwordx4 v[160:163], v26, s[24:27], s46 offen
s_add_u32 s46, s47, 491520
buffer_load_dwordx4 v[164:167], v26, s[24:27], s46 offen
s_mov_b32 s72, 7
s_branch LF_hb
LF_hz1:
s_mov_b32 s16, s92
s_and_b32 s17, s93, 0xffff
s_mov_b32 s18, 0x10000000
s_mov_b32 s19, 0x20000
s_mov_b32 s40, s90
s_and_b32 s41, s91, 0xffff
s_mov_b32 s42, 0x100
s_mov_b32 s43, 0x20000
s_mov_b32 s20, s74
s_and_b32 s21, s75, 0xffff
s_mov_b32 s22, 0x800000
s_mov_b32 s23, 0x20000
s_mov_b32 s24, s68
s_and_b32 s25, s69, 0xffff
s_mov_b32 s26, 0x80000
s_mov_b32 s27, 0x20000
s_mov_b32 s28, s78
s_and_b32 s29, s79, 0xffff
s_mov_b32 s30, 0xac000
s_mov_b32 s31, 0x20000
s_mov_b32 s32, s88
s_and_b32 s33, s89, 0xffff
s_mov_b32 s34, 0x200000
s_mov_b32 s35, 0x20000
s_mov_b32 s36, s76
s_and_b32 s37, s77, 0xffff
s_mov_b32 s38, 0x1000
s_mov_b32 s39, 0x20000
v_lshrrev_b32 v3, 3, v1
v_lshlrev_b32 v3, 13, v3
v_lshrrev_b32 v30, 4, v1
v_and_b32 v31, 7, v1
v_xor_b32 v30, v30, v31
v_lshl_add_u32 v8, v30, 4, v3
v_xor_b32_e64 v30, 4, v30
v_lshl_add_u32 v9, v30, 4, v3
v_add_u32 v9, 64512, v9
s_lshl_b32 s59, s6, 2
s_add_u32 s59, s59, s4
s_lshl_b32 s59, s59, 17
s_lshl_b32 s61, s48, 11
s_add_u32 s59, s59, s61
s_mul_i32 s73, s7, 6
s_add_u32 s61, s73, 5
s_min_u32 s61, s61, 43
s_sub_u32 s73, s73, 1
s_max_i32 s73, s73, 0
s_sub_u32 s61, s61, s73
s_lshl_b32 s73, s73, 5
s_mul_i32 s61, s4, 44032
s_add_u32 s73, s73, s61
v_lshlrev_b32_e64 v10, 3, v1
s_lshl_b32 s64, s6, 5
s_add_u32 s64, s64, s4
s_lshl_b32 s64, s64, 9
s_add_u32 s64, s64, 20971520
s_add_u32 s65, s64, 4096
s_add_u32 s66, s64, 8192
s_add_u32 s67, s64, 12288
v_lshlrev_b32 v11, 4, v1
v_add_u32_e64 v11, s60, v11
s_lshl_b32 s61, s4, 8
s_add_u32 s61, s61, 151552
v_lshrrev_b32_e64 v12, 1, v1
v_lshl_add_u32 v12, v12, 2, s61
v_lshrrev_b32_e64 v13, 4, v1
v_lshl_add_u32 v13, v13, 5, s61
v_lshrrev_b32_e64 v3, 5, v1
v_mul_u32_u24 v3, 3072, v3
v_bfe_u32 v30, v1, 4, 1
v_lshl_add_u32 v3, v30, 9, v3
v_and_b32_e64 v30, 15, v1
v_lshl_add_u32 v14, v30, 4, v3
s_lshl_b32 s57, s7, 4
s_add_u32 s57, s57, s6
s_lshl_b32 s57, s57, 2
s_add_u32 s57, s57, s4
s_mul_i32 s57, s57, 6144
s_add_u32 s57, s57, 0
v_mov_b32 v16, 0xffff0000
s_waitcnt vmcnt(7)
s_barrier
s_load_dword s52, s[90:91], 128
s_add_u32 s61, s44, 2
s_and_b32 s61, s61, 7
s_lshl_b32 s58, s61, 7
s_add_u32 s62, s58, s53
s_add_u32 m0, s60, 57344
s_add_u32 s63, s62, 1024
buffer_load_dwordx4 v4, s[8:11], s62 offen lds
buffer_load_dwordx4 v5, s[8:11], s62 offen offset:1024 lds
s_add_u32 m0, s60, 59392
s_nop 0
buffer_load_dwordx4 v4, s[8:11], s63 offen lds
buffer_load_dwordx4 v5, s[8:11], s63 offen offset:1024 lds
s_mul_i32 s63, s61, 176128
s_add_u32 m0, s56, 73728
s_add_u32 s63, s63, s54
buffer_load_dwordx4 v23, s[12:15], s63 offen offset:0 lds
buffer_load_dwordx4 v24, s[12:15], s63 offen offset:1024 lds
buffer_load_dwordx4 v25, s[12:15], s63 offen offset:2048 lds
s_waitcnt lgkmcnt(0)
s_cmp_lg_u32 s52, 0
s_cbranch_scc1 Lok_8
s_mov_b32 s63, 0
Lspin_7:
s_sleep 2
v_mov_b32_e64 v31, 0
buffer_load_dword v30, v31, s[40:43], 0 offen sc1
s_waitcnt vmcnt(0)
s_add_u32 s63, s63, 1
s_cmp_gt_u32 s63, 32768
s_cbranch_scc1 Lok_8
v_readfirstlane_b32 s52, v30
s_cmp_lg_u32 s52, 0
s_cbranch_scc0 Lspin_7
Lok_8:
s_waitcnt vmcnt(7)
s_barrier
s_add_u32 s61, s44, 3
s_and_b32 s61, s61, 7
s_lshl_b32 s58, s61, 7
s_add_u32 s62, s58, s53
s_add_u32 m0, s60, 0
s_add_u32 s63, s62, 1024
buffer_load_dwordx4 v4, s[8:11], s62 offen lds
buffer_load_dwordx4 v5, s[8:11], s62 offen offset:1024 lds
s_add_u32 m0, s60, 2048
s_nop 0
buffer_load_dwordx4 v4, s[8:11], s63 offen lds
buffer_load_dwordx4 v5, s[8:11], s63 offen offset:1024 lds
s_mul_i32 s63, s61, 176128
s_add_u32 m0, s56, 16384
s_add_u32 s63, s63, s54
buffer_load_dwordx4 v23, s[12:15], s63 offen offset:0 lds
buffer_load_dwordx4 v24, s[12:15], s63 offen offset:1024 lds
buffer_load_dwordx4 v25, s[12:15], s63 offen offset:2048 lds
s_waitcnt vmcnt(7)
s_barrier
s_add_u32 s61, s44, 4
s_and_b32 s61, s61, 7
s_lshl_b32 s58, s61, 7
s_add_u32 s62, s58, s53
s_add_u32 m0, s60, 28672
s_add_u32 s63, s62, 1024
buffer_load_dwordx4 v4, s[8:11], s62 offen lds
buffer_load_dwordx4 v5, s[8:11], s62 offen offset:1024 lds
s_add_u32 m0, s60, 30720
s_nop 0
buffer_load_dwordx4 v4, s[8:11], s63 offen lds
buffer_load_dwordx4 v5, s[8:11], s63 offen offset:1024 lds
s_mul_i32 s63, s61, 176128
s_add_u32 m0, s56, 45056
s_add_u32 s63, s63, s54
buffer_load_dwordx4 v23, s[12:15], s63 offen offset:0 lds
buffer_load_dwordx4 v24, s[12:15], s63 offen offset:1024 lds
buffer_load_dwordx4 v25, s[12:15], s63 offen offset:2048 lds
s_waitcnt vmcnt(7)
s_barrier
s_add_u32 s61, s44, 5
s_and_b32 s61, s61, 7
s_lshl_b32 s58, s61, 7
s_add_u32 s62, s58, s53
s_add_u32 m0, s60, 57344
s_add_u32 s63, s62, 1024
buffer_load_dwordx4 v4, s[8:11], s62 offen lds
buffer_load_dwordx4 v5, s[8:11], s62 offen offset:1024 lds
s_add_u32 m0, s60, 59392
s_nop 0
buffer_load_dwordx4 v4, s[8:11], s63 offen lds
buffer_load_dwordx4 v5, s[8:11], s63 offen offset:1024 lds
s_mul_i32 s63, s61, 176128
s_add_u32 m0, s56, 73728
s_add_u32 s63, s63, s54
buffer_load_dwordx4 v23, s[12:15], s63 offen offset:0 lds
buffer_load_dwordx4 v24, s[12:15], s63 offen offset:1024 lds
buffer_load_dwordx4 v25, s[12:15], s63 offen offset:2048 lds
s_lshl_b32 s69, s6, 2
s_add_u32 s69, s69, s4
s_lshl_b32 s69, s69, 9
s_add_u32 s69, s69, 21495808
s_lshl_b32 s70, s6, 11
s_sub_u32 s70, s70, 256
s_max_i32 s70, s70, 0
s_add_u32 s70, s70, 21495808
v_lshlrev_b32_e64 v36, 3, v1
v_and_b32 v37, 0xff, v36
buffer_load_dwordx2 v[32:33], v36, s[16:19], s69 offen sc1
s_waitcnt vmcnt(8)
s_barrier
s_add_u32 s61, s44, 6
s_and_b32 s61, s61, 7
s_lshl_b32 s58, s61, 7
s_add_u32 s62, s58, s53
s_add_u32 m0, s60, 0
s_add_u32 s63, s62, 1024
buffer_load_dwordx4 v4, s[8:11], s62 offen lds
buffer_load_dwordx4 v5, s[8:11], s62 offen offset:1024 lds
s_add_u32 m0, s60, 2048
s_nop 0
buffer_load_dwordx4 v4, s[8:11], s63 offen lds
buffer_load_dwordx4 v5, s[8:11], s63 offen offset:1024 lds
s_mul_i32 s63, s61, 176128
s_add_u32 m0, s56, 16384
s_add_u32 s63, s63, s54
buffer_load_dwordx4 v23, s[12:15], s63 offen offset:0 lds
buffer_load_dwordx4 v24, s[12:15], s63 offen offset:1024 lds
buffer_load_dwordx4 v25, s[12:15], s63 offen offset:2048 lds
s_waitcnt vmcnt(8)
s_barrier
s_add_u32 s61, s44, 7
s_and_b32 s61, s61, 7
s_lshl_b32 s58, s61, 7
s_add_u32 s62, s58, s53
s_add_u32 m0, s60, 28672
s_add_u32 s63, s62, 1024
buffer_load_dwordx4 v4, s[8:11], s62 offen lds
buffer_load_dwordx4 v5, s[8:11], s62 offen offset:1024 lds
s_add_u32 m0, s60, 30720
s_nop 0
buffer_load_dwordx4 v4, s[8:11], s63 offen lds
buffer_load_dwordx4 v5, s[8:11], s63 offen offset:1024 lds
s_mul_i32 s63, s61, 176128
s_add_u32 m0, s56, 45056
s_add_u32 s63, s63, s54
buffer_load_dwordx4 v23, s[12:15], s63 offen offset:0 lds
buffer_load_dwordx4 v24, s[12:15], s63 offen offset:1024 lds
buffer_load_dwordx4 v25, s[12:15], s63 offen offset:2048 lds
s_waitcnt vmcnt(7)
s_barrier
v_cmp_ne_u32 vcc, s52, v33
s_cmp_eq_u64 vcc, 0
s_cbranch_scc1 Lok_10
s_mov_b32 s63, 0
Lspin_9:
buffer_load_dwordx2 v[32:33], v36, s[16:19], s69 offen sc1
s_waitcnt vmcnt(0)
s_add_u32 s63, s63, 1
s_cmp_gt_u32 s63, 32768
s_cbranch_scc1 Lok_10
v_cmp_ne_u32 vcc, s52, v33
s_cmp_eq_u64 vcc, 0
s_cbranch_scc0 Lspin_9
Lok_10:
v_bfe_u32 v38, v1, 1, 1
v_lshrrev_b32 v39, 2, v1
v_lshl_add_u32 v38, v38, 4, v39
s_lshl_b32 s61, s4, 7
s_add_u32 s61, s61, 159744
v_lshl_add_u32 v38, v38, 2, s61
v_mov_b32_dpp v33, v32 quad_perm:[1,0,3,2] row_mask:0xf bank_mask:0xf
v_rsq_f32 v34, v33
v_sqrt_f32 v33, v33
v_mul_f32 v35, v34, v34
v_mul_f32_e64 v35, v35, v34
v_mul_f32 v35, 0xbdd2d3e8, v35
v_mul_f32 v34, 0xc0135761, v34
s_mov_b32 exec_lo, 0x55555555
s_mov_b32 exec_hi, 0x55555555
ds_write_b32 v38, v32 offset:0
ds_write_b32 v38, v35 offset:640
ds_write_b32 v38, v34 offset:1280
ds_write_b32 v38, v33 offset:1920
s_mov_b64 exec, -1
s_waitcnt lgkmcnt(0)
s_add_u32 s61, s44, 0
s_and_b32 s61, s61, 7
s_mul_i32 s63, s61, 176128
s_add_u32 m0, s56, 86016
s_add_u32 s63, s63, s73
buffer_load_dwordx4 v23, s[12:15], s63 offen offset:0 lds
buffer_load_dwordx4 v24, s[12:15], s63 offen offset:1024 lds
buffer_load_dwordx4 v25, s[12:15], s63 offen offset:2048 lds
s_add_u32 s61, s44, 1
s_and_b32 s61, s61, 7
s_mul_i32 s63, s61, 176128
s_add_u32 m0, s56, 98304
s_add_u32 s63, s63, s73
buffer_load_dwordx4 v23, s[12:15], s63 offen offset:0 lds
buffer_load_dwordx4 v24, s[12:15], s63 offen offset:1024 lds
buffer_load_dwordx4 v25, s[12:15], s63 offen offset:2048 lds
s_waitcnt vmcnt(6)
s_barrier
s_add_u32 s61, s44, 2
s_and_b32 s61, s61, 7
s_mul_i32 s63, s61, 176128
s_add_u32 m0, s56, 110592
s_add_u32 s63, s63, s73
buffer_load_dwordx4 v23, s[12:15], s63 offen offset:0 lds
buffer_load_dwordx4 v24, s[12:15], s63 offen offset:1024 lds
buffer_load_dwordx4 v25, s[12:15], s63 offen offset:2048 lds
s_add_u32 s61, s44, 3
s_and_b32 s61, s61, 7
s_mul_i32 s63, s61, 176128
s_add_u32 m0, s56, 122880
s_add_u32 s63, s63, s73
buffer_load_dwordx4 v23, s[12:15], s63 offen offset:0 lds
buffer_load_dwordx4 v24, s[12:15], s63 offen offset:1024 lds
buffer_load_dwordx4 v25, s[12:15], s63 offen offset:2048 lds
s_add_u32 s61, s44, 4
s_and_b32 s61, s61, 7
s_mul_i32 s63, s61, 176128
s_add_u32 m0, s56, 135168
s_add_u32 s63, s63, s73
buffer_load_dwordx4 v23, s[12:15], s63 offen offset:0 lds
buffer_load_dwordx4 v24, s[12:15], s63 offen offset:1024 lds
buffer_load_dwordx4 v25, s[12:15], s63 offen offset:2048 lds
s_add_u32 s61, s44, 5
s_and_b32 s61, s61, 7
s_mul_i32 s63, s61, 176128
s_add_u32 m0, s56, 147456
s_add_u32 s63, s63, s73
buffer_load_dwordx4 v23, s[12:15], s63 offen offset:0 lds
buffer_load_dwordx4 v24, s[12:15], s63 offen offset:1024 lds
buffer_load_dwordx4 v25, s[12:15], s63 offen offset:2048 lds
s_add_u32 s61, s44, 6
s_and_b32 s61, s61, 7
s_mul_i32 s63, s61, 176128
s_add_u32 m0, s56, 61440
s_add_u32 s63, s63, s73
buffer_load_dwordx4 v23, s[12:15], s63 offen offset:0 lds
buffer_load_dwordx4 v24, s[12:15], s63 offen offset:1024 lds
buffer_load_dwordx4 v25, s[12:15], s63 offen offset:2048 lds
s_add_u32 s61, s44, 7
s_and_b32 s61, s61, 7
s_mul_i32 s63, s61, 176128
s_add_u32 m0, s56, 73728
s_add_u32 s63, s63, s73
buffer_load_dwordx4 v23, s[12:15], s63 offen offset:0 lds
buffer_load_dwordx4 v24, s[12:15], s63 offen offset:1024 lds
buffer_load_dwordx4 v25, s[12:15], s63 offen offset:2048 lds
v_bfe_u32 v3, v1, 4, 1
v_lshlrev_b32 v3, 2, v3
v_and_b32 v30, 7, v1
v_xor_b32 v30, v30, v3
v_lshrrev_b32 v3, 3, v1
v_lshlrev_b32_e64 v3, 10, v3
v_lshl_add_u32 v26, v30, 4, v3
s_lshl_b32 s47, s50, 7
s_lshl_b32 s61, s4, 13
s_add_u32 s47, s47, s61
s_add_u32 s46, s47, 0
buffer_load_dwordx4 v[104:107], v26, s[24:27], s46 offen
s_add_u32 s46, s47, 32768
buffer_load_dwordx4 v[108:111], v26, s[24:27], s46 offen
s_add_u32 s46, s47, 65536
buffer_load_dwordx4 v[112:115], v26, s[24:27], s46 offen
s_add_u32 s46, s47, 98304
buffer_load_dwordx4 v[116:119], v26, s[24:27], s46 offen
s_add_u32 s46, s47, 131072
buffer_load_dwordx4 v[120:123], v26, s[24:27], s46 offen
s_add_u32 s46, s47, 163840
buffer_load_dwordx4 v[124:127], v26, s[24:27], s46 offen
s_add_u32 s46, s47, 196608
buffer_load_dwordx4 v[128:131], v26, s[24:27], s46 offen
s_add_u32 s46, s47, 229376
buffer_load_dwordx4 v[132:135], v26, s[24:27], s46 offen
s_add_u32 s46, s47, 262144
buffer_load_dwordx4 v[136:139], v26, s[24:27], s46 offen
s_add_u32 s46, s47, 294912
buffer_load_dwordx4 v[140:143], v26, s[24:27], s46 offen
s_add_u32 s46, s47, 327680
buffer_load_dwordx4 v[144:147], v26, s[24:27], s46 offen
s_add_u32 s46, s47, 360448
buffer_load_dwordx4 v[148:151], v26, s[24:27], s46 offen
s_add_u32 s46, s47, 393216
buffer_load_dwordx4 v[152:155], v26, s[24:27], s46 offen
s_add_u32 s46, s47, 425984
buffer_load_dwordx4 v[156:159], v26, s[24:27], s46 offen
s_add_u32 s46, s47, 458752
buffer_load_dwordx4 v[160:163], v26, s[24:27], s46 offen
s_add_u32 s46, s47, 491520
buffer_load_dwordx4 v[164:167], v26, s[24:27], s46 offen
s_waitcnt vmcnt(16)
s_barrier
s_setprio 3
ds_read_b128 v[60:63], v11 offset:0
ds_read_b128 v[68:71], v11 offset:1024
ds_read_b128 v[76:79], v11 offset:2048
ds_read_b128 v[84:87], v11 offset:3072
ds_read_b128 v[92:95], v11 offset:16384
ds_read_b128 v[100:103], v11 offset:17408
s_waitcnt lgkmcnt(0)
v_lshlrev_b32 v56, 16, v60
v_and_b32 v57, v16, v60
v_lshlrev_b32 v58, 16, v61
v_and_b32 v59, v16, v61
v_lshlrev_b32 v60, 16, v62
v_and_b32 v61, v16, v62
v_lshlrev_b32 v62, 16, v63
v_and_b32 v63, v16, v63
v_lshlrev_b32 v64, 16, v68
v_and_b32 v65, v16, v68
v_lshlrev_b32 v66, 16, v69
v_and_b32 v67, v16, v69
v_lshlrev_b32 v68, 16, v70
v_and_b32 v69, v16, v70
v_lshlrev_b32 v70, 16, v71
v_and_b32 v71, v16, v71
v_lshlrev_b32 v72, 16, v76
v_and_b32 v73, v16, v76
v_lshlrev_b32 v74, 16, v77
v_and_b32 v75, v16, v77
v_lshlrev_b32 v76, 16, v78
v_and_b32 v77, v16, v78
v_lshlrev_b32 v78, 16, v79
v_and_b32 v79, v16, v79
v_lshlrev_b32 v80, 16, v84
v_and_b32 v81, v16, v84
v_lshlrev_b32 v82, 16, v85
v_and_b32 v83, v16, v85
v_lshlrev_b32 v84, 16, v86
v_and_b32 v85, v16, v86
v_lshlrev_b32 v86, 16, v87
v_and_b32 v87, v16, v87
v_lshlrev_b32 v88, 16, v92
v_and_b32 v89, v16, v92
v_lshlrev_b32 v90, 16, v93
v_and_b32 v91, v16, v93
v_lshlrev_b32 v92, 16, v94
v_and_b32 v93, v16, v94
v_lshlrev_b32 v94, 16, v95
v_and_b32 v95, v16, v95
v_lshlrev_b32 v96, 16, v100
v_and_b32 v97, v16, v100
v_lshlrev_b32 v98, 16, v101
v_and_b32 v99, v16, v101
v_lshlrev_b32 v100, 16, v102
v_and_b32 v101, v16, v102
v_lshlrev_b32 v102, 16, v103
v_and_b32_e64 v103, v16, v103
s_mul_i32 s62, s7, 6
s_add_u32 s58, s62, 5
s_min_u32 s58, s58, 43
s_sub_u32 s62, s62, 1
s_max_i32 s62, s62, 0
s_sub_u32 s58, s58, s62
s_sleep 8
buffer_load_dwordx2 v[32:33], v10, s[16:19], s64 offen offset:0 sc1
buffer_load_dwordx2 v[34:35], v10, s[16:19], s64 offen offset:2048 sc1
buffer_load_dwordx2 v[36:37], v10, s[16:19], s65 offen offset:0 sc1
buffer_load_dwordx2 v[38:39], v10, s[16:19], s65 offen offset:2048 sc1
buffer_load_dwordx2 v[40:41], v10, s[16:19], s66 offen offset:0 sc1
buffer_load_dwordx2 v[42:43], v10, s[16:19], s66 offen offset:2048 sc1
buffer_load_dwordx2 v[44:45], v10, s[16:19], s67 offen offset:0 sc1
buffer_load_dwordx2 v[46:47], v10, s[16:19], s67 offen offset:2048 sc1
s_waitcnt vmcnt(0)
v_xor_b32 v48, s52, v33
v_xor_b32 v49, s52, v35
v_xor_b32 v50, s52, v37
v_xor_b32 v51, s52, v39
v_xor_b32 v52, s52, v41
v_xor_b32 v53, s52, v43
v_xor_b32 v54, s52, v45
v_xor_b32_e64 v55, s52, v47
v_or3_b32 v48, v48, v49, v50
v_or3_b32 v51, v51, v52, v53
v_or3_b32 v48, v48, v54, v55
v_or_b32_e64 v48, v48, v51
v_cmp_ne_u32 vcc, 0, v48
s_cmp_eq_u64 vcc, 0
s_cbranch_scc1 Lok_12
s_mov_b32 s63, 0
Lspin_11:
buffer_load_dwordx2 v[32:33], v10, s[16:19], s64 offen offset:0 sc1
buffer_load_dwordx2 v[34:35], v10, s[16:19], s64 offen offset:2048 sc1
buffer_load_dwordx2 v[36:37], v10, s[16:19], s65 offen offset:0 sc1
buffer_load_dwordx2 v[38:39], v10, s[16:19], s65 offen offset:2048 sc1
buffer_load_dwordx2 v[40:41], v10, s[16:19], s66 offen offset:0 sc1
buffer_load_dwordx2 v[42:43], v10, s[16:19], s66 offen offset:2048 sc1
buffer_load_dwordx2 v[44:45], v10, s[16:19], s67 offen offset:0 sc1
buffer_load_dwordx2 v[46:47], v10, s[16:19], s67 offen offset:2048 sc1
s_waitcnt vmcnt(0)
s_add_u32 s63, s63, 1
s_cmp_gt_u32 s63, 32768
s_cbranch_scc1 Lok_12
v_xor_b32 v48, s52, v33
v_xor_b32 v49, s52, v35
v_xor_b32 v50, s52, v37
v_xor_b32 v51, s52, v39
v_xor_b32 v52, s52, v41
v_xor_b32 v53, s52, v43
v_xor_b32 v54, s52, v45
v_xor_b32_e64 v55, s52, v47
v_or3_b32 v48, v48, v49, v50
v_or3_b32 v51, v51, v52, v53
v_or3_b32 v48, v48, v54, v55
v_or_b32 v48, v48, v51
v_cmp_ne_u32 vcc, 0, v48
s_cmp_eq_u64 vcc, 0
s_cbranch_scc0 Lspin_11
Lok_12:
v_add_f32 v36, v36, v38
v_add_f32 v40, v40, v42
v_add_f32 v44, v44, v46
v_add_f32 v32, v32, v34
v_add_f32 v36, v36, v40
v_add_f32 v32, v32, v44
v_add_f32_e64 v32, v32, v36
v_mul_f32 v32, 0x3abe82fa, v32
s_nop 1
v_mov_b32_dpp v33, v32 quad_perm:[1,0,3,2] row_mask:0xf bank_mask:0xf
v_fma_f32 v33, -v32, v32, v33
v_max_f32 v33, 0, v33
v_add_f32 v33, 0x3727c5ac, v33
v_rsq_f32 v33, v33
s_nop 0
v_mul_f32_e64 v48, -v32, v33
v_mov_b32 v49, v33
s_nop 0
v_mov_b32_dpp v40, v48 row_newbcast:0 row_mask:0xf bank_mask:0xf
v_mov_b32_dpp v41, v48 row_newbcast:2 row_mask:0xf bank_mask:0xf
v_mov_b32_dpp v42, v48 row_newbcast:4 row_mask:0xf bank_mask:0xf
v_mov_b32_dpp v43, v48 row_newbcast:6 row_mask:0xf bank_mask:0xf
v_mov_b32_dpp v44, v48 row_newbcast:8 row_mask:0xf bank_mask:0xf
v_mov_b32_dpp v45, v48 row_newbcast:10 row_mask:0xf bank_mask:0xf
v_mov_b32_dpp v46, v48 row_newbcast:12 row_mask:0xf bank_mask:0xf
v_mov_b32_dpp v47, v48 row_newbcast:14 row_mask:0xf bank_mask:0xf
v_mov_b32_dpp v32, v49 row_newbcast:0 row_mask:0xf bank_mask:0xf
v_mov_b32_dpp v33, v49 row_newbcast:2 row_mask:0xf bank_mask:0xf
v_mov_b32_dpp v34, v49 row_newbcast:4 row_mask:0xf bank_mask:0xf
v_mov_b32_dpp v35, v49 row_newbcast:6 row_mask:0xf bank_mask:0xf
v_mov_b32_dpp v36, v49 row_newbcast:8 row_mask:0xf bank_mask:0xf
v_mov_b32_dpp v37, v49 row_newbcast:10 row_mask:0xf bank_mask:0xf
v_mov_b32_dpp v38, v49 row_newbcast:12 row_mask:0xf bank_mask:0xf
v_mov_b32_dpp v39, v49 row_newbcast:14 row_mask:0xf bank_mask:0xf
v_fma_f32 v56, v56, v32, v40
v_fma_f32 v57, v57, v33, v41
v_fma_f32 v58, v58, v34, v42
v_fma_f32 v59, v59, v35, v43
v_fma_f32 v60, v60, v36, v44
v_fma_f32 v61, v61, v37, v45
v_fma_f32 v62, v62, v38, v46
v_fma_f32 v63, v63, v39, v47
v_cvt_pk_bf16_f32 v56, v56, v57
v_cvt_pk_bf16_f32 v57, v58, v59
v_cvt_pk_bf16_f32 v58, v60, v61
v_cvt_pk_bf16_f32 v59, v62, v63
s_cmp_gt_u32 s58, 0
s_cselect_b32 s61, s57, 268435456
buffer_store_dwordx4 v[56:59], v14, s[16:19], s61 offen offset:0 sc1
s_nop 0
v_fma_f32 v64, v64, v32, v40
v_fma_f32 v65, v65, v33, v41
v_fma_f32 v66, v66, v34, v42
v_fma_f32 v67, v67, v35, v43
v_fma_f32 v68, v68, v36, v44
v_fma_f32 v69, v69, v37, v45
v_fma_f32 v70, v70, v38, v46
v_fma_f32 v71, v71, v39, v47
v_cvt_pk_bf16_f32 v64, v64, v65
v_cvt_pk_bf16_f32 v65, v66, v67
v_cvt_pk_bf16_f32 v66, v68, v69
v_cvt_pk_bf16_f32 v67, v70, v71
s_cmp_gt_u32 s58, 1
s_cselect_b32 s61, s57, 268435456
buffer_store_dwordx4 v[64:67], v14, s[16:19], s61 offen offset:256 sc1
s_nop 0
v_fma_f32 v72, v72, v32, v40
v_fma_f32 v73, v73, v33, v41
v_fma_f32 v74, v74, v34, v42
v_fma_f32 v75, v75, v35, v43
v_fma_f32 v76, v76, v36, v44
v_fma_f32 v77, v77, v37, v45
v_fma_f32 v78, v78, v38, v46
v_fma_f32 v79, v79, v39, v47
v_cvt_pk_bf16_f32 v72, v72, v73
v_cvt_pk_bf16_f32 v73, v74, v75
v_cvt_pk_bf16_f32 v74, v76, v77
v_cvt_pk_bf16_f32 v75, v78, v79
s_cmp_gt_u32 s58, 2
s_cselect_b32 s61, s57, 268435456
buffer_store_dwordx4 v[72:75], v14, s[16:19], s61 offen offset:1024 sc1
s_nop 0
v_fma_f32 v80, v80, v32, v40
v_fma_f32 v81, v81, v33, v41
v_fma_f32 v82, v82, v34, v42
v_fma_f32 v83, v83, v35, v43
v_fma_f32 v84, v84, v36, v44
v_fma_f32 v85, v85, v37, v45
v_fma_f32 v86, v86, v38, v46
v_fma_f32 v87, v87, v39, v47
v_cvt_pk_bf16_f32 v80, v80, v81
v_cvt_pk_bf16_f32 v81, v82, v83
v_cvt_pk_bf16_f32 v82, v84, v85
v_cvt_pk_bf16_f32 v83, v86, v87
s_cmp_gt_u32 s58, 3
s_cselect_b32 s61, s57, 268435456
buffer_store_dwordx4 v[80:83], v14, s[16:19], s61 offen offset:1280 sc1
s_nop 0
v_fma_f32 v88, v88, v32, v40
v_fma_f32 v89, v89, v33, v41
v_fma_f32 v90, v90, v34, v42
v_fma_f32 v91, v91, v35, v43
v_fma_f32 v92, v92, v36, v44
v_fma_f32 v93, v93, v37, v45
v_fma_f32 v94, v94, v38, v46
v_fma_f32 v95, v95, v39, v47
v_cvt_pk_bf16_f32 v88, v88, v89
v_cvt_pk_bf16_f32 v89, v90, v91
v_cvt_pk_bf16_f32 v90, v92, v93
v_cvt_pk_bf16_f32 v91, v94, v95
s_cmp_gt_u32 s58, 4
s_cselect_b32 s61, s57, 268435456
buffer_store_dwordx4 v[88:91], v14, s[16:19], s61 offen offset:2048 sc1
s_nop 0
v_fma_f32 v96, v96, v32, v40
v_fma_f32 v97, v97, v33, v41
v_fma_f32 v98, v98, v34, v42
v_fma_f32 v99, v99, v35, v43
v_fma_f32 v100, v100, v36, v44
v_fma_f32 v101, v101, v37, v45
v_fma_f32 v102, v102, v38, v46
v_fma_f32 v103, v103, v39, v47
v_cvt_pk_bf16_f32 v96, v96, v97
v_cvt_pk_bf16_f32 v97, v98, v99
v_cvt_pk_bf16_f32 v98, v100, v101
v_cvt_pk_bf16_f32 v99, v102, v103
s_cmp_gt_u32 s58, 5
s_cselect_b32 s61, s57, 268435456
buffer_store_dwordx4 v[96:99], v14, s[16:19], s61 offen offset:2304 sc1
s_setprio 0
s_waitcnt vmcnt(0)
s_lshl_b32 s61, s7, 4
s_add_u32 s61, s61, s6
s_lshl_b32 s61, s61, 2
s_add_u32 s61, s61, s4
s_lshl_b32 s61, s61, 7
s_add_u32 s61, s61, 22020096
v_mov_b32 v30, s52
v_mov_b32_e64 v31, 0
s_mov_b64 exec, 1
buffer_store_dword v30, v31, s[16:19], s61 offen sc1
s_mov_b64 exec, -1
s_add_u32 s61, s51, 0
s_and_b32 s61, s61, 15
s_lshl_b32 s61, s61, 7
s_add_u32 s61, s61, s59
s_add_u32 m0, s60, 0
s_add_u32 s62, s61, 4096
buffer_load_dwordx4 v8, s[20:23], s61 offen lds
buffer_load_dwordx4 v9, s[20:23], s61 offen offset:1024 lds
s_add_u32 m0, s60, 2048
s_nop 0
buffer_load_dwordx4 v8, s[20:23], s62 offen lds
buffer_load_dwordx4 v9, s[20:23], s62 offen offset:1024 lds
s_add_u32 s61, s51, 1
s_and_b32 s61, s61, 15
s_lshl_b32 s61, s61, 7
s_add_u32 s61, s61, s59
s_add_u32 m0, s60, 16384
s_add_u32 s62, s61, 4096
buffer_load_dwordx4 v8, s[20:23], s61 offen lds
buffer_load_dwordx4 v9, s[20:23], s61 offen offset:1024 lds
s_add_u32 m0, s60, 18432
s_nop 0
buffer_load_dwordx4 v8, s[20:23], s62 offen lds
buffer_load_dwordx4 v9, s[20:23], s62 offen offset:1024 lds
s_add_u32 s61, s51, 2
s_and_b32 s61, s61, 15
s_lshl_b32 s61, s61, 7
s_add_u32 s61, s61, s59
s_add_u32 m0, s60, 32768
s_add_u32 s62, s61, 4096
buffer_load_dwordx4 v8, s[20:23], s61 offen lds
buffer_load_dwordx4 v9, s[20:23], s61 offen offset:1024 lds
s_add_u32 m0, s60, 34816
s_nop 0
buffer_load_dwordx4 v8, s[20:23], s62 offen lds
buffer_load_dwordx4 v9, s[20:23], s62 offen offset:1024 lds
v_mov_b32 v30, 163344
s_mov_b32 s63, 0
Llw_13:
ds_read_b128 v[32:35], v30
s_add_u32 s63, s63, 1
s_waitcnt lgkmcnt(0)
v_and_b32 v32, v32, v33
v_and_b32 v34, v34, v35
v_and_b32_e64 v32, v32, v34
v_cmp_ne_u32 vcc, 0, v32
s_cbranch_vccnz Llk_14
s_cmp_lt_u32 s63, 0x100000
s_cbranch_scc1 Llw_13
Llk_14:
s_add_u32 s61, s51, 3
s_and_b32 s61, s61, 15
s_lshl_b32 s61, s61, 7
s_add_u32 s61, s61, s59
s_add_u32 m0, s60, 49152
s_add_u32 s62, s61, 4096
buffer_load_dwordx4 v8, s[20:23], s61 offen lds
buffer_load_dwordx4 v9, s[20:23], s61 offen offset:1024 lds
s_add_u32 m0, s60, 51200
s_nop 0
buffer_load_dwordx4 v8, s[20:23], s62 offen lds
buffer_load_dwordx4 v9, s[20:23], s62 offen offset:1024 lds
s_mov_b32 s72, 4
LF_hb:
v_lshlrev_b32 v10, 4, v1
s_lshl_b32 s61, s4, 10
v_add_u32 v27, s61, v10
v_add_u32 v28, 0x10000, v27
v_add_u32 v29, 0x20000, v27
s_lshl_b32 s53, s50, 1
s_add_u32 s53, s53, s48
s_mul_i32 s53, s53, 196608
s_mul_i32 s54, s4, 3072
s_add_u32 s53, s53, s54
s_add_u32 s53, s53, 0
s_add_u32 s54, s54, 114688
s_mul_i32 s61, s50, 6
s_add_u32 s62, s61, 5
s_min_u32 s62, s62, 43
s_sub_u32 s61, s61, 1
s_max_i32 s61, s61, 0
s_sub_u32 s62, s62, s61
v_bfe_u32 v3, v1, 4, 1
v_add_u32_e64 v30, 2, v3
v_cmp_le_u32 vcc, s62, v30
s_nop 1
v_cndmask_b32_e64 v30, 0, 1, vcc
v_lshl_add_u32 v14, v30, 28, v10
v_add_u32_e64 v30, 4, v3
v_cmp_le_u32 vcc, s62, v30
s_nop 1
v_cndmask_b32_e64 v30, 0, 1, vcc
v_lshl_add_u32 v15, v30, 28, v10
s_lshl_b32 s71, s50, 1
s_add_u32 s71, s71, s48
s_lshl_b32 s71, s71, 12
s_add_u32 s71, s71, 22020096
v_and_b32 v31, 31, v1
v_lshlrev_b32 v31, 7, v31
v_mov_b32 v30, 0
buffer_load_dword v30, v31, s[16:19], s71 offen sc1
s_waitcnt vmcnt(0)
s_cmp_ge_u32 s72, 7
s_cbranch_scc1 LfB_16
v_cmp_ne_u32 vcc, s52, v30
s_cmp_eq_u64 vcc, 0
s_cbranch_scc1 LfA_15
s_add_u32 s61, s51, 4
s_and_b32 s61, s61, 15
s_lshl_b32 s61, s61, 7
s_add_u32 s61, s61, s59
s_add_u32 m0, s60, 65536
s_add_u32 s62, s61, 4096
buffer_load_dwordx4 v8, s[20:23], s61 offen lds
buffer_load_dwordx4 v9, s[20:23], s61 offen offset:1024 lds
s_add_u32 m0, s60, 67584
s_nop 0
buffer_load_dwordx4 v8, s[20:23], s62 offen lds
buffer_load_dwordx4 v9, s[20:23], s62 offen offset:1024 lds
s_mov_b32 s72, 5
buffer_load_dword v30, v31, s[16:19], s71 offen sc1
s_waitcnt vmcnt(0)
v_cmp_ne_u32 vcc, s52, v30
s_cmp_eq_u64 vcc, 0
s_cbranch_scc1 LfA_15
s_add_u32 s61, s51, 5
s_and_b32 s61, s61, 15
s_lshl_b32 s61, s61, 7
s_add_u32 s61, s61, s59
s_add_u32 m0, s60, 81920
s_add_u32 s62, s61, 4096
buffer_load_dwordx4 v8, s[20:23], s61 offen lds
buffer_load_dwordx4 v9, s[20:23], s61 offen offset:1024 lds
s_add_u32 m0, s60, 83968
s_nop 0
buffer_load_dwordx4 v8, s[20:23], s62 offen lds
buffer_load_dwordx4 v9, s[20:23], s62 offen offset:1024 lds
s_mov_b32 s72, 6
buffer_load_dword v30, v31, s[16:19], s71 offen sc1
s_waitcnt vmcnt(0)
v_cmp_ne_u32 vcc, s52, v30
s_cmp_eq_u64 vcc, 0
s_cbranch_scc1 LfA_15
s_add_u32 s61, s51, 6
s_and_b32 s61, s61, 15
s_lshl_b32 s61, s61, 7
s_add_u32 s61, s61, s59
s_add_u32 m0, s60, 98304
s_add_u32 s62, s61, 4096
buffer_load_dwordx4 v8, s[20:23], s61 offen lds
buffer_load_dwordx4 v9, s[20:23], s61 offen offset:1024 lds
s_add_u32 m0, s60, 100352
s_nop 0
buffer_load_dwordx4 v8, s[20:23], s62 offen lds
buffer_load_dwordx4 v9, s[20:23], s62 offen offset:1024 lds
s_mov_b32 s72, 7
buffer_load_dword v30, v31, s[16:19], s71 offen sc1
s_waitcnt vmcnt(0)
LfB_16:
v_cmp_ne_u32 vcc, s52, v30
s_cmp_eq_u64 vcc, 0
s_cbranch_scc1 Lok_18
s_mov_b32 s63, 0
Lspin_17:
buffer_load_dword v30, v31, s[16:19], s71 offen sc1
s_waitcnt vmcnt(0)
s_add_u32 s63, s63, 1
s_cmp_gt_u32 s63, 32768
s_cbranch_scc1 Lok_18
v_cmp_ne_u32 vcc, s52, v30
s_cmp_eq_u64 vcc, 0
s_cbranch_scc0 Lspin_17
Lok_18:
s_waitcnt vmcnt(0)
LfA_15:
s_add_u32 s61, s51, 0
s_and_b32 s61, s61, 15
s_mul_i32 s61, s61, 12288
s_add_u32 m0, s54, 0
s_add_u32 s61, s61, s53
buffer_load_dwordx4 v10, s[16:19], s61 offen offset:0 sc1 lds
buffer_load_dwordx4 v14, s[16:19], s61 offen offset:1024 sc1 lds
buffer_load_dwordx4 v15, s[16:19], s61 offen offset:2048 sc1 lds
s_add_u32 s61, s51, 1
s_and_b32 s61, s61, 15
s_mul_i32 s61, s61, 12288
s_add_u32 m0, s54, 12288
s_add_u32 s61, s61, s53
buffer_load_dwordx4 v10, s[16:19], s61 offen offset:0 sc1 lds
buffer_load_dwordx4 v14, s[16:19], s61 offen offset:1024 sc1 lds
buffer_load_dwordx4 v15, s[16:19], s61 offen offset:2048 sc1 lds
s_add_u32 s61, s51, 2
s_and_b32 s61, s61, 15
s_mul_i32 s61, s61, 12288
s_add_u32 m0, s54, 24576
s_add_u32 s61, s61, s53
buffer_load_dwordx4 v10, s[16:19], s61 offen offset:0 sc1 lds
buffer_load_dwordx4 v14, s[16:19], s61 offen offset:1024 sc1 lds
buffer_load_dwordx4 v15, s[16:19], s61 offen offset:2048 sc1 lds
v_mov_b32 v25, 256
s_barrier
v_add_u32 v18, 4096, v8
v_add_u32 v19, 4096, v9
s_lshl_b32 s76, s4, 10
s_waitcnt vmcnt(6)
s_barrier
s_cmp_gt_u32 s72, 4
s_cbranch_scc1 Lld_19
s_add_u32 s61, s51, 4
s_and_b32 s61, s61, 15
s_lshl_b32 s61, s61, 7
s_add_u32 s61, s61, s59
s_add_u32 m0, s60, 65536
s_add_u32 s62, s61, 4096
buffer_load_dwordx4 v8, s[20:23], s61 offen lds
buffer_load_dwordx4 v9, s[20:23], s61 offen offset:1024 lds
s_add_u32 m0, s60, 67584
s_nop 0
buffer_load_dwordx4 v8, s[20:23], s62 offen lds
buffer_load_dwordx4 v9, s[20:23], s62 offen offset:1024 lds
s_branch Lle_20
Lld_19:
s_mov_b64 exec, 1
buffer_load_dword v24, v25, s[40:43], 0 offen
buffer_load_dword v24, v25, s[40:43], 0 offen
buffer_load_dword v24, v25, s[40:43], 0 offen
buffer_load_dword v24, v25, s[40:43], 0 offen
s_mov_b64 exec, -1
Lle_20:
s_cmp_gt_u32 s72, 5
s_cbranch_scc1 Lld_21
s_add_u32 s61, s51, 5
s_and_b32 s61, s61, 15
s_lshl_b32 s61, s61, 7
s_add_u32 s61, s61, s59
s_add_u32 m0, s60, 81920
s_add_u32 s62, s61, 4096
buffer_load_dwordx4 v8, s[20:23], s61 offen lds
buffer_load_dwordx4 v9, s[20:23], s61 offen offset:1024 lds
s_add_u32 m0, s60, 83968
s_nop 0
buffer_load_dwordx4 v8, s[20:23], s62 offen lds
buffer_load_dwordx4 v9, s[20:23], s62 offen offset:1024 lds
s_branch Lle_22
Lld_21:
s_mov_b64 exec, 1
buffer_load_dword v24, v25, s[40:43], 0 offen
buffer_load_dword v24, v25, s[40:43], 0 offen
buffer_load_dword v24, v25, s[40:43], 0 offen
buffer_load_dword v24, v25, s[40:43], 0 offen
s_mov_b64 exec, -1
Lle_22:
s_add_u32 s61, s51, 3
s_and_b32 s61, s61, 15
s_mul_i32 s61, s61, 12288
s_add_u32 m0, s54, 36864
s_add_u32 s61, s61, s53
buffer_load_dwordx4 v10, s[16:19], s61 offen offset:0 sc1 lds
buffer_load_dwordx4 v14, s[16:19], s61 offen offset:1024 sc1 lds
buffer_load_dwordx4 v15, s[16:19], s61 offen offset:2048 sc1 lds
s_waitcnt vmcnt(14)
s_barrier
s_cmp_gt_u32 s72, 6
s_cbranch_scc1 Lld_23
s_add_u32 s61, s51, 6
s_and_b32 s61, s61, 15
s_lshl_b32 s61, s61, 7
s_add_u32 s61, s61, s59
s_add_u32 m0, s60, 98304
s_add_u32 s62, s61, 4096
buffer_load_dwordx4 v8, s[20:23], s61 offen lds
buffer_load_dwordx4 v9, s[20:23], s61 offen offset:1024 lds
s_add_u32 m0, s60, 100352
s_nop 0
buffer_load_dwordx4 v8, s[20:23], s62 offen lds
buffer_load_dwordx4 v9, s[20:23], s62 offen offset:1024 lds
s_branch Lle_24
Lld_23:
s_mov_b64 exec, 1
buffer_load_dword v24, v25, s[40:43], 0 offen
buffer_load_dword v24, v25, s[40:43], 0 offen
buffer_load_dword v24, v25, s[40:43], 0 offen
buffer_load_dword v24, v25, s[40:43], 0 offen
s_mov_b64 exec, -1
Lle_24:
s_add_u32 s61, s51, 4
s_and_b32 s61, s61, 15
s_mul_i32 s61, s61, 12288
s_add_u32 m0, s54, 0
s_add_u32 s61, s61, s53
buffer_load_dwordx4 v10, s[16:19], s61 offen offset:0 sc1 lds
buffer_load_dwordx4 v14, s[16:19], s61 offen offset:1024 sc1 lds
buffer_load_dwordx4 v15, s[16:19], s61 offen offset:2048 sc1 lds
s_add_u32 s58, s51, 7
s_and_b32 s58, s58, 15
s_lshl_b32 s58, s58, 7
s_add_u32 s58, s58, s59
s_add_u32 m0, s60, 0
s_nop 0
buffer_load_dwordx4 v8, s[20:23], s58 offen offset:0 lds
s_add_u32 m0, s60, 0
s_nop 0
buffer_load_dwordx4 v9, s[20:23], s58 offen offset:1024 lds
s_add_u32 m0, s60, 2048
s_nop 0
buffer_load_dwordx4 v18, s[20:23], s58 offen offset:0 lds
s_waitcnt vmcnt(21)
s_barrier
s_lshl_b32 s61, s6, 1
s_add_u32 s61, s61, s45
s_lshl_b32 s61, s61, 3
s_add_u32 s61, s61, s7
s_lshl_b32 s61, s61, 7
s_add_u32 s61, s61, 22085632
s_cmp_eq_u32 s4, 0
s_cselect_b32 s61, s61, 268435456
v_mov_b32 v30, s52
v_mov_b32_e64 v31, 0
s_mov_b64 exec, 1
buffer_store_dword v30, v31, s[16:19], s61 offen sc1
s_mov_b64 exec, -1
s_add_u32 s61, s51, 5
s_and_b32 s61, s61, 15
s_mul_i32 s61, s61, 12288
s_add_u32 m0, s54, 12288
s_add_u32 s61, s61, s53
buffer_load_dwordx4 v10, s[16:19], s61 offen offset:0 sc1 lds
buffer_load_dwordx4 v14, s[16:19], s61 offen offset:1024 sc1 lds
buffer_load_dwordx4 v15, s[16:19], s61 offen offset:2048 sc1 lds
s_add_u32 m0, s60, 2048
s_nop 0
buffer_load_dwordx4 v19, s[20:23], s58 offen offset:1024 lds
s_add_u32 s58, s51, 8
s_and_b32 s58, s58, 15
s_lshl_b32 s58, s58, 7
s_add_u32 s58, s58, s59
s_add_u32 m0, s60, 16384
s_nop 0
buffer_load_dwordx4 v8, s[20:23], s58 offen offset:0 lds
s_add_u32 m0, s60, 16384
s_nop 0
buffer_load_dwordx4 v9, s[20:23], s58 offen offset:1024 lds
s_waitcnt vmcnt(17)
s_barrier
s_add_u32 s61, s51, 6
s_and_b32 s61, s61, 15
s_mul_i32 s61, s61, 12288
s_add_u32 m0, s54, 24576
s_add_u32 s61, s61, s53
buffer_load_dwordx4 v10, s[16:19], s61 offen offset:0 sc1 lds
buffer_load_dwordx4 v14, s[16:19], s61 offen offset:1024 sc1 lds
buffer_load_dwordx4 v15, s[16:19], s61 offen offset:2048 sc1 lds
s_add_u32 m0, s60, 18432
s_nop 0
buffer_load_dwordx4 v18, s[20:23], s58 offen offset:0 lds
s_add_u32 m0, s60, 18432
s_nop 0
buffer_load_dwordx4 v19, s[20:23], s58 offen offset:1024 lds
s_add_u32 s58, s51, 9
s_and_b32 s58, s58, 15
s_lshl_b32 s58, s58, 7
s_add_u32 s58, s58, s59
s_add_u32 m0, s60, 32768
s_nop 0
buffer_load_dwordx4 v8, s[20:23], s58 offen offset:0 lds
s_waitcnt vmcnt(16)
s_barrier
s_add_u32 s61, s51, 7
s_and_b32 s61, s61, 15
s_mul_i32 s61, s61, 12288
s_add_u32 m0, s54, 36864
s_add_u32 s61, s61, s53
buffer_load_dwordx4 v10, s[16:19], s61 offen offset:0 sc1 lds
buffer_load_dwordx4 v14, s[16:19], s61 offen offset:1024 sc1 lds
buffer_load_dwordx4 v15, s[16:19], s61 offen offset:2048 sc1 lds
s_add_u32 m0, s60, 32768
s_nop 0
buffer_load_dwordx4 v9, s[20:23], s58 offen offset:1024 lds
s_add_u32 m0, s60, 34816
s_nop 0
buffer_load_dwordx4 v18, s[20:23], s58 offen offset:0 lds
s_add_u32 m0, s60, 34816
s_nop 0
buffer_load_dwordx4 v19, s[20:23], s58 offen offset:1024 lds
s_waitcnt vmcnt(15)
s_barrier
s_add_u32 s61, s51, 8
s_and_b32 s61, s61, 15
s_mul_i32 s61, s61, 12288
s_add_u32 m0, s54, 0
s_add_u32 s61, s61, s53
buffer_load_dwordx4 v10, s[16:19], s61 offen offset:0 sc1 lds
buffer_load_dwordx4 v14, s[16:19], s61 offen offset:1024 sc1 lds
buffer_load_dwordx4 v15, s[16:19], s61 offen offset:2048 sc1 lds
s_add_u32 s58, s51, 10
s_and_b32 s58, s58, 15
s_lshl_b32 s58, s58, 7
s_add_u32 s58, s58, s59
s_add_u32 m0, s60, 49152
s_nop 0
buffer_load_dwordx4 v8, s[20:23], s58 offen offset:0 lds
s_add_u32 m0, s60, 49152
s_nop 0
buffer_load_dwordx4 v9, s[20:23], s58 offen offset:1024 lds
s_add_u32 m0, s60, 51200
s_nop 0
buffer_load_dwordx4 v18, s[20:23], s58 offen offset:0 lds
s_waitcnt vmcnt(15)
s_barrier
s_add_u32 s61, s51, 9
s_and_b32 s61, s61, 15
s_mul_i32 s61, s61, 12288
s_add_u32 m0, s54, 12288
s_add_u32 s61, s61, s53
buffer_load_dwordx4 v10, s[16:19], s61 offen offset:0 sc1 lds
buffer_load_dwordx4 v14, s[16:19], s61 offen offset:1024 sc1 lds
buffer_load_dwordx4 v15, s[16:19], s61 offen offset:2048 sc1 lds
s_add_u32 m0, s60, 51200
s_nop 0
buffer_load_dwordx4 v19, s[20:23], s58 offen offset:1024 lds
s_add_u32 s58, s51, 11
s_and_b32 s58, s58, 15
s_lshl_b32 s58, s58, 7
s_add_u32 s58, s58, s59
s_add_u32 m0, s60, 65536
s_nop 0
buffer_load_dwordx4 v8, s[20:23], s58 offen offset:0 lds
s_add_u32 m0, s60, 65536
s_nop 0
buffer_load_dwordx4 v9, s[20:23], s58 offen offset:1024 lds
s_waitcnt vmcnt(15)
s_barrier
s_add_u32 s61, s51, 10
s_and_b32 s61, s61, 15
s_mul_i32 s61, s61, 12288
s_add_u32 m0, s54, 24576
s_add_u32 s61, s61, s53
buffer_load_dwordx4 v10, s[16:19], s61 offen offset:0 sc1 lds
buffer_load_dwordx4 v14, s[16:19], s61 offen offset:1024 sc1 lds
buffer_load_dwordx4 v15, s[16:19], s61 offen offset:2048 sc1 lds
s_add_u32 m0, s60, 67584
s_nop 0
buffer_load_dwordx4 v18, s[20:23], s58 offen offset:0 lds
s_add_u32 m0, s60, 67584
s_nop 0
buffer_load_dwordx4 v19, s[20:23], s58 offen offset:1024 lds
s_add_u32 s58, s51, 12
s_and_b32 s58, s58, 15
s_lshl_b32 s58, s58, 7
s_add_u32 s58, s58, s59
s_add_u32 m0, s60, 81920
s_nop 0
buffer_load_dwordx4 v8, s[20:23], s58 offen offset:0 lds
s_waitcnt vmcnt(15)
s_barrier
s_add_u32 s61, s51, 11
s_and_b32 s61, s61, 15
s_mul_i32 s61, s61, 12288
s_add_u32 m0, s54, 36864
s_add_u32 s61, s61, s53
buffer_load_dwordx4 v10, s[16:19], s61 offen offset:0 sc1 lds
buffer_load_dwordx4 v14, s[16:19], s61 offen offset:1024 sc1 lds
buffer_load_dwordx4 v15, s[16:19], s61 offen offset:2048 sc1 lds
s_add_u32 m0, s60, 81920
s_nop 0
buffer_load_dwordx4 v9, s[20:23], s58 offen offset:1024 lds
s_add_u32 m0, s60, 83968
s_nop 0
buffer_load_dwordx4 v18, s[20:23], s58 offen offset:0 lds
s_add_u32 m0, s60, 83968
s_nop 0
buffer_load_dwordx4 v19, s[20:23], s58 offen offset:1024 lds
s_waitcnt vmcnt(15)
s_barrier
s_add_u32 s61, s51, 12
s_and_b32 s61, s61, 15
s_mul_i32 s61, s61, 12288
s_add_u32 m0, s54, 0
s_add_u32 s61, s61, s53
buffer_load_dwordx4 v10, s[16:19], s61 offen offset:0 sc1 lds
buffer_load_dwordx4 v14, s[16:19], s61 offen offset:1024 sc1 lds
buffer_load_dwordx4 v15, s[16:19], s61 offen offset:2048 sc1 lds
s_add_u32 s58, s51, 13
s_and_b32 s58, s58, 15
s_lshl_b32 s58, s58, 7
s_add_u32 s58, s58, s59
s_add_u32 m0, s60, 98304
s_nop 0
buffer_load_dwordx4 v8, s[20:23], s58 offen offset:0 lds
s_add_u32 m0, s60, 98304
s_nop 0
buffer_load_dwordx4 v9, s[20:23], s58 offen offset:1024 lds
s_add_u32 m0, s60, 100352
s_nop 0
buffer_load_dwordx4 v18, s[20:23], s58 offen offset:0 lds
s_waitcnt vmcnt(20)
s_waitcnt vmcnt(15)
s_barrier
s_lshl_b32 s62, s6, 11
s_add_u32 s62, s62, 22086656
s_lshr_b32 s61, s49, 1
s_lshl_b32 s61, s61, 12
s_add_u32 s61, s61, 22249472
v_lshlrev_b32 v21, 7, v1
v_add_u32 v20, s61, v21
s_lshl_b32 s63, s50, 7
s_add_u32 s62, s62, s63
v_mov_b32 v21, s62
v_cmp_lt_u32 vcc, 31, v1
s_nop 1
v_cndmask_b32 v20, v20, v21, vcc
s_cmp_eq_u32 s45, 0
s_cselect_b32 s77, 0, 268435456
s_cselect_b32 s62, 268435456, 0
s_mov_b32 s78, s62
buffer_load_dword v21, v20, s[16:19], s77 offen sc1
s_add_u32 s61, s51, 13
s_and_b32 s61, s61, 15
s_mul_i32 s61, s61, 12288
s_add_u32 m0, s54, 12288
s_add_u32 s61, s61, s53
buffer_load_dwordx4 v10, s[16:19], s61 offen offset:0 sc1 lds
buffer_load_dwordx4 v14, s[16:19], s61 offen offset:1024 sc1 lds
buffer_load_dwordx4 v15, s[16:19], s61 offen offset:2048 sc1 lds
s_add_u32 m0, s60, 100352
s_nop 0
buffer_load_dwordx4 v19, s[20:23], s58 offen offset:1024 lds
s_add_u32 s58, s51, 14
s_and_b32 s58, s58, 15
s_lshl_b32 s58, s58, 7
s_add_u32 s58, s58, s59
s_add_u32 m0, s60, 0
s_nop 0
buffer_load_dwordx4 v8, s[20:23], s58 offen offset:0 lds
s_add_u32 m0, s60, 0
s_nop 0
buffer_load_dwordx4 v9, s[20:23], s58 offen offset:1024 lds
s_waitcnt vmcnt(20)
s_waitcnt vmcnt(16)
s_barrier
s_add_u32 s61, s51, 14
s_and_b32 s61, s61, 15
s_mul_i32 s61, s61, 12288
s_add_u32 m0, s54, 24576
s_add_u32 s61, s61, s53
buffer_load_dwordx4 v10, s[16:19], s61 offen offset:0 sc1 lds
buffer_load_dwordx4 v14, s[16:19], s61 offen offset:1024 sc1 lds
buffer_load_dwordx4 v15, s[16:19], s61 offen offset:2048 sc1 lds
s_add_u32 m0, s60, 2048
s_nop 0
buffer_load_dwordx4 v18, s[20:23], s58 offen offset:0 lds
s_add_u32 m0, s60, 2048
s_nop 0
buffer_load_dwordx4 v19, s[20:23], s58 offen offset:1024 lds
s_add_u32 s58, s51, 15
s_and_b32 s58, s58, 15
s_lshl_b32 s58, s58, 7
s_add_u32 s58, s58, s59
s_add_u32 m0, s60, 16384
s_nop 0
buffer_load_dwordx4 v8, s[20:23], s58 offen offset:0 lds
s_waitcnt vmcnt(19)
s_waitcnt vmcnt(16)
s_barrier
s_add_u32 s61, s51, 15
s_and_b32 s61, s61, 15
s_mul_i32 s61, s61, 12288
s_add_u32 m0, s54, 36864
s_add_u32 s61, s61, s53
buffer_load_dwordx4 v10, s[16:19], s61 offen offset:0 sc1 lds
buffer_load_dwordx4 v14, s[16:19], s61 offen offset:1024 sc1 lds
buffer_load_dwordx4 v15, s[16:19], s61 offen offset:2048 sc1 lds
s_add_u32 m0, s60, 16384
s_nop 0
buffer_load_dwordx4 v9, s[20:23], s58 offen offset:1024 lds
s_add_u32 m0, s60, 18432
s_nop 0
buffer_load_dwordx4 v18, s[20:23], s58 offen offset:0 lds
s_add_u32 m0, s60, 18432
s_nop 0
buffer_load_dwordx4 v19, s[20:23], s58 offen offset:1024 lds
s_waitcnt vmcnt(14)
s_cmp_lg_u32 s45, 0
s_cbranch_scc1 Lf2z_25
v_cmp_ne_u32 vcc, s52, v21
s_cmp_eq_u64 vcc, 0
s_cbranch_scc1 Lok_27
s_mov_b32 s63, 0
Lspin_26:
buffer_load_dword v21, v20, s[16:19], 0 offen sc1
s_waitcnt vmcnt(0)
s_add_u32 s63, s63, 1
s_cmp_gt_u32 s63, 32768
s_cbranch_scc1 Lok_27
v_cmp_ne_u32 vcc, s52, v21
s_cmp_eq_u64 vcc, 0
s_cbranch_scc0 Lspin_26
Lok_27:
Lf2z_25:
s_barrier
buffer_load_dword v22, v20, s[16:19], s78 offen sc1
s_waitcnt vmcnt(8)
s_waitcnt vmcnt(1)
s_barrier
ds_write_b128 v28, v[104:107] offset:32768
ds_write_b128 v28, v[108:111] offset:36864
ds_write_b128 v28, v[112:115] offset:40960
ds_write_b128 v28, v[116:119] offset:45056
s_add_u32 m0, s76, 32768
s_add_u32 s46, s47, 0
buffer_load_dwordx4 v26, s[28:31], s46 offen lds
s_add_u32 m0, s76, 36864
s_add_u32 s46, s47, 32768
buffer_load_dwordx4 v26, s[28:31], s46 offen lds
s_add_u32 m0, s76, 40960
s_add_u32 s46, s47, 65536
buffer_load_dwordx4 v26, s[28:31], s46 offen lds
s_add_u32 m0, s76, 45056
s_add_u32 s46, s47, 98304
buffer_load_dwordx4 v26, s[28:31], s46 offen lds
s_add_u32 m0, s76, 49152
s_add_u32 s46, s47, 131072
buffer_load_dwordx4 v26, s[28:31], s46 offen lds
s_add_u32 m0, s76, 53248
s_add_u32 s46, s47, 163840
buffer_load_dwordx4 v26, s[28:31], s46 offen lds
s_add_u32 m0, s76, 57344
s_add_u32 s46, s47, 196608
buffer_load_dwordx4 v26, s[28:31], s46 offen lds
s_add_u32 m0, s76, 61440
s_add_u32 s46, s47, 229376
buffer_load_dwordx4 v26, s[28:31], s46 offen lds
v_mov_b32 v30, 135168
s_mov_b32 s63, 0
Llw_28:
ds_read_b128 v[32:35], v30
s_add_u32 s63, s63, 1
s_waitcnt lgkmcnt(0)
v_xor_b32 v32, s52, v32
v_xor_b32 v33, s52, v33
v_xor_b32 v34, s52, v34
v_xor_b32 v35, s52, v35
v_or3_b32 v32, v32, v33, v34
v_or_b32_e64 v32, v32, v35
v_cmp_eq_u32 vcc, 0, v32
s_cbranch_vccnz Llk_29
s_cmp_lt_u32 s63, 0x100000
s_cbranch_scc1 Llw_28
Llk_29:
ds_write_b128 v27, v[120:123] offset:0
ds_write_b128 v27, v[124:127] offset:4096
ds_write_b128 v27, v[128:131] offset:8192
ds_write_b128 v27, v[132:135] offset:12288
ds_write_b128 v27, v[136:139] offset:16384
ds_write_b128 v27, v[140:143] offset:20480
ds_write_b128 v27, v[144:147] offset:24576
ds_write_b128 v27, v[148:151] offset:28672
ds_write_b128 v28, v[152:155] offset:49152
ds_write_b128 v28, v[156:159] offset:53248
ds_write_b128 v28, v[160:163] offset:57344
ds_write_b128 v28, v[164:167] offset:61440
s_waitcnt vmcnt(8)
v_or_b32_e64 v21, v21, v22
v_cmp_ne_u32 vcc, s52, v21
s_cmp_eq_u64 vcc, 0
s_cbranch_scc1 Lok_31
s_mov_b32 s63, 0
Lspin_30:
buffer_load_dword v21, v20, s[16:19], 0 offen sc1
s_waitcnt vmcnt(0)
s_add_u32 s63, s63, 1
s_cmp_gt_u32 s63, 32768
s_cbranch_scc1 Lok_31
v_cmp_ne_u32 vcc, s52, v21
s_cmp_eq_u64 vcc, 0
s_cbranch_scc0 Lspin_30
Lok_31:
s_waitcnt lgkmcnt(0)
s_barrier
s_barrier
s_add_u32 m0, s76, 65536
s_add_u32 s46, s47, 262144
buffer_load_dwordx4 v26, s[28:31], s46 offen lds
s_add_u32 m0, s76, 69632
s_add_u32 s46, s47, 294912
buffer_load_dwordx4 v26, s[28:31], s46 offen lds
s_add_u32 m0, s76, 73728
s_add_u32 s46, s47, 327680
buffer_load_dwordx4 v26, s[28:31], s46 offen lds
s_add_u32 m0, s76, 77824
s_add_u32 s46, s47, 360448
buffer_load_dwordx4 v26, s[28:31], s46 offen lds
s_add_u32 m0, s76, 81920
s_add_u32 s46, s47, 393216
buffer_load_dwordx4 v26, s[28:31], s46 offen lds
s_add_u32 m0, s76, 86016
s_add_u32 s46, s47, 425984
buffer_load_dwordx4 v26, s[28:31], s46 offen lds
s_add_u32 m0, s76, 90112
s_add_u32 s46, s47, 458752
buffer_load_dwordx4 v26, s[28:31], s46 offen lds
s_add_u32 m0, s76, 94208
s_add_u32 s46, s47, 491520
buffer_load_dwordx4 v26, s[28:31], s46 offen lds
s_add_u32 m0, s76, 131072
s_add_u32 s46, s47, 524288
buffer_load_dwordx4 v26, s[28:31], s46 offen lds
s_add_u32 m0, s76, 135168
s_add_u32 s46, s47, 557056
buffer_load_dwordx4 v26, s[28:31], s46 offen lds
s_add_u32 m0, s76, 139264
s_add_u32 s46, s47, 589824
buffer_load_dwordx4 v26, s[28:31], s46 offen lds
s_add_u32 m0, s76, 143360
s_add_u32 s46, s47, 622592
buffer_load_dwordx4 v26, s[28:31], s46 offen lds
s_add_u32 m0, s76, 147456
s_add_u32 s46, s47, 655360
buffer_load_dwordx4 v26, s[28:31], s46 offen lds
s_add_u32 m0, s76, 151552
s_add_u32 s46, s47, 688128
buffer_load_dwordx4 v26, s[28:31], s46 offen lds
v_lshrrev_b32 v3, 3, v1
s_lshl_b32 s61, s3, 3
v_add_u32 v3, s61, v3
v_and_b32_e64 v30, 7, v1
v_mul_u32_u24 v6, 272, v3
v_lshl_add_u32 v6, v30, 5, v6
v_add_u32 v5, 98304, v6
v_and_b32 v31, 15, v3
v_lshlrev_b32 v31, 1, v31
v_bfe_u32 v7, v3, 4, 1
v_add_u32 v31, v31, v7
v_and_b32 v7, 32, v3
v_add_u32 v31, v31, v7
v_lshlrev_b32 v31, 10, v31
v_lshl_add_u32 v7, v30, 4, v31
s_lshl_b32 s47, s49, 9
s_add_u32 s47, s47, s50
s_lshl_b32 s47, s47, 7
buffer_load_dwordx4 v[8:11], v7, s[8:11], s47 offen
s_waitcnt vmcnt(1)
s_waitcnt lgkmcnt(0)
s_barrier
s_waitcnt vmcnt(0)
v_lshlrev_b32 v64, 16, v8
v_and_b32 v65, 0xffff0000, v8
v_lshlrev_b32_e64 v66, 16, v9
v_and_b32 v67, 0xffff0000, v9
v_lshlrev_b32_e64 v68, 16, v10
v_and_b32 v69, 0xffff0000, v10
v_lshlrev_b32_e64 v70, 16, v11
v_and_b32 v71, 0xffff0000, v11
s_waitcnt lgkmcnt(0)
s_barrier
ds_read_b128 v[16:19], v6
ds_read_b128 v[20:23], v6 offset:16
ds_read_b128 v[24:27], v5
ds_read_b128 v[28:31], v5 offset:16
s_waitcnt lgkmcnt(2)
v_pk_add_f32 v[64:65], v[64:65], v[16:17]
v_pk_add_f32 v[66:67], v[66:67], v[18:19]
v_pk_add_f32 v[68:69], v[68:69], v[20:21]
v_pk_add_f32 v[70:71], v[70:71], v[22:23]
s_waitcnt lgkmcnt(0)
v_pk_add_f32 v[64:65], v[64:65], v[24:25]
v_pk_add_f32 v[66:67], v[66:67], v[26:27]
v_pk_add_f32 v[68:69], v[68:69], v[28:29]
v_pk_add_f32 v[70:71], v[70:71], v[30:31]
v_cvt_pk_bf16_f32 v32, v64, v65
v_cvt_pk_bf16_f32 v33, v66, v67
v_cvt_pk_bf16_f32 v34, v68, v69
v_cvt_pk_bf16_f32 v35, v70, v71
buffer_store_dwordx4 v[32:35], v7, s[32:35], s47 offen
s_endpgm
Lb7_62:
s_barrier
ds_read_b128 v[80:83], v18 offset:0
ds_read_b128 v[84:87], v10 offset:0
ds_read_b128 v[88:91], v18 offset:3072
ds_read_b128 v[92:95], v11 offset:0
ds_read_b128 v[96:99], v18 offset:6144
ds_read_b128 v[100:103], v12 offset:0
ds_read_b128 v[104:107], v18 offset:9216
ds_read_b128 v[108:111], v13 offset:0
s_waitcnt lgkmcnt(6)
v_mfma_f32_32x32x16_bf16 v[32:47], v[80:83], v[84:87], v[232:247]
s_waitcnt lgkmcnt(0)
s_barrier
ds_read_b128 v[112:115], v18 offset:12288
ds_read_b128 v[116:119], v10 offset:16384
v_mfma_f32_32x32x16_bf16 v[32:47], v[88:91], v[92:95], v[32:47]
ds_read_b128 v[120:123], v18 offset:15360
ds_read_b128 v[124:127], v11 offset:16384
v_mfma_f32_32x32x16_bf16 v[32:47], v[96:99], v[100:103], v[32:47]
ds_read_b128 v[128:131], v18 offset:18432
ds_read_b128 v[132:135], v12 offset:16384
v_mfma_f32_32x32x16_bf16 v[32:47], v[104:107], v[108:111], v[32:47]
ds_read_b128 v[136:139], v18 offset:21504
ds_read_b128 v[140:143], v13 offset:16384
s_waitcnt lgkmcnt(6)
v_mfma_f32_32x32x16_bf16 v[32:47], v[112:115], v[116:119], v[32:47]
v_mov_b32 v30, s52
v_mov_b32 v31, 0
s_waitcnt vmcnt(0)
s_mov_b64 exec, 1
buffer_store_dword v30, v31, s[16:19], s75 offen sc1
s_mov_b64 exec, -1
s_waitcnt lgkmcnt(0)
s_barrier
ds_read_b128 v[80:83], v18 offset:24576
ds_read_b128 v[84:87], v10 offset:32768
v_mfma_f32_32x32x16_bf16 v[32:47], v[120:123], v[124:127], v[32:47]
ds_read_b128 v[88:91], v18 offset:27648
ds_read_b128 v[92:95], v11 offset:32768
v_mfma_f32_32x32x16_bf16 v[32:47], v[128:131], v[132:135], v[32:47]
ds_read_b128 v[96:99], v18 offset:30720
ds_read_b128 v[100:103], v12 offset:32768
v_mfma_f32_32x32x16_bf16 v[32:47], v[136:139], v[140:143], v[32:47]
ds_read_b128 v[104:107], v18 offset:33792
ds_read_b128 v[108:111], v13 offset:32768
s_waitcnt lgkmcnt(6)
v_mfma_f32_32x32x16_bf16 v[32:47], v[80:83], v[84:87], v[32:47]
s_waitcnt lgkmcnt(0)
s_barrier
ds_read_b128 v[112:115], v18 offset:36864
ds_read_b128 v[116:119], v10 offset:49152
v_mfma_f32_32x32x16_bf16 v[32:47], v[88:91], v[92:95], v[32:47]
ds_read_b128 v[120:123], v18 offset:39936
ds_read_b128 v[124:127], v11 offset:49152
v_mfma_f32_32x32x16_bf16 v[32:47], v[96:99], v[100:103], v[32:47]
ds_read_b128 v[128:131], v18 offset:43008
ds_read_b128 v[132:135], v12 offset:49152
v_mfma_f32_32x32x16_bf16 v[32:47], v[104:107], v[108:111], v[32:47]
ds_read_b128 v[136:139], v18 offset:46080
ds_read_b128 v[140:143], v13 offset:49152
s_waitcnt lgkmcnt(6)
v_mfma_f32_32x32x16_bf16 v[32:47], v[112:115], v[116:119], v[32:47]
s_waitcnt lgkmcnt(0)
s_barrier
ds_read_b128 v[80:83], v18 offset:0
ds_read_b128 v[84:87], v14 offset:0
v_mfma_f32_32x32x16_bf16 v[32:47], v[120:123], v[124:127], v[32:47]
ds_read_b128 v[88:91], v18 offset:3072
ds_read_b128 v[92:95], v15 offset:0
v_mfma_f32_32x32x16_bf16 v[32:47], v[128:131], v[132:135], v[32:47]
ds_read_b128 v[96:99], v18 offset:6144
ds_read_b128 v[100:103], v16 offset:0
v_mfma_f32_32x32x16_bf16 v[32:47], v[136:139], v[140:143], v[32:47]
ds_read_b128 v[104:107], v18 offset:9216
ds_read_b128 v[108:111], v17 offset:0
s_waitcnt lgkmcnt(6)
v_mfma_f32_32x32x16_bf16 v[32:47], v[80:83], v[84:87], v[32:47]
s_waitcnt lgkmcnt(0)
s_barrier
ds_read_b128 v[112:115], v18 offset:12288
ds_read_b128 v[116:119], v14 offset:16384
v_mfma_f32_32x32x16_bf16 v[32:47], v[88:91], v[92:95], v[32:47]
ds_read_b128 v[120:123], v18 offset:15360
ds_read_b128 v[124:127], v15 offset:16384
v_mfma_f32_32x32x16_bf16 v[32:47], v[96:99], v[100:103], v[32:47]
ds_read_b128 v[128:131], v18 offset:18432
ds_read_b128 v[132:135], v16 offset:16384
v_mfma_f32_32x32x16_bf16 v[32:47], v[104:107], v[108:111], v[32:47]
ds_read_b128 v[136:139], v18 offset:21504
ds_read_b128 v[140:143], v17 offset:16384
s_waitcnt lgkmcnt(6)
v_mfma_f32_32x32x16_bf16 v[32:47], v[112:115], v[116:119], v[32:47]
s_waitcnt lgkmcnt(0)
s_barrier
ds_read_b128 v[80:83], v18 offset:24576
ds_read_b128 v[84:87], v14 offset:32768
v_mfma_f32_32x32x16_bf16 v[32:47], v[120:123], v[124:127], v[32:47]
ds_read_b128 v[88:91], v18 offset:27648
ds_read_b128 v[92:95], v15 offset:32768
v_mfma_f32_32x32x16_bf16 v[32:47], v[128:131], v[132:135], v[32:47]
ds_read_b128 v[96:99], v18 offset:30720
ds_read_b128 v[100:103], v16 offset:32768
v_mfma_f32_32x32x16_bf16 v[32:47], v[136:139], v[140:143], v[32:47]
ds_read_b128 v[104:107], v18 offset:33792
ds_read_b128 v[108:111], v17 offset:32768
s_waitcnt lgkmcnt(6)
v_mfma_f32_32x32x16_bf16 v[32:47], v[80:83], v[84:87], v[32:47]
s_waitcnt lgkmcnt(0)
s_barrier
ds_read_b128 v[112:115], v18 offset:36864
ds_read_b128 v[116:119], v10 offset:0
v_mfma_f32_32x32x16_bf16 v[32:47], v[88:91], v[92:95], v[32:47]
ds_read_b128 v[120:123], v18 offset:39936
ds_read_b128 v[124:127], v11 offset:0
v_mfma_f32_32x32x16_bf16 v[32:47], v[96:99], v[100:103], v[32:47]
ds_read_b128 v[128:131], v18 offset:43008
ds_read_b128 v[132:135], v12 offset:0
v_mfma_f32_32x32x16_bf16 v[32:47], v[104:107], v[108:111], v[32:47]
ds_read_b128 v[136:139], v18 offset:46080
ds_read_b128 v[140:143], v13 offset:0
s_waitcnt lgkmcnt(6)
v_mfma_f32_32x32x16_bf16 v[32:47], v[112:115], v[116:119], v[32:47]
s_waitcnt lgkmcnt(0)
s_barrier
ds_read_b128 v[80:83], v18 offset:0
ds_read_b128 v[84:87], v10 offset:16384
v_mfma_f32_32x32x16_bf16 v[32:47], v[120:123], v[124:127], v[32:47]
ds_read_b128 v[88:91], v18 offset:3072
ds_read_b128 v[92:95], v11 offset:16384
v_mfma_f32_32x32x16_bf16 v[32:47], v[128:131], v[132:135], v[32:47]
ds_read_b128 v[96:99], v18 offset:6144
ds_read_b128 v[100:103], v12 offset:16384
v_mfma_f32_32x32x16_bf16 v[32:47], v[136:139], v[140:143], v[32:47]
ds_read_b128 v[104:107], v18 offset:9216
ds_read_b128 v[108:111], v13 offset:16384
s_waitcnt lgkmcnt(6)
v_mfma_f32_32x32x16_bf16 v[32:47], v[80:83], v[84:87], v[32:47]
s_waitcnt lgkmcnt(0)
s_barrier
ds_read_b128 v[112:115], v18 offset:12288
ds_read_b128 v[116:119], v10 offset:32768
v_mfma_f32_32x32x16_bf16 v[32:47], v[88:91], v[92:95], v[32:47]
ds_read_b128 v[120:123], v18 offset:15360
ds_read_b128 v[124:127], v11 offset:32768
v_mfma_f32_32x32x16_bf16 v[32:47], v[96:99], v[100:103], v[32:47]
ds_read_b128 v[128:131], v18 offset:18432
ds_read_b128 v[132:135], v12 offset:32768
v_mfma_f32_32x32x16_bf16 v[32:47], v[104:107], v[108:111], v[32:47]
ds_read_b128 v[136:139], v18 offset:21504
ds_read_b128 v[140:143], v13 offset:32768
s_waitcnt lgkmcnt(6)
v_mfma_f32_32x32x16_bf16 v[32:47], v[112:115], v[116:119], v[32:47]
s_waitcnt lgkmcnt(0)
s_barrier
ds_read_b128 v[80:83], v18 offset:24576
ds_read_b128 v[84:87], v10 offset:49152
v_mfma_f32_32x32x16_bf16 v[32:47], v[120:123], v[124:127], v[32:47]
ds_read_b128 v[88:91], v18 offset:27648
ds_read_b128 v[92:95], v11 offset:49152
v_mfma_f32_32x32x16_bf16 v[32:47], v[128:131], v[132:135], v[32:47]
ds_read_b128 v[96:99], v18 offset:30720
ds_read_b128 v[100:103], v12 offset:49152
v_mfma_f32_32x32x16_bf16 v[32:47], v[136:139], v[140:143], v[32:47]
ds_read_b128 v[104:107], v18 offset:33792
ds_read_b128 v[108:111], v13 offset:49152
s_waitcnt lgkmcnt(6)
v_mfma_f32_32x32x16_bf16 v[32:47], v[80:83], v[84:87], v[32:47]
s_waitcnt lgkmcnt(0)
s_barrier
ds_read_b128 v[112:115], v18 offset:36864
ds_read_b128 v[116:119], v14 offset:0
v_mfma_f32_32x32x16_bf16 v[32:47], v[88:91], v[92:95], v[32:47]
ds_read_b128 v[120:123], v18 offset:39936
ds_read_b128 v[124:127], v15 offset:0
v_mfma_f32_32x32x16_bf16 v[32:47], v[96:99], v[100:103], v[32:47]
ds_read_b128 v[128:131], v18 offset:43008
ds_read_b128 v[132:135], v16 offset:0
v_mfma_f32_32x32x16_bf16 v[32:47], v[104:107], v[108:111], v[32:47]
ds_read_b128 v[136:139], v18 offset:46080
ds_read_b128 v[140:143], v17 offset:0
s_waitcnt lgkmcnt(6)
v_mfma_f32_32x32x16_bf16 v[32:47], v[112:115], v[116:119], v[32:47]
s_waitcnt lgkmcnt(0)
s_barrier
ds_read_b128 v[80:83], v18 offset:0
ds_read_b128 v[84:87], v14 offset:16384
v_mfma_f32_32x32x16_bf16 v[32:47], v[120:123], v[124:127], v[32:47]
ds_read_b128 v[88:91], v18 offset:3072
ds_read_b128 v[92:95], v15 offset:16384
v_mfma_f32_32x32x16_bf16 v[32:47], v[128:131], v[132:135], v[32:47]
ds_read_b128 v[96:99], v18 offset:6144
ds_read_b128 v[100:103], v16 offset:16384
v_mfma_f32_32x32x16_bf16 v[32:47], v[136:139], v[140:143], v[32:47]
ds_read_b128 v[104:107], v18 offset:9216
ds_read_b128 v[108:111], v17 offset:16384
s_waitcnt lgkmcnt(6)
v_mfma_f32_32x32x16_bf16 v[32:47], v[80:83], v[84:87], v[32:47]
s_waitcnt lgkmcnt(0)
s_barrier
ds_read_b128 v[112:115], v18 offset:12288
ds_read_b128 v[116:119], v14 offset:32768
s_cmp_lg_u32 s45, 0
s_cbranch_scc1 Lnz_70
buffer_load_dwordx4 v[144:147], v19, s[16:19], s53 offen offset:0 sc1
Lnz_70:
v_mfma_f32_32x32x16_bf16 v[32:47], v[88:91], v[92:95], v[32:47]
ds_read_b128 v[120:123], v18 offset:15360
ds_read_b128 v[124:127], v15 offset:32768
s_cmp_lg_u32 s45, 0
s_cbranch_scc1 Lnz_71
buffer_load_dwordx4 v[148:151], v19, s[16:19], s53 offen offset:1024 sc1
Lnz_71:
v_mfma_f32_32x32x16_bf16 v[32:47], v[96:99], v[100:103], v[32:47]
ds_read_b128 v[128:131], v18 offset:18432
ds_read_b128 v[132:135], v16 offset:32768
s_cmp_gt_u32 s58, 2
s_cselect_b32 s53, s53, s60
s_cmp_lg_u32 s45, 0
s_cbranch_scc1 Lnz_72
buffer_load_dwordx4 v[152:155], v19, s[16:19], s53 offen offset:2048 sc1
Lnz_72:
v_mfma_f32_32x32x16_bf16 v[32:47], v[104:107], v[108:111], v[32:47]
ds_read_b128 v[136:139], v18 offset:21504
ds_read_b128 v[140:143], v17 offset:32768
s_cmp_gt_u32 s58, 3
s_cselect_b32 s53, s53, s60
s_cmp_lg_u32 s45, 0
s_cbranch_scc1 Lnz_73
buffer_load_dwordx4 v[156:159], v19, s[16:19], s53 offen offset:3072 sc1
Lnz_73:
s_waitcnt lgkmcnt(6)
v_mfma_f32_32x32x16_bf16 v[32:47], v[112:115], v[116:119], v[32:47]
s_waitcnt lgkmcnt(0)
s_barrier
ds_read_b128 v[80:83], v18 offset:24576
ds_read_b128 v[84:87], v10 offset:0
s_add_u32 s53, s53, 4096
s_cmp_gt_u32 s58, 4
s_cselect_b32 s53, s53, s60
s_cmp_lg_u32 s45, 0
s_cbranch_scc1 Lnz_74
buffer_load_dwordx4 v[160:163], v19, s[16:19], s53 offen offset:0 sc1
Lnz_74:
v_mfma_f32_32x32x16_bf16 v[32:47], v[120:123], v[124:127], v[32:47]
ds_read_b128 v[88:91], v18 offset:27648
ds_read_b128 v[92:95], v11 offset:0
s_cmp_gt_u32 s58, 5
s_cselect_b32 s53, s53, s60
s_cmp_lg_u32 s45, 0
s_cbranch_scc1 Lnz_75
buffer_load_dwordx4 v[164:167], v19, s[16:19], s53 offen offset:1024 sc1
Lnz_75:
v_mfma_f32_32x32x16_bf16 v[32:47], v[128:131], v[132:135], v[32:47]
ds_read_b128 v[96:99], v18 offset:30720
ds_read_b128 v[100:103], v12 offset:0
v_mfma_f32_32x32x16_bf16 v[32:47], v[136:139], v[140:143], v[32:47]
ds_read_b128 v[104:107], v18 offset:33792
ds_read_b128 v[108:111], v13 offset:0
s_waitcnt lgkmcnt(6)
v_mfma_f32_32x32x16_bf16 v[32:47], v[80:83], v[84:87], v[32:47]
ds_read_b128 v[112:115], v18 offset:36864
ds_read_b128 v[116:119], v10 offset:16384
s_waitcnt lgkmcnt(6)
v_mfma_f32_32x32x16_bf16 v[32:47], v[88:91], v[92:95], v[32:47]
ds_read_b128 v[120:123], v18 offset:39936
ds_read_b128 v[124:127], v11 offset:16384
s_waitcnt lgkmcnt(6)
v_mfma_f32_32x32x16_bf16 v[32:47], v[96:99], v[100:103], v[32:47]
ds_read_b128 v[128:131], v18 offset:43008
ds_read_b128 v[132:135], v12 offset:16384
s_waitcnt lgkmcnt(6)
v_mfma_f32_32x32x16_bf16 v[32:47], v[104:107], v[108:111], v[32:47]
ds_read_b128 v[136:139], v18 offset:46080
ds_read_b128 v[140:143], v13 offset:16384
s_waitcnt lgkmcnt(6)
v_mfma_f32_32x32x16_bf16 v[32:47], v[112:115], v[116:119], v[32:47]
s_waitcnt lgkmcnt(4)
v_mfma_f32_32x32x16_bf16 v[32:47], v[120:123], v[124:127], v[32:47]
s_waitcnt lgkmcnt(2)
v_mfma_f32_32x32x16_bf16 v[32:47], v[128:131], v[132:135], v[32:47]
s_waitcnt lgkmcnt(0)
v_mfma_f32_32x32x16_bf16 v[32:47], v[136:139], v[140:143], v[32:47]
s_branch Lbj_63
LF_end:
s_endpgm

.section .rodata,"a"
.p2align 6
.amdhsa_kernel parallel_sum__sliding_local_dilated__mixer_gmlp__prompt_kernel
  .amdhsa_next_free_vgpr 256
  .amdhsa_next_free_sgpr 102
  .amdhsa_accum_offset 256
  .amdhsa_group_segment_fixed_size 0
  .amdhsa_kernarg_size 88
  .amdhsa_user_sgpr_count 2
  .amdhsa_user_sgpr_kernarg_segment_ptr 1
  .amdhsa_system_sgpr_workgroup_id_x 1
.end_amdhsa_kernel
```
